```python
import torch

def _softmax(x, axis=-1):
    return torch.softmax(x, dim=axis)
def _gelu(x):
    return torch.nn.functional.gelu(x, approximate="tanh")
def _silu(x):
    return torch.nn.functional.silu(x)
def _sigmoid(x):
    return torch.sigmoid(x)
def _layernorm(x, axis=-1, eps=1e-5):
    m = x.mean(dim=axis, keepdim=True)
    v = x.var(dim=axis, keepdim=True, unbiased=False)
    return (x - m) / torch.sqrt(v + eps)
def _scatter_add(tgt, idx, src, axis=0):
    return tgt.clone().index_add_(axis, idx, src)
def _segment_sum(src, seg, n):
    out = torch.zeros((n,) + src.shape[1:], dtype=src.dtype)
    return out.index_add_(0, seg, src)
def _pad(x, pw):
    flat = tuple(v for pair in reversed(pw) for v in pair)
    return torch.nn.functional.pad(x, flat)

kernel_name = 'sequential_preLN__sliding_block__dense_activation_silu__prompt'

def setup_inputs():

    _w = (lambda a: (lambda t: t.to(torch.bfloat16) if t.is_floating_point() else t)(torch.as_tensor(a)))
    def _A_setup():
        B, S, D = 1, 2048, 1024
        return {
            "x": _w((lambda *s: torch.randn(*s, dtype=torch.bfloat16) * 0.05)(B, S, D)),
            "wqkv": _w((lambda *s: torch.randn(*s, dtype=torch.bfloat16) * 0.05)(D, 3 * D)),
            "wo": _w((lambda *s: torch.randn(*s, dtype=torch.bfloat16) * 0.05)(D, D)),
        }
    _A_in = _A_setup()

    def _B_setup():
        B, S, D, F = 1, 2048, 1024, 3584
        return {
            "x": _w((lambda *s: torch.randn(*s, dtype=torch.bfloat16) * 0.05)(B, S, D)),
            "w1": _w((lambda *s: torch.randn(*s, dtype=torch.bfloat16) * 3.2)(D, F) * (D ** -0.5)),
            "w2": _w((lambda *s: torch.randn(*s, dtype=torch.bfloat16) * 0.4)(F, D) * (F ** -0.5)),
        }
    _B_in = _B_setup()

    return {
        "A_x": _A_in["x"],
        "A_wqkv": _A_in["wqkv"],
        "A_wo": _A_in["wo"],
        "B_x": _B_in["x"],
        "B_w1": _B_in["w1"],
        "B_w2": _B_in["w2"],
    }

def reference(A_x, A_wqkv, A_wo, B_x, B_w1, B_w2):
    def _A_ref(x, wqkv, wo):
        B, S, D = x.shape
        H = 32; Dh = D // H; W = 256
        qkv = (lambda x, *d: x.permute(*d))((x @ wqkv).reshape(B, S, 3, H, Dh), 2, 0, 3, 1, 4)
        q, k, v = qkv[0], qkv[1], qkv[2]
        scores = torch.einsum("bhqd,bhkd->bhqk", q, k) * (Dh ** -0.5)
        idx = torch.arange(S)
        mask = (idx[:, None] - idx[None, :] >= 0) & (idx[:, None] - idx[None, :] < W)
        scores = torch.where(mask[None, None], scores, -1e9)
        p = _softmax(scores, axis=-1)
        o = torch.einsum("bhqk,bhkd->bhqd", p, v)
        return (lambda x, *d: x.permute(*d))(o, 0, 2, 1, 3).reshape(B, S, D) @ wo

    def _B_ref(x, w1, w2):
        h = torch.einsum("bsd,df->bsf", x, w1)
        h = _silu(h)
        out = torch.einsum("bsf,fd->bsd", h, w2)
        return out

    x = A_x
    h = x + _A_ref(_layernorm(x, axis=-1), A_wqkv, A_wo)
    h2 = h + _B_ref(_layernorm(h, axis=-1), B_w1, B_w2)
    return h2
```

```asm
; @launch grid=(256,1,1) block=(512,1,1) lds=163840
.amdgcn_target "amdgcn-amd-amdhsa--gfx950"
.text
.globl sequential_preLN__sliding_block__dense_activation_silu__prompt_kernel
.p2align 8
.type sequential_preLN__sliding_block__dense_activation_silu__prompt_kernel,@function
sequential_preLN__sliding_block__dense_activation_silu__prompt_kernel:
    s_cmp_ge_u32 s2, 256
    s_cbranch_scc1 L_end
    s_load_dwordx16 s[80:95], s[0:1], 0
    s_load_dwordx2 s[4:5], s[0:1], 64
    v_lshrrev_b32 v2, 6, v0
    v_and_b32 v1, 63, v0
    v_readfirstlane_b32 s3, v2
    s_getreg_b32 s74, hwreg(HW_REG_XCC_ID)
    s_and_b32 s74, s74, 15
    s_mov_b32 s72, 0
    s_mov_b32 s73, 0
    s_waitcnt lgkmcnt(0)
    s_add_u32 s76, s4, 41943040
    s_addc_u32 s77, s5, 0
    s_mov_b32 s78, 131072
    s_mov_b32 s79, 0x20000
    s_cmp_ge_u32 s3, 4
    s_cbranch_scc0 L_cons
L_prod:
    s_sub_u32 s38, s3, 4
    s_and_b32 s30, s2, 7
    s_lshr_b32 s31, s2, 3
    s_lshr_b32 s24, s30, 2
    s_lshl_b32 s24, s24, 3
    s_and_b32 s25, s30, 3
    s_lshl_b32 s25, s25, 2
    s_lshr_b32 s30, s31, 2
    s_add_u32 s24, s24, s30
    s_and_b32 s30, s31, 3
    s_add_u32 s25, s25, s30
    s_lshl_b32 s30, s24, 18
    s_add_u32 s8, s80, s30
    s_addc_u32 s9, s81, 0
    s_mov_b32 s10, 262144
    s_mov_b32 s11, 0x20000
    v_lshrrev_b32 v2, 3, v1
    v_lshrrev_b32 v3, 4, v1
    v_and_b32 v15, 7, v1
    v_xor_b32 v3, v3, v15
    v_lshlrev_b32 v3, 4, v3
    v_lshl_add_u32 v2, v2, 11, v3
    v_xor_b32 v3, 64, v2
    s_lshl_b32 s30, s38, 16
    s_add_u32 s31, s30, 0
    v_add_u32 v4, s31, v2
    s_add_u32 s31, s30, 15360
    v_add_u32 v5, s31, v3
    s_add_u32 s31, s30, 30720
    v_add_u32 v6, s31, v2
    s_add_u32 s31, s30, 46080
    v_add_u32 v7, s31, v3
    s_and_b32 s65, s25, 3
    s_mul_i32 s65, s65, 0
    s_lshl_b32 s34, s38, 12
    s_mul_i32 s35, s38, 6144
    s_mul_i32 s30, s25, 128
    s_sub_u32 s31, 6291456, s30
    s_add_u32 s12, s82, s30
    s_addc_u32 s13, s83, 0
    s_mov_b32 s14, s31
    s_mov_b32 s15, 0x20000
    v_lshrrev_b32 v2, 3, v1
    v_mul_u32_u24 v2, 6144, v2
    v_bfe_u32 v3, v1, 4, 1
    v_lshlrev_b32 v3, 1, v3
    v_and_b32 v15, 7, v1
    v_xor_b32 v3, v3, v15
    v_lshl_add_u32 v2, v3, 4, v2
    s_mul_i32 s36, s38, 6
    v_xor_b32 v3, 64, v2
    s_add_u32 s30, s36, 0
    s_and_b32 s31, s30, 7
    s_mul_i32 s31, s31, 49152
    s_lshr_b32 s30, s30, 3
    s_mul_i32 s30, s30, 2048
    s_add_u32 s31, s31, s30
    v_add_u32 v8, s31, v2
    s_add_u32 s30, s36, 1
    s_and_b32 s31, s30, 7
    s_mul_i32 s31, s31, 49152
    s_lshr_b32 s30, s30, 3
    s_mul_i32 s30, s30, 2048
    s_add_u32 s31, s31, s30
    s_sub_u32 s31, s31, 1024
    v_add_u32 v9, s31, v3
    s_add_u32 s30, s36, 2
    s_and_b32 s31, s30, 7
    s_mul_i32 s31, s31, 49152
    s_lshr_b32 s30, s30, 3
    s_mul_i32 s30, s30, 2048
    s_add_u32 s31, s31, s30
    s_sub_u32 s31, s31, 2048
    v_add_u32 v10, s31, v2
    s_add_u32 s30, s36, 3
    s_and_b32 s31, s30, 7
    s_mul_i32 s31, s31, 49152
    s_lshr_b32 s30, s30, 3
    s_mul_i32 s30, s30, 2048
    s_add_u32 s31, s31, s30
    s_sub_u32 s31, s31, 3072
    v_add_u32 v11, s31, v3
    s_add_u32 s30, s36, 4
    s_and_b32 s31, s30, 7
    s_mul_i32 s31, s31, 49152
    s_lshr_b32 s30, s30, 3
    s_mul_i32 s30, s30, 2048
    s_add_u32 s31, s31, s30
    v_add_u32 v12, s31, v2
    s_add_u32 s30, s36, 5
    s_and_b32 s31, s30, 7
    s_mul_i32 s31, s31, 49152
    s_lshr_b32 s30, s30, 3
    s_mul_i32 s30, s30, 2048
    s_add_u32 s31, s31, s30
    s_sub_u32 s31, s31, 1024
    v_add_u32 v13, s31, v3
    s_mov_b32 s27, 0
    s_mov_b32 s32, 49152
    s_mul_i32 s28, s65, 128
    s_mul_i32 s29, s65, 393216
    s_add_u32 m0, s34, 0
    s_nop 0
    buffer_load_dwordx4 v4, s[8:11], s28 offen offset:0 lds
    buffer_load_dwordx4 v5, s[8:11], s28 offen offset:1024 lds
    buffer_load_dwordx4 v6, s[8:11], s28 offen offset:2048 lds
    buffer_load_dwordx4 v7, s[8:11], s28 offen offset:3072 lds
    s_add_u32 s28, s28, 128
    s_add_u32 m0, s35, 49152
    s_nop 0
    buffer_load_dwordx4 v8, s[12:15], s29 offen offset:0 lds
    buffer_load_dwordx4 v9, s[12:15], s29 offen offset:1024 lds
    buffer_load_dwordx4 v10, s[12:15], s29 offen offset:2048 lds
    buffer_load_dwordx4 v11, s[12:15], s29 offen offset:3072 lds
    s_add_u32 m0, s35, 53248
    s_nop 0
    buffer_load_dwordx4 v12, s[12:15], s29 offen offset:0 lds
    buffer_load_dwordx4 v13, s[12:15], s29 offen offset:1024 lds
    s_add_u32 s29, s29, 393216
    s_mul_i32 s30, s25, 384
    s_sub_u32 s31, 6291456, s30
    s_add_u32 s20, s82, s30
    s_addc_u32 s21, s83, 0
    s_mov_b32 s22, s31
    s_mov_b32 s23, 0x20000
    v_lshrrev_b32 v2, 3, v1
    v_mul_u32_u24 v2, 6144, v2
    v_bfe_u32 v3, v1, 4, 1
    v_lshlrev_b32 v3, 1, v3
    v_and_b32 v15, 7, v1
    v_xor_b32 v3, v3, v15
    v_lshl_add_u32 v2, v3, 4, v2
    s_mul_i32 s36, s38, 6
    v_xor_b32 v3, 64, v2
    s_add_u32 s30, s36, 0
    s_and_b32 s31, s30, 7
    s_mul_i32 s31, s31, 49152
    s_lshr_b32 s30, s30, 3
    s_mul_i32 s30, s30, 128
    s_add_u32 s31, s31, s30
    v_add_u32 v16, s31, v2
    s_add_u32 s30, s36, 1
    s_and_b32 s31, s30, 7
    s_mul_i32 s31, s31, 49152
    s_lshr_b32 s30, s30, 3
    s_mul_i32 s30, s30, 128
    s_add_u32 s31, s31, s30
    v_add_u32 v17, s31, v3
    s_add_u32 s30, s36, 2
    s_and_b32 s31, s30, 7
    s_mul_i32 s31, s31, 49152
    s_lshr_b32 s30, s30, 3
    s_mul_i32 s30, s30, 128
    s_add_u32 s31, s31, s30
    v_add_u32 v18, s31, v2
    s_add_u32 s30, s36, 3
    s_and_b32 s31, s30, 7
    s_mul_i32 s31, s31, 49152
    s_lshr_b32 s30, s30, 3
    s_mul_i32 s30, s30, 128
    s_add_u32 s31, s31, s30
    v_add_u32 v19, s31, v3
    s_add_u32 s30, s36, 4
    s_and_b32 s31, s30, 7
    s_mul_i32 s31, s31, 49152
    s_lshr_b32 s30, s30, 3
    s_mul_i32 s30, s30, 128
    s_add_u32 s31, s31, s30
    v_add_u32 v20, s31, v2
    s_add_u32 s30, s36, 5
    s_and_b32 s31, s30, 7
    s_mul_i32 s31, s31, 49152
    s_lshr_b32 s30, s30, 3
    s_mul_i32 s30, s30, 128
    s_add_u32 s31, s31, s30
    v_add_u32 v21, s31, v3
    s_mul_i32 s33, s24, 393216
    s_add_u32 m0, s35, 122880
    s_nop 0
    buffer_load_dwordx4 v16, s[20:23], s33 offen lds
    s_add_u32 m0, s35, 123904
    s_nop 0
    buffer_load_dwordx4 v17, s[20:23], s33 offen lds
    s_add_u32 m0, s35, 124928
    s_nop 0
    buffer_load_dwordx4 v18, s[20:23], s33 offen lds
    s_add_u32 m0, s35, 125952
    s_nop 0
    buffer_load_dwordx4 v19, s[20:23], s33 offen lds
    s_add_u32 m0, s35, 126976
    s_nop 0
    buffer_load_dwordx4 v20, s[20:23], s33 offen lds
    s_add_u32 m0, s35, 128000
    s_nop 0
    buffer_load_dwordx4 v21, s[20:23], s33 offen lds
    s_add_u32 s44, s82, 0
    s_addc_u32 s45, s83, 0
    s_mov_b32 s46, 6291456
    s_mov_b32 s47, 0x20000
    s_and_b32 s30, s25, 3
    s_lshl_b32 s31, s30, 11
    s_or_b32 s70, s25, 3
    s_lshl_b32 s70, s70, 7
    s_add_u32 s31, s31, s70
    v_mov_b32 v2, 6144
    v_mul_lo_u32 v23, v1, v2
    v_add_u32 v23, s31, v23
    s_and_b32 s70, s24, 7
    s_cmp_eq_u32 s30, 3
    s_cselect_b32 s70, 99, s70
    s_and_b32 s30, s25, 4
    s_cselect_b32 s70, 99, s70
    s_cmp_lg_u32 s38, 0
    s_cselect_b32 s70, 99, s70
    s_add_u32 m0, s34, 16384
    s_nop 0
    buffer_load_dwordx4 v4, s[8:11], s28 offen offset:0 lds
    buffer_load_dwordx4 v5, s[8:11], s28 offen offset:1024 lds
    buffer_load_dwordx4 v6, s[8:11], s28 offen offset:2048 lds
    buffer_load_dwordx4 v7, s[8:11], s28 offen offset:3072 lds
    s_add_u32 s28, s28, 128
    s_add_u32 m0, s35, 73728
    s_nop 0
    buffer_load_dwordx4 v8, s[12:15], s29 offen offset:0 lds
    buffer_load_dwordx4 v9, s[12:15], s29 offen offset:1024 lds
    buffer_load_dwordx4 v10, s[12:15], s29 offen offset:2048 lds
    buffer_load_dwordx4 v11, s[12:15], s29 offen offset:3072 lds
    s_add_u32 m0, s35, 77824
    s_nop 0
    buffer_load_dwordx4 v12, s[12:15], s29 offen offset:0 lds
    buffer_load_dwordx4 v13, s[12:15], s29 offen offset:1024 lds
    s_add_u32 s29, s29, 393216
    s_waitcnt vmcnt(16)
    s_barrier
    s_add_u32 m0, s34, 32768
    s_nop 0
    buffer_load_dwordx4 v4, s[8:11], s28 offen offset:0 lds
    buffer_load_dwordx4 v5, s[8:11], s28 offen offset:1024 lds
    buffer_load_dwordx4 v6, s[8:11], s28 offen offset:2048 lds
    buffer_load_dwordx4 v7, s[8:11], s28 offen offset:3072 lds
    s_add_u32 s28, s28, 128
    s_add_u32 m0, s35, 98304
    s_nop 0
    buffer_load_dwordx4 v8, s[12:15], s29 offen offset:0 lds
    buffer_load_dwordx4 v9, s[12:15], s29 offen offset:1024 lds
    buffer_load_dwordx4 v10, s[12:15], s29 offen offset:2048 lds
    buffer_load_dwordx4 v11, s[12:15], s29 offen offset:3072 lds
    s_add_u32 m0, s35, 102400
    s_nop 0
    buffer_load_dwordx4 v12, s[12:15], s29 offen offset:0 lds
    buffer_load_dwordx4 v13, s[12:15], s29 offen offset:1024 lds
    s_add_u32 s29, s29, 393216
    s_cmp_lg_u32 s70, 0
    s_cbranch_scc1 skip_help_22
    s_mov_b32 s30, 1572864
    buffer_load_dword v253, v23, s[44:47], s30 offen
skip_help_22:
    s_waitcnt vmcnt(10)
    s_barrier
    s_add_u32 m0, s34, 0
    s_nop 0
    buffer_load_dwordx4 v4, s[8:11], s28 offen offset:0 lds
    buffer_load_dwordx4 v5, s[8:11], s28 offen offset:1024 lds
    buffer_load_dwordx4 v6, s[8:11], s28 offen offset:2048 lds
    buffer_load_dwordx4 v7, s[8:11], s28 offen offset:3072 lds
    s_add_u32 s28, s28, 128
    s_add_u32 m0, s35, 49152
    s_nop 0
    buffer_load_dwordx4 v8, s[12:15], s29 offen offset:0 lds
    buffer_load_dwordx4 v9, s[12:15], s29 offen offset:1024 lds
    buffer_load_dwordx4 v10, s[12:15], s29 offen offset:2048 lds
    buffer_load_dwordx4 v11, s[12:15], s29 offen offset:3072 lds
    s_add_u32 m0, s35, 53248
    s_nop 0
    buffer_load_dwordx4 v12, s[12:15], s29 offen offset:0 lds
    buffer_load_dwordx4 v13, s[12:15], s29 offen offset:1024 lds
    s_add_u32 s29, s29, 393216
    s_cmp_lg_u32 s70, 1
    s_cbranch_scc1 skip_help_23
    s_mov_b32 s30, 1966080
    buffer_load_dword v253, v23, s[44:47], s30 offen
skip_help_23:
    v_mov_b32 v2, 159744
    ds_read_b64 v[32:33], v2
    s_waitcnt lgkmcnt(0)
    v_readfirstlane_b32 s72, v32
    v_readfirstlane_b32 s73, v33
    s_setprio 3
    v_lshrrev_b32 v72, 4, v1
    v_bfe_u32 v73, v1, 2, 2
    v_mul_u32_u24 v74, 8, v72
    v_add_u32 v74, v74, v73
    v_mul_u32_u24 v74, 128, v74
    v_and_b32 v75, 3, v1
    v_lshl_add_u32 v74, v75, 3, v74
    v_and_b32 v72, 1, v72
    s_lshl_b32 s71, s38, 13
    s_add_u32 s71, s71, 122880
    v_add_u32 v74, s71, v74
    v_lshrrev_b32 v73, 1, v73
    v_lshl_or_b32 v72, v72, 1, v73
    v_xor_b32 v75, 0, v72
    v_lshl_add_u32 v32, v75, 5, v74
    v_xor_b32 v75, 1, v72
    v_lshl_add_u32 v33, v75, 5, v74
    v_xor_b32 v75, 2, v72
    v_lshl_add_u32 v34, v75, 5, v74
    v_xor_b32 v75, 3, v72
    v_lshl_add_u32 v35, v75, 5, v74
    ds_read_b64_tr_b16 v[40:41], v32 offset:0
    ds_read_b64_tr_b16 v[42:43], v33 offset:0
    ds_read_b64_tr_b16 v[44:45], v34 offset:0
    ds_read_b64_tr_b16 v[46:47], v35 offset:0
    ds_read_b64_tr_b16 v[48:49], v32 offset:512
    ds_read_b64_tr_b16 v[50:51], v33 offset:512
    ds_read_b64_tr_b16 v[52:53], v34 offset:512
    ds_read_b64_tr_b16 v[54:55], v35 offset:512
    ds_read_b64_tr_b16 v[56:57], v32 offset:4096
    ds_read_b64_tr_b16 v[58:59], v33 offset:4096
    ds_read_b64_tr_b16 v[60:61], v34 offset:4096
    ds_read_b64_tr_b16 v[62:63], v35 offset:4096
    ds_read_b64_tr_b16 v[64:65], v32 offset:4608
    ds_read_b64_tr_b16 v[66:67], v33 offset:4608
    ds_read_b64_tr_b16 v[68:69], v34 offset:4608
    ds_read_b64_tr_b16 v[70:71], v35 offset:4608
    v_mov_b32 v36, 0
    v_mov_b32 v37, 0
    v_mov_b32 v38, 0
    v_mov_b32 v39, 0
    s_add_u32 s16, s4, 44040192
    s_addc_u32 s17, s5, 0
    s_mov_b32 s18, 524288
    s_mov_b32 s19, 0x20000
    s_mov_b32 s75, 0x3f803f80
    v_lshlrev_b32 v72, 3, v1
    s_lshl_b32 s71, s24, 15
    s_mul_i32 s31, s25, 1536
    s_add_u32 s71, s71, s31
    s_lshl_b32 s31, s38, 9
    s_add_u32 s71, s71, s31
    s_cmp_eq_u32 s38, 3
    s_cselect_b32 s71, 0x40000000, s71
    s_waitcnt lgkmcnt(12)
    v_dot2c_f32_bf16 v36, s75, v40
    v_dot2c_f32_bf16 v37, s75, v42
    v_dot2c_f32_bf16 v38, s75, v44
    v_dot2c_f32_bf16 v39, s75, v46
    v_dot2c_f32_bf16 v36, s75, v41
    v_dot2c_f32_bf16 v37, s75, v43
    v_dot2c_f32_bf16 v38, s75, v45
    v_dot2c_f32_bf16 v39, s75, v47
    s_waitcnt lgkmcnt(8)
    v_dot2c_f32_bf16 v36, s75, v48
    v_dot2c_f32_bf16 v37, s75, v50
    v_dot2c_f32_bf16 v38, s75, v52
    v_dot2c_f32_bf16 v39, s75, v54
    v_dot2c_f32_bf16 v36, s75, v49
    v_dot2c_f32_bf16 v37, s75, v51
    v_dot2c_f32_bf16 v38, s75, v53
    v_dot2c_f32_bf16 v39, s75, v55
    s_waitcnt lgkmcnt(4)
    v_dot2c_f32_bf16 v36, s75, v56
    v_dot2c_f32_bf16 v37, s75, v58
    v_dot2c_f32_bf16 v38, s75, v60
    v_dot2c_f32_bf16 v39, s75, v62
    v_dot2c_f32_bf16 v36, s75, v57
    v_dot2c_f32_bf16 v37, s75, v59
    v_dot2c_f32_bf16 v38, s75, v61
    v_dot2c_f32_bf16 v39, s75, v63
    s_waitcnt lgkmcnt(0)
    v_dot2c_f32_bf16 v36, s75, v64
    v_dot2c_f32_bf16 v37, s75, v66
    v_dot2c_f32_bf16 v38, s75, v68
    v_dot2c_f32_bf16 v39, s75, v70
    v_dot2c_f32_bf16 v36, s75, v65
    v_dot2c_f32_bf16 v37, s75, v67
    v_dot2c_f32_bf16 v38, s75, v69
    v_dot2c_f32_bf16 v39, s75, v71
    s_nop 1
    v_permlane32_swap_b32 v36, v38
    v_permlane32_swap_b32 v37, v39
    v_add_f32 v36, v36, v38
    v_add_f32 v37, v37, v39
    s_nop 1
    v_permlane16_swap_b32 v36, v37
    v_add_f32 v36, v36, v37
    v_mov_b32 v37, s72
    s_cmp_lg_u32 s38, 3
    s_cbranch_scc1 skip_xi_24
    v_cmp_eq_u32 vcc, s74, v1
    s_nop 1
    v_cndmask_b32 v36, 0, 1.0, vcc
skip_xi_24:
    buffer_store_dwordx2 v[36:37], v72, s[16:19], s71 offen sc0 sc1
    s_setprio 0
    s_waitcnt vmcnt(11)
    s_barrier
    s_add_u32 m0, s34, 16384
    s_nop 0
    buffer_load_dwordx4 v4, s[8:11], s28 offen offset:0 lds
    buffer_load_dwordx4 v5, s[8:11], s28 offen offset:1024 lds
    buffer_load_dwordx4 v6, s[8:11], s28 offen offset:2048 lds
    buffer_load_dwordx4 v7, s[8:11], s28 offen offset:3072 lds
    s_add_u32 s28, s28, 128
    s_add_u32 m0, s35, 73728
    s_nop 0
    buffer_load_dwordx4 v8, s[12:15], s29 offen offset:0 lds
    buffer_load_dwordx4 v9, s[12:15], s29 offen offset:1024 lds
    buffer_load_dwordx4 v10, s[12:15], s29 offen offset:2048 lds
    buffer_load_dwordx4 v11, s[12:15], s29 offen offset:3072 lds
    s_add_u32 m0, s35, 77824
    s_nop 0
    buffer_load_dwordx4 v12, s[12:15], s29 offen offset:0 lds
    buffer_load_dwordx4 v13, s[12:15], s29 offen offset:1024 lds
    s_add_u32 s29, s29, 393216
    s_cmp_lg_u32 s70, 2
    s_cbranch_scc1 skip_help_25
    s_mov_b32 s30, 2359296
    buffer_load_dword v253, v23, s[44:47], s30 offen
skip_help_25:
    s_waitcnt vmcnt(10)
    s_barrier
    s_add_u32 m0, s34, 32768
    s_nop 0
    buffer_load_dwordx4 v4, s[8:11], s28 offen offset:0 lds
    buffer_load_dwordx4 v5, s[8:11], s28 offen offset:1024 lds
    buffer_load_dwordx4 v6, s[8:11], s28 offen offset:2048 lds
    buffer_load_dwordx4 v7, s[8:11], s28 offen offset:3072 lds
    s_add_u32 s28, s28, 128
    s_add_u32 m0, s35, 98304
    s_nop 0
    buffer_load_dwordx4 v8, s[12:15], s29 offen offset:0 lds
    buffer_load_dwordx4 v9, s[12:15], s29 offen offset:1024 lds
    buffer_load_dwordx4 v10, s[12:15], s29 offen offset:2048 lds
    buffer_load_dwordx4 v11, s[12:15], s29 offen offset:3072 lds
    s_add_u32 m0, s35, 102400
    s_nop 0
    buffer_load_dwordx4 v12, s[12:15], s29 offen offset:0 lds
    buffer_load_dwordx4 v13, s[12:15], s29 offen offset:1024 lds
    s_add_u32 s29, s29, 393216
    s_cmp_lg_u32 s70, 3
    s_cbranch_scc1 skip_help_26
    s_mov_b32 s30, 2752512
    buffer_load_dword v253, v23, s[44:47], s30 offen
skip_help_26:
    s_waitcnt vmcnt(10)
    s_barrier
    s_add_u32 m0, s34, 0
    s_nop 0
    buffer_load_dwordx4 v4, s[8:11], s28 offen offset:0 lds
    buffer_load_dwordx4 v5, s[8:11], s28 offen offset:1024 lds
    buffer_load_dwordx4 v6, s[8:11], s28 offen offset:2048 lds
    buffer_load_dwordx4 v7, s[8:11], s28 offen offset:3072 lds
    s_add_u32 s28, s28, 128
    s_add_u32 m0, s35, 49152
    s_nop 0
    buffer_load_dwordx4 v8, s[12:15], s29 offen offset:0 lds
    buffer_load_dwordx4 v9, s[12:15], s29 offen offset:1024 lds
    buffer_load_dwordx4 v10, s[12:15], s29 offen offset:2048 lds
    buffer_load_dwordx4 v11, s[12:15], s29 offen offset:3072 lds
    s_add_u32 m0, s35, 53248
    s_nop 0
    buffer_load_dwordx4 v12, s[12:15], s29 offen offset:0 lds
    buffer_load_dwordx4 v13, s[12:15], s29 offen offset:1024 lds
    s_add_u32 s29, s29, 393216
    s_cmp_lg_u32 s70, 4
    s_cbranch_scc1 skip_help_27
    s_mov_b32 s30, 3145728
    buffer_load_dword v253, v23, s[44:47], s30 offen
skip_help_27:
    s_waitcnt vmcnt(10)
    s_barrier
    s_add_u32 m0, s34, 16384
    s_nop 0
    buffer_load_dwordx4 v4, s[8:11], s28 offen offset:0 lds
    buffer_load_dwordx4 v5, s[8:11], s28 offen offset:1024 lds
    buffer_load_dwordx4 v6, s[8:11], s28 offen offset:2048 lds
    buffer_load_dwordx4 v7, s[8:11], s28 offen offset:3072 lds
    s_add_u32 s28, s28, 128
    s_add_u32 m0, s35, 73728
    s_nop 0
    buffer_load_dwordx4 v8, s[12:15], s29 offen offset:0 lds
    buffer_load_dwordx4 v9, s[12:15], s29 offen offset:1024 lds
    buffer_load_dwordx4 v10, s[12:15], s29 offen offset:2048 lds
    buffer_load_dwordx4 v11, s[12:15], s29 offen offset:3072 lds
    s_add_u32 m0, s35, 77824
    s_nop 0
    buffer_load_dwordx4 v12, s[12:15], s29 offen offset:0 lds
    buffer_load_dwordx4 v13, s[12:15], s29 offen offset:1024 lds
    s_add_u32 s29, s29, 393216
    s_cmp_lg_u32 s70, 5
    s_cbranch_scc1 skip_help_28
    s_mov_b32 s30, 3538944
    buffer_load_dword v253, v23, s[44:47], s30 offen
skip_help_28:
    s_lshl_b32 s30, s2, 2
    s_add_u32 s30, s30, s38
    s_mul_i32 s30, s30, 7168
    s_add_u32 s68, s90, s30
    s_addc_u32 s69, s91, 0
    s_load_dword s100, s[68:69], 0
    s_load_dword s101, s[68:69], 64
    s_load_dword s100, s[68:69], 128
    s_load_dword s101, s[68:69], 192
    s_load_dword s100, s[68:69], 256
    s_load_dword s101, s[68:69], 320
    s_waitcnt vmcnt(10)
    s_barrier
    s_add_u32 m0, s34, 32768
    s_nop 0
    buffer_load_dwordx4 v4, s[8:11], s28 offen offset:0 lds
    buffer_load_dwordx4 v5, s[8:11], s28 offen offset:1024 lds
    buffer_load_dwordx4 v6, s[8:11], s28 offen offset:2048 lds
    buffer_load_dwordx4 v7, s[8:11], s28 offen offset:3072 lds
    s_add_u32 s28, s28, 128
    s_add_u32 m0, s35, 98304
    s_nop 0
    buffer_load_dwordx4 v8, s[12:15], s29 offen offset:0 lds
    buffer_load_dwordx4 v9, s[12:15], s29 offen offset:1024 lds
    buffer_load_dwordx4 v10, s[12:15], s29 offen offset:2048 lds
    buffer_load_dwordx4 v11, s[12:15], s29 offen offset:3072 lds
    s_add_u32 m0, s35, 102400
    s_nop 0
    buffer_load_dwordx4 v12, s[12:15], s29 offen offset:0 lds
    buffer_load_dwordx4 v13, s[12:15], s29 offen offset:1024 lds
    s_add_u32 s29, s29, 393216
    s_cmp_lg_u32 s70, 6
    s_cbranch_scc1 skip_help_29
    s_mov_b32 s30, 3932160
    buffer_load_dword v253, v23, s[44:47], s30 offen
skip_help_29:
    s_load_dword s100, s[68:69], 384
    s_load_dword s101, s[68:69], 448
    s_load_dword s100, s[68:69], 512
    s_load_dword s101, s[68:69], 576
    s_load_dword s100, s[68:69], 640
    s_load_dword s101, s[68:69], 704
    s_waitcnt vmcnt(10)
    s_barrier
    s_add_u32 m0, s34, 0
    s_nop 0
    buffer_load_dwordx4 v4, s[8:11], s28 offen offset:0 lds
    buffer_load_dwordx4 v5, s[8:11], s28 offen offset:1024 lds
    buffer_load_dwordx4 v6, s[8:11], s28 offen offset:2048 lds
    buffer_load_dwordx4 v7, s[8:11], s28 offen offset:3072 lds
    s_add_u32 s28, s28, 128
    s_add_u32 m0, s35, 49152
    s_nop 0
    buffer_load_dwordx4 v8, s[12:15], s29 offen offset:0 lds
    buffer_load_dwordx4 v9, s[12:15], s29 offen offset:1024 lds
    buffer_load_dwordx4 v10, s[12:15], s29 offen offset:2048 lds
    buffer_load_dwordx4 v11, s[12:15], s29 offen offset:3072 lds
    s_add_u32 m0, s35, 53248
    s_nop 0
    buffer_load_dwordx4 v12, s[12:15], s29 offen offset:0 lds
    buffer_load_dwordx4 v13, s[12:15], s29 offen offset:1024 lds
    s_add_u32 s29, s29, 393216
    s_cmp_lg_u32 s70, 7
    s_cbranch_scc1 skip_help_30
    s_mov_b32 s30, 4325376
    buffer_load_dword v253, v23, s[44:47], s30 offen
skip_help_30:
    s_load_dword s100, s[68:69], 768
    s_load_dword s101, s[68:69], 832
    s_load_dword s100, s[68:69], 896
    s_load_dword s101, s[68:69], 960
    s_load_dword s100, s[68:69], 1024
    s_load_dword s101, s[68:69], 1088
    s_waitcnt vmcnt(10)
    s_barrier
    s_add_u32 m0, s34, 16384
    s_nop 0
    buffer_load_dwordx4 v4, s[8:11], s28 offen offset:0 lds
    buffer_load_dwordx4 v5, s[8:11], s28 offen offset:1024 lds
    buffer_load_dwordx4 v6, s[8:11], s28 offen offset:2048 lds
    buffer_load_dwordx4 v7, s[8:11], s28 offen offset:3072 lds
    s_add_u32 s28, s28, 128
    s_add_u32 m0, s35, 73728
    s_nop 0
    buffer_load_dwordx4 v8, s[12:15], s29 offen offset:0 lds
    buffer_load_dwordx4 v9, s[12:15], s29 offen offset:1024 lds
    buffer_load_dwordx4 v10, s[12:15], s29 offen offset:2048 lds
    buffer_load_dwordx4 v11, s[12:15], s29 offen offset:3072 lds
    s_add_u32 m0, s35, 77824
    s_nop 0
    buffer_load_dwordx4 v12, s[12:15], s29 offen offset:0 lds
    buffer_load_dwordx4 v13, s[12:15], s29 offen offset:1024 lds
    s_add_u32 s29, s29, 393216
    s_cmp_lg_u32 s70, 0
    s_cbranch_scc1 skip_help_31
    s_mov_b32 s30, 4718592
    buffer_load_dword v253, v23, s[44:47], s30 offen
skip_help_31:
    s_load_dword s100, s[68:69], 1152
    s_load_dword s101, s[68:69], 1216
    s_load_dword s100, s[68:69], 1280
    s_load_dword s101, s[68:69], 1344
    s_load_dword s100, s[68:69], 1408
    s_load_dword s101, s[68:69], 1472
    s_waitcnt vmcnt(10)
    s_barrier
    s_add_u32 m0, s34, 32768
    s_nop 0
    buffer_load_dwordx4 v4, s[8:11], s28 offen offset:0 lds
    buffer_load_dwordx4 v5, s[8:11], s28 offen offset:1024 lds
    buffer_load_dwordx4 v6, s[8:11], s28 offen offset:2048 lds
    buffer_load_dwordx4 v7, s[8:11], s28 offen offset:3072 lds
    s_add_u32 s28, s28, 128
    s_add_u32 m0, s35, 98304
    s_nop 0
    buffer_load_dwordx4 v8, s[12:15], s29 offen offset:0 lds
    buffer_load_dwordx4 v9, s[12:15], s29 offen offset:1024 lds
    buffer_load_dwordx4 v10, s[12:15], s29 offen offset:2048 lds
    buffer_load_dwordx4 v11, s[12:15], s29 offen offset:3072 lds
    s_add_u32 m0, s35, 102400
    s_nop 0
    buffer_load_dwordx4 v12, s[12:15], s29 offen offset:0 lds
    buffer_load_dwordx4 v13, s[12:15], s29 offen offset:1024 lds
    s_add_u32 s29, s29, 393216
    s_cmp_lg_u32 s70, 1
    s_cbranch_scc1 skip_help_32
    s_mov_b32 s30, 5111808
    buffer_load_dword v253, v23, s[44:47], s30 offen
skip_help_32:
    s_load_dword s100, s[68:69], 1536
    s_load_dword s101, s[68:69], 1600
    s_load_dword s100, s[68:69], 1664
    s_load_dword s101, s[68:69], 1728
    s_load_dword s100, s[68:69], 1792
    s_load_dword s101, s[68:69], 1856
    s_waitcnt vmcnt(10)
    s_barrier
    s_add_u32 m0, s34, 0
    s_nop 0
    buffer_load_dwordx4 v4, s[8:11], s28 offen offset:0 lds
    buffer_load_dwordx4 v5, s[8:11], s28 offen offset:1024 lds
    buffer_load_dwordx4 v6, s[8:11], s28 offen offset:2048 lds
    buffer_load_dwordx4 v7, s[8:11], s28 offen offset:3072 lds
    s_add_u32 s28, s28, 128
    s_add_u32 m0, s35, 49152
    s_nop 0
    buffer_load_dwordx4 v8, s[12:15], s29 offen offset:0 lds
    buffer_load_dwordx4 v9, s[12:15], s29 offen offset:1024 lds
    buffer_load_dwordx4 v10, s[12:15], s29 offen offset:2048 lds
    buffer_load_dwordx4 v11, s[12:15], s29 offen offset:3072 lds
    s_add_u32 m0, s35, 53248
    s_nop 0
    buffer_load_dwordx4 v12, s[12:15], s29 offen offset:0 lds
    buffer_load_dwordx4 v13, s[12:15], s29 offen offset:1024 lds
    s_add_u32 s29, s29, 393216
    s_cmp_lg_u32 s70, 2
    s_cbranch_scc1 skip_help_33
    s_mov_b32 s30, 5505024
    buffer_load_dword v253, v23, s[44:47], s30 offen
skip_help_33:
    s_load_dword s100, s[68:69], 1920
    s_load_dword s101, s[68:69], 1984
    s_load_dword s100, s[68:69], 2048
    s_load_dword s101, s[68:69], 2112
    s_load_dword s100, s[68:69], 2176
    s_load_dword s101, s[68:69], 2240
    s_waitcnt vmcnt(10)
    s_barrier
    s_add_u32 m0, s34, 16384
    s_nop 0
    buffer_load_dwordx4 v4, s[8:11], s28 offen offset:0 lds
    buffer_load_dwordx4 v5, s[8:11], s28 offen offset:1024 lds
    buffer_load_dwordx4 v6, s[8:11], s28 offen offset:2048 lds
    buffer_load_dwordx4 v7, s[8:11], s28 offen offset:3072 lds
    s_add_u32 s28, s28, 128
    s_add_u32 m0, s35, 73728
    s_nop 0
    buffer_load_dwordx4 v8, s[12:15], s29 offen offset:0 lds
    buffer_load_dwordx4 v9, s[12:15], s29 offen offset:1024 lds
    buffer_load_dwordx4 v10, s[12:15], s29 offen offset:2048 lds
    buffer_load_dwordx4 v11, s[12:15], s29 offen offset:3072 lds
    s_add_u32 m0, s35, 77824
    s_nop 0
    buffer_load_dwordx4 v12, s[12:15], s29 offen offset:0 lds
    buffer_load_dwordx4 v13, s[12:15], s29 offen offset:1024 lds
    s_add_u32 s29, s29, 393216
    s_cmp_lg_u32 s70, 3
    s_cbranch_scc1 skip_help_34
    s_mov_b32 s30, 5898240
    buffer_load_dword v253, v23, s[44:47], s30 offen
skip_help_34:
    s_load_dword s100, s[68:69], 2304
    s_load_dword s101, s[68:69], 2368
    s_load_dword s100, s[68:69], 2432
    s_load_dword s101, s[68:69], 2496
    s_load_dword s100, s[68:69], 2560
    s_load_dword s101, s[68:69], 2624
    s_waitcnt vmcnt(10)
    s_barrier
    s_add_u32 m0, s34, 32768
    s_nop 0
    buffer_load_dwordx4 v4, s[8:11], s28 offen offset:0 lds
    buffer_load_dwordx4 v5, s[8:11], s28 offen offset:1024 lds
    buffer_load_dwordx4 v6, s[8:11], s28 offen offset:2048 lds
    buffer_load_dwordx4 v7, s[8:11], s28 offen offset:3072 lds
    s_add_u32 s28, s28, 128
    s_add_u32 m0, s35, 98304
    s_nop 0
    buffer_load_dwordx4 v8, s[12:15], s29 offen offset:0 lds
    buffer_load_dwordx4 v9, s[12:15], s29 offen offset:1024 lds
    buffer_load_dwordx4 v10, s[12:15], s29 offen offset:2048 lds
    buffer_load_dwordx4 v11, s[12:15], s29 offen offset:3072 lds
    s_add_u32 m0, s35, 102400
    s_nop 0
    buffer_load_dwordx4 v12, s[12:15], s29 offen offset:0 lds
    buffer_load_dwordx4 v13, s[12:15], s29 offen offset:1024 lds
    s_add_u32 s29, s29, 393216
    s_add_u32 s16, s4, 44040192
    s_addc_u32 s17, s5, 0
    s_mov_b32 s18, 524288
    s_mov_b32 s19, 0x20000
    s_min_u32 s31, s38, 2
    s_lshl_b32 s60, s31, 13
    s_lshl_b32 s31, s25, 9
    s_add_u32 s60, s60, s31
    s_mov_b32 s67, 32768
    v_lshlrev_b32 v24, 3, v1
    s_add_u32 s20, s4, 42991616
    s_addc_u32 s21, s5, 0
    s_mov_b32 s22, 32768
    s_mov_b32 s23, 0x20000
    v_and_b32 v25, 31, v1
    v_lshlrev_b32 v25, 4, v25
    s_lshl_b32 s61, s24, 11
    s_lshl_b32 s31, s38, 9
    s_add_u32 s61, s61, s31
    s_load_dword s100, s[68:69], 2688
    s_load_dword s101, s[68:69], 2752
    s_load_dword s100, s[68:69], 2816
    s_load_dword s101, s[68:69], 2880
    s_load_dword s100, s[68:69], 2944
    s_load_dword s101, s[68:69], 3008
    s_waitcnt vmcnt(10)
    s_barrier
    s_add_u32 m0, s34, 0
    s_nop 0
    buffer_load_dwordx4 v4, s[8:11], s28 offen offset:0 lds
    buffer_load_dwordx4 v5, s[8:11], s28 offen offset:1024 lds
    buffer_load_dwordx4 v6, s[8:11], s28 offen offset:2048 lds
    buffer_load_dwordx4 v7, s[8:11], s28 offen offset:3072 lds
    s_add_u32 s28, s28, 128
    s_add_u32 m0, s35, 49152
    s_nop 0
    buffer_load_dwordx4 v8, s[12:15], s29 offen offset:0 lds
    buffer_load_dwordx4 v9, s[12:15], s29 offen offset:1024 lds
    buffer_load_dwordx4 v10, s[12:15], s29 offen offset:2048 lds
    buffer_load_dwordx4 v11, s[12:15], s29 offen offset:3072 lds
    s_add_u32 m0, s35, 53248
    s_nop 0
    buffer_load_dwordx4 v12, s[12:15], s29 offen offset:0 lds
    buffer_load_dwordx4 v13, s[12:15], s29 offen offset:1024 lds
    s_add_u32 s29, s29, 393216
    s_waitcnt vmcnt(10)
    s_barrier
    buffer_load_dwordx4 v[64:67], v25, s[20:23], s61 offen sc0 sc1
    buffer_load_dwordx2 v[32:33], v24, s[16:19], s60 offen sc0 sc1
    s_add_u32 s60, s60, s67
    buffer_load_dwordx2 v[34:35], v24, s[16:19], s60 offen sc0 sc1
    s_add_u32 s60, s60, s67
    buffer_load_dwordx2 v[36:37], v24, s[16:19], s60 offen sc0 sc1
    s_add_u32 s60, s60, s67
    buffer_load_dwordx2 v[38:39], v24, s[16:19], s60 offen sc0 sc1
    s_add_u32 s60, s60, s67
    buffer_load_dwordx2 v[40:41], v24, s[16:19], s60 offen sc0 sc1
    s_add_u32 s60, s60, s67
    buffer_load_dwordx2 v[42:43], v24, s[16:19], s60 offen sc0 sc1
    s_add_u32 s60, s60, s67
    buffer_load_dwordx2 v[44:45], v24, s[16:19], s60 offen sc0 sc1
    s_add_u32 s60, s60, s67
    buffer_load_dwordx2 v[46:47], v24, s[16:19], s60 offen sc0 sc1
    s_add_u32 s60, s60, s67
    buffer_load_dwordx2 v[48:49], v24, s[16:19], s60 offen sc0 sc1
    s_add_u32 s60, s60, s67
    buffer_load_dwordx2 v[50:51], v24, s[16:19], s60 offen sc0 sc1
    s_add_u32 s60, s60, s67
    buffer_load_dwordx2 v[52:53], v24, s[16:19], s60 offen sc0 sc1
    s_add_u32 s60, s60, s67
    buffer_load_dwordx2 v[54:55], v24, s[16:19], s60 offen sc0 sc1
    s_add_u32 s60, s60, s67
    buffer_load_dwordx2 v[56:57], v24, s[16:19], s60 offen sc0 sc1
    s_add_u32 s60, s60, s67
    buffer_load_dwordx2 v[58:59], v24, s[16:19], s60 offen sc0 sc1
    s_add_u32 s60, s60, s67
    buffer_load_dwordx2 v[60:61], v24, s[16:19], s60 offen sc0 sc1
    s_add_u32 s60, s60, s67
    buffer_load_dwordx2 v[62:63], v24, s[16:19], s60 offen sc0 sc1
    s_add_u32 s60, s60, s67
    s_waitcnt vmcnt(17)
    s_barrier
    s_waitcnt vmcnt(0)
    s_setprio 3
    s_mov_b32 s62, 0x40000
gchk_35:
    v_xor_b32 v15, s72, v33
    v_xor_b32 v27, s72, v35
    v_or_b32 v15, v15, v27
    v_xor_b32 v27, s72, v37
    v_or_b32 v15, v15, v27
    v_xor_b32 v27, s72, v39
    v_or_b32 v15, v15, v27
    v_xor_b32 v27, s72, v41
    v_or_b32 v15, v15, v27
    v_xor_b32 v27, s72, v43
    v_or_b32 v15, v15, v27
    v_xor_b32 v27, s72, v45
    v_or_b32 v15, v15, v27
    v_xor_b32 v27, s72, v47
    v_or_b32 v15, v15, v27
    v_xor_b32 v27, s72, v49
    v_or_b32 v15, v15, v27
    v_xor_b32 v27, s72, v51
    v_or_b32 v15, v15, v27
    v_xor_b32 v27, s72, v53
    v_or_b32 v15, v15, v27
    v_xor_b32 v27, s72, v55
    v_or_b32 v15, v15, v27
    v_xor_b32 v27, s72, v57
    v_or_b32 v15, v15, v27
    v_xor_b32 v27, s72, v59
    v_or_b32 v15, v15, v27
    v_xor_b32 v27, s72, v61
    v_or_b32 v15, v15, v27
    v_xor_b32 v27, s72, v63
    v_or_b32 v15, v15, v27
    v_xor_b32 v27, s72, v66
    v_or_b32 v15, v15, v27
    v_xor_b32 v27, s73, v67
    v_or_b32 v15, v15, v27
    v_cmp_ne_u32 vcc, 0, v15
    s_nop 3
    s_cmp_eq_u64 vcc, 0
    s_cbranch_scc1 skip_gok_36
    s_sub_u32 s62, s62, 1
    s_cbranch_scc1 skip_gok_36
    s_sleep 2
    s_add_u32 s16, s4, 44040192
    s_addc_u32 s17, s5, 0
    s_mov_b32 s18, 524288
    s_mov_b32 s19, 0x20000
    s_min_u32 s31, s38, 2
    s_lshl_b32 s60, s31, 13
    s_lshl_b32 s31, s25, 9
    s_add_u32 s60, s60, s31
    s_mov_b32 s67, 32768
    v_lshlrev_b32 v24, 3, v1
    buffer_load_dwordx2 v[32:33], v24, s[16:19], s60 offen sc0 sc1
    s_add_u32 s60, s60, s67
    buffer_load_dwordx2 v[34:35], v24, s[16:19], s60 offen sc0 sc1
    s_add_u32 s60, s60, s67
    buffer_load_dwordx2 v[36:37], v24, s[16:19], s60 offen sc0 sc1
    s_add_u32 s60, s60, s67
    buffer_load_dwordx2 v[38:39], v24, s[16:19], s60 offen sc0 sc1
    s_add_u32 s60, s60, s67
    buffer_load_dwordx2 v[40:41], v24, s[16:19], s60 offen sc0 sc1
    s_add_u32 s60, s60, s67
    buffer_load_dwordx2 v[42:43], v24, s[16:19], s60 offen sc0 sc1
    s_add_u32 s60, s60, s67
    buffer_load_dwordx2 v[44:45], v24, s[16:19], s60 offen sc0 sc1
    s_add_u32 s60, s60, s67
    buffer_load_dwordx2 v[46:47], v24, s[16:19], s60 offen sc0 sc1
    s_add_u32 s60, s60, s67
    buffer_load_dwordx2 v[48:49], v24, s[16:19], s60 offen sc0 sc1
    s_add_u32 s60, s60, s67
    buffer_load_dwordx2 v[50:51], v24, s[16:19], s60 offen sc0 sc1
    s_add_u32 s60, s60, s67
    buffer_load_dwordx2 v[52:53], v24, s[16:19], s60 offen sc0 sc1
    s_add_u32 s60, s60, s67
    buffer_load_dwordx2 v[54:55], v24, s[16:19], s60 offen sc0 sc1
    s_add_u32 s60, s60, s67
    buffer_load_dwordx2 v[56:57], v24, s[16:19], s60 offen sc0 sc1
    s_add_u32 s60, s60, s67
    buffer_load_dwordx2 v[58:59], v24, s[16:19], s60 offen sc0 sc1
    s_add_u32 s60, s60, s67
    buffer_load_dwordx2 v[60:61], v24, s[16:19], s60 offen sc0 sc1
    s_add_u32 s60, s60, s67
    buffer_load_dwordx2 v[62:63], v24, s[16:19], s60 offen sc0 sc1
    s_add_u32 s60, s60, s67
    buffer_load_dwordx4 v[64:67], v25, s[20:23], s61 offen sc0 sc1
    s_waitcnt vmcnt(0)
    s_branch gchk_35
skip_gok_36:
    v_add_f32 v32, v32, v34
    v_add_f32 v32, v32, v36
    v_add_f32 v32, v32, v38
    v_add_f32 v32, v32, v40
    v_add_f32 v32, v32, v42
    v_add_f32 v32, v32, v44
    v_add_f32 v32, v32, v46
    v_add_f32 v32, v32, v48
    v_add_f32 v32, v32, v50
    v_add_f32 v32, v32, v52
    v_add_f32 v32, v32, v54
    v_add_f32 v32, v32, v56
    v_add_f32 v32, v32, v58
    v_add_f32 v32, v32, v60
    v_add_f32 v32, v32, v62
    v_lshlrev_b32 v2, 2, v1
    s_lshl_b32 s30, s38, 8
    s_add_u32 s30, s30, 158720
    v_add_u32 v2, s30, v2
    ds_write_b32 v2, v32
    s_setprio 0
    s_setprio 3
    v_and_b32 v3, 31, v1
    s_lshl_b32 s30, s38, 5
    v_add_u32 v3, s30, v3
    v_lshlrev_b32 v2, 4, v3
    v_add_u32 v2, 155648, v2
    v_lshlrev_b32 v3, 2, v3
    v_add_u32 v3, 157696, v3
    ds_write_b128 v2, v[64:67]
    ds_write_b32 v3, v64
    ds_write_b32 v3, v65 offset:512
    s_waitcnt lgkmcnt(0)
    s_setprio 0
    s_barrier
    v_mov_b32 v28, v4
    v_mov_b32 v29, v5
    v_mov_b32 v30, v6
    v_mov_b32 v31, v7
    s_mov_b32 s48, s8
    s_mov_b32 s49, s9
    s_mov_b32 s50, s10
    s_mov_b32 s51, 0x20000
    s_sub_u32 s30, s24, 1
    s_max_i32 s30, s30, 0
    s_sub_u32 s31, s24, 2
    s_max_i32 s31, s31, 0
    s_sub_u32 s30, s30, s31
    s_lshl_b32 s30, s30, 11
    v_bfe_u32 v2, v1, 2, 1
    v_mul_lo_u32 v2, v2, s30
    v_and_b32 v3, 3, v1
    v_lshl_add_u32 v2, v3, 3, v2
    s_lshl_b32 s31, s31, 11
    s_lshl_b32 s30, s25, 7
    s_add_u32 s33, s30, s31
    s_add_u32 s33, s33, 65536
    s_lshr_b32 s34, s38, 1
    s_and_b32 s35, s38, 1
    s_lshl_b32 s30, s25, 1
    s_add_u32 s30, s30, s34
    s_lshl_b32 s30, s30, 17
    s_lshl_b32 s31, s35, 22
    s_add_u32 s30, s30, s31
    s_add_u32 s30, s30, 8388608
    s_add_u32 s8, s4, s30
    s_addc_u32 s9, s5, 0
    s_mov_b32 s10, 131072
    s_mov_b32 s11, 0x20000
    s_lshl_b32 s30, s24, 13
    s_sub_u32 s30, s30, 16384
    v_lshlrev_b32 v4, 4, v1
    v_add_u32 v4, s30, v4
    s_mul_i32 s34, s34, 57344
    s_mul_i32 s35, s35, 24576
    s_add_u32 s34, s34, s35
    v_mov_b32 v5, v2
    s_mul_i32 s30, s25, 448
    s_sub_u32 s31, 7340032, s30
    s_add_u32 s20, s88, s30
    s_addc_u32 s21, s89, 0
    s_mov_b32 s22, s31
    s_mov_b32 s23, 0x20000
    s_mul_i32 s30, s38, 448
    s_mov_b32 s36, 7168
    s_add_u32 s31, s30, 0
    v_add_u32 v3, s31, v1
    v_mul_u32_u24 v2, 2341, v3
    v_lshrrev_b32 v2, 16, v2
    v_mul_u32_u24 v15, 28, v2
    v_sub_u32 v3, v3, v15
    v_bfe_u32 v15, v2, 2, 1
    v_lshlrev_b32 v15, 1, v15
    v_xor_b32 v3, v3, v15
    v_mul_lo_u32 v2, v2, s36
    v_lshl_add_u32 v16, v3, 4, v2
    s_add_u32 s31, s30, 64
    v_add_u32 v3, s31, v1
    v_mul_u32_u24 v2, 2341, v3
    v_lshrrev_b32 v2, 16, v2
    v_mul_u32_u24 v15, 28, v2
    v_sub_u32 v3, v3, v15
    v_bfe_u32 v15, v2, 2, 1
    v_lshlrev_b32 v15, 1, v15
    v_xor_b32 v3, v3, v15
    v_mul_lo_u32 v2, v2, s36
    v_lshl_add_u32 v17, v3, 4, v2
    v_subrev_u32 v17, 1024, v17
    s_add_u32 s31, s30, 128
    v_add_u32 v3, s31, v1
    v_mul_u32_u24 v2, 2341, v3
    v_lshrrev_b32 v2, 16, v2
    v_mul_u32_u24 v15, 28, v2
    v_sub_u32 v3, v3, v15
    v_bfe_u32 v15, v2, 2, 1
    v_lshlrev_b32 v15, 1, v15
    v_xor_b32 v3, v3, v15
    v_mul_lo_u32 v2, v2, s36
    v_lshl_add_u32 v18, v3, 4, v2
    v_subrev_u32 v18, 2048, v18
    s_add_u32 s31, s30, 192
    v_add_u32 v3, s31, v1
    v_mul_u32_u24 v2, 2341, v3
    v_lshrrev_b32 v2, 16, v2
    v_mul_u32_u24 v15, 28, v2
    v_sub_u32 v3, v3, v15
    v_bfe_u32 v15, v2, 2, 1
    v_lshlrev_b32 v15, 1, v15
    v_xor_b32 v3, v3, v15
    v_mul_lo_u32 v2, v2, s36
    v_lshl_add_u32 v19, v3, 4, v2
    v_subrev_u32 v19, 3072, v19
    s_add_u32 s31, s30, 256
    v_add_u32 v3, s31, v1
    v_mul_u32_u24 v2, 2341, v3
    v_lshrrev_b32 v2, 16, v2
    v_mul_u32_u24 v15, 28, v2
    v_sub_u32 v3, v3, v15
    v_bfe_u32 v15, v2, 2, 1
    v_lshlrev_b32 v15, 1, v15
    v_xor_b32 v3, v3, v15
    v_mul_lo_u32 v2, v2, s36
    v_lshl_add_u32 v20, v3, 4, v2
    s_add_u32 s31, s30, 320
    v_add_u32 v3, s31, v1
    v_mul_u32_u24 v2, 2341, v3
    v_lshrrev_b32 v2, 16, v2
    v_mul_u32_u24 v15, 28, v2
    v_sub_u32 v3, v3, v15
    v_bfe_u32 v15, v2, 2, 1
    v_lshlrev_b32 v15, 1, v15
    v_xor_b32 v3, v3, v15
    v_mul_lo_u32 v2, v2, s36
    v_lshl_add_u32 v21, v3, 4, v2
    v_subrev_u32 v21, 1024, v21
    s_add_u32 s31, s30, 384
    v_add_u32 v3, s31, v1
    v_mul_u32_u24 v2, 2341, v3
    v_lshrrev_b32 v2, 16, v2
    v_mul_u32_u24 v15, 28, v2
    v_sub_u32 v3, v3, v15
    v_bfe_u32 v15, v2, 2, 1
    v_lshlrev_b32 v15, 1, v15
    v_xor_b32 v3, v3, v15
    v_mul_lo_u32 v2, v2, s36
    v_lshl_add_u32 v22, v3, 4, v2
    v_subrev_u32 v22, 2048, v22
    s_mov_b32 s39, 0x100000
poll_37:
    buffer_load_dwordx2 v[32:33], v5, s[76:79], s33 offen sc0 sc1
    s_waitcnt vmcnt(0)
    v_cmp_eq_u64 vcc, s[72:73], v[32:33]
    s_nop 3
    s_cmp_eq_u64 vcc, -1
    s_cbranch_scc1 polld_38
    s_sleep 1
    s_sub_u32 s39, s39, 1
    s_cmp_lg_u32 s39, 0
    s_cbranch_scc1 poll_37
polld_38:
    s_add_u32 m0, s34, 0
    s_nop 0
    buffer_load_dwordx4 v4, s[8:11], 0 offen offset:0 sc1 lds
    buffer_load_dwordx4 v4, s[8:11], 0 offen offset:1024 sc1 lds
    buffer_load_dwordx4 v4, s[8:11], 0 offen offset:2048 sc1 lds
    buffer_load_dwordx4 v4, s[8:11], 0 offen offset:3072 sc1 lds
    v_add_u32 v4, 0x1000, v4
    s_add_u32 m0, s34, 4096
    s_nop 0
    buffer_load_dwordx4 v4, s[8:11], 0 offen offset:0 sc1 lds
    buffer_load_dwordx4 v4, s[8:11], 0 offen offset:1024 sc1 lds
    buffer_load_dwordx4 v4, s[8:11], 0 offen offset:2048 sc1 lds
    buffer_load_dwordx4 v4, s[8:11], 0 offen offset:3072 sc1 lds
    v_add_u32 v4, 0x1000, v4
    s_add_u32 m0, s34, 8192
    s_nop 0
    buffer_load_dwordx4 v4, s[8:11], 0 offen offset:0 sc1 lds
    buffer_load_dwordx4 v4, s[8:11], 0 offen offset:1024 sc1 lds
    buffer_load_dwordx4 v4, s[8:11], 0 offen offset:2048 sc1 lds
    buffer_load_dwordx4 v4, s[8:11], 0 offen offset:3072 sc1 lds
    v_add_u32 v4, 0x1000, v4
    s_add_u32 m0, s34, 12288
    s_nop 0
    buffer_load_dwordx4 v4, s[8:11], 0 offen offset:0 sc1 lds
    buffer_load_dwordx4 v4, s[8:11], 0 offen offset:1024 sc1 lds
    buffer_load_dwordx4 v4, s[8:11], 0 offen offset:2048 sc1 lds
    buffer_load_dwordx4 v4, s[8:11], 0 offen offset:3072 sc1 lds
    s_mov_b32 s98, s24
    s_mov_b32 s99, s25
    s_and_b32 s30, s2, 7
    s_lshr_b32 s31, s2, 3
    s_lshr_b32 s24, s30, 2
    s_lshl_b32 s24, s24, 3
    s_and_b32 s25, s30, 3
    s_lshl_b32 s25, s25, 2
    s_lshr_b32 s30, s31, 2
    s_add_u32 s24, s24, s30
    s_and_b32 s30, s31, 3
    s_add_u32 s25, s25, s30
    s_mul_i32 s30, s24, 262144
    s_add_u32 s30, s30, 16777216
    s_add_u32 s8, s4, s30
    s_addc_u32 s9, s5, 0
    s_mov_b32 s10, 262144
    s_mov_b32 s11, 0x20000
    s_and_b32 s30, s38, 3
    s_lshl_b32 s30, s30, 12
    v_lshlrev_b32 v4, 4, v1
    v_add_u32 v4, s30, v4
    s_and_b32 s65, s25, 3
    s_mul_i32 s65, s65, 4
    s_mov_b32 s65, 4
    s_lshl_b32 s34, s38, 12
    s_mul_i32 s35, s38, 2048
    s_mul_i32 s30, s25, 128
    s_sub_u32 s31, 2097152, s30
    s_add_u32 s12, s84, s30
    s_addc_u32 s13, s85, 0
    s_mov_b32 s14, s31
    s_mov_b32 s15, 0x20000
    v_lshrrev_b32 v2, 3, v1
    v_mul_u32_u24 v2, 2048, v2
    v_bfe_u32 v3, v1, 4, 2
    v_lshlrev_b32 v3, 1, v3
    v_and_b32 v15, 7, v1
    v_xor_b32 v3, v3, v15
    v_lshl_add_u32 v2, v3, 4, v2
    s_mul_i32 s36, s38, 2
    s_add_u32 s30, s36, 0
    s_and_b32 s31, s30, 7
    s_mul_i32 s31, s31, 16384
    v_add_u32 v8, s31, v2
    s_add_u32 s30, s36, 1
    s_and_b32 s31, s30, 7
    s_mul_i32 s31, s31, 16384
    s_sub_u32 s31, s31, 1024
    v_add_u32 v9, s31, v2
    s_mov_b32 s27, 0
    s_mov_b32 s32, 114688
    s_mul_i32 s28, s65, 16384
    s_mul_i32 s29, s65, 131072
    s_mov_b32 s24, s98
    s_mov_b32 s25, s99
    s_add_u32 s16, s84, 0
    s_addc_u32 s17, s85, 0
    s_mov_b32 s18, 2097152
    s_mov_b32 s19, 0x20000
    v_lshrrev_b32 v2, 2, v1
    v_lshlrev_b32 v2, 11, v2
    v_and_b32 v3, 3, v1
    v_lshl_add_u32 v2, v3, 7, v2
    s_and_b32 s30, s2, 3
    s_lshl_b32 s30, s30, 9
    s_lshl_b32 s31, s38, 14
    s_add_u32 s30, s30, s31
    v_add_u32 v2, s30, v2
    v_mov_b32 v3, 0x40000000
    v_cmp_gt_u32 vcc, 32, v1
    s_nop 1
    v_cndmask_b32 v25, v3, v2, vcc
    s_lshr_b32 s37, s2, 3
    s_lshl_b32 s37, s37, 16
    s_waitcnt vmcnt(0)
    s_barrier
    s_add_u32 m0, s34, 147456
    s_lshl_b32 s30, s25, 7
    buffer_load_dwordx4 v28, s[48:51], s30 offen offset:0 lds
    buffer_load_dwordx4 v29, s[48:51], s30 offen offset:1024 lds
    buffer_load_dwordx4 v30, s[48:51], s30 offen offset:2048 lds
    buffer_load_dwordx4 v31, s[48:51], s30 offen offset:3072 lds
    s_add_u32 m0, s35, 114688
    s_nop 0
    buffer_load_dwordx4 v8, s[12:15], s29 offen offset:0 lds
    buffer_load_dwordx4 v9, s[12:15], s29 offen offset:1024 lds
    s_add_u32 s29, s29, 131072
    s_cmp_eq_u32 s29, 2097152
    s_cselect_b32 s29, 0, s29
    s_add_u32 m0, s35, 122880
    s_nop 0
    buffer_load_dwordx4 v8, s[12:15], s29 offen offset:0 lds
    buffer_load_dwordx4 v9, s[12:15], s29 offen offset:1024 lds
    s_add_u32 s29, s29, 131072
    s_cmp_eq_u32 s29, 2097152
    s_cselect_b32 s29, 0, s29
    s_add_u32 m0, s35, 131072
    s_nop 0
    buffer_load_dwordx4 v8, s[12:15], s29 offen offset:0 lds
    buffer_load_dwordx4 v9, s[12:15], s29 offen offset:1024 lds
    s_add_u32 s29, s29, 131072
    s_cmp_eq_u32 s29, 2097152
    s_cselect_b32 s29, 0, s29
    s_add_u32 m0, s35, 139264
    s_nop 0
    buffer_load_dwordx4 v8, s[12:15], s29 offen offset:0 lds
    buffer_load_dwordx4 v9, s[12:15], s29 offen offset:1024 lds
    s_add_u32 s29, s29, 131072
    s_cmp_eq_u32 s29, 2097152
    s_cselect_b32 s29, 0, s29
    buffer_load_dword v253, v25, s[16:19], s37 offen
    s_branch L_attn
L_cons:
    s_or_b32 s30, s2, s3
    s_cmp_lg_u32 s30, 0
    s_cbranch_scc1 L_notag
    s_add_u32 s16, s94, 0
    s_addc_u32 s17, s95, 0
    s_mov_b32 s18, 256
    s_mov_b32 s19, 0x20000
    s_memrealtime s[30:31]
    v_mov_b32 v4, 0
    s_waitcnt lgkmcnt(0)
    s_or_b32 s30, s30, 1
    v_mov_b32 v2, s30
    v_mov_b32 v3, s31
    s_mov_b64 exec, 1
    buffer_store_dwordx2 v[2:3], v4, s[16:19], 0 offen sc0 sc1
    s_mov_b64 exec, -1
L_notag:
    s_getpc_b64 s[30:31]
Lpc_1:
    s_sub_u32 s30, s30, Lpc_1-sequential_preLN__sliding_block__dense_activation_silu__prompt_kernel
    s_subb_u32 s31, s31, 0
    s_lshr_b32 s36, s2, 3
    s_lshl_b32 s36, s36, 11
    s_lshl_b32 s37, s3, 9
    s_add_u32 s36, s36, s37
    v_lshlrev_b32 v14, 7, v1
    v_add_u32 v14, s36, v14
    v_mov_b32 v15, L_code_end-sequential_preLN__sliding_block__dense_activation_silu__prompt_kernel
    v_cmp_gt_u32 vcc, 4, v1
    s_nop 1
    v_cndmask_b32 v15, 0, v15, vcc
    v_cmp_lt_u32 s[36:37], v14, v15
    v_mov_b32 v15, s31
    v_add_co_u32 v14, vcc, s30, v14
    s_nop 1
    v_addc_co_u32 v15, vcc, 0, v15, vcc
    s_and_saveexec_b64 s[30:31], s[36:37]
    s_cbranch_execz skip_cpf_2
    global_load_dword v253, v[14:15], off
skip_cpf_2:
    s_mov_b64 exec, -1
    s_and_b32 s30, s2, 7
    s_lshr_b32 s31, s2, 3
    s_lshr_b32 s24, s30, 2
    s_lshl_b32 s24, s24, 3
    s_and_b32 s25, s30, 3
    s_lshl_b32 s25, s25, 2
    s_lshr_b32 s30, s31, 2
    s_add_u32 s24, s24, s30
    s_and_b32 s30, s31, 3
    s_add_u32 s25, s25, s30
    s_add_u32 s20, s80, 0
    s_addc_u32 s21, s81, 0
    s_mov_b32 s22, 4194304
    s_mov_b32 s23, 0x20000
    s_add_u32 s16, s94, 0
    s_addc_u32 s17, s95, 0
    s_mov_b32 s18, 256
    s_mov_b32 s19, 0x20000
    s_lshl_b32 s30, s24, 7
    s_lshl_b32 s31, s25, 3
    s_add_u32 s30, s30, s31
    s_lshl_b32 s31, s3, 1
    s_add_u32 s33, s30, s31
    s_lshl_b32 s30, s33, 11
    v_lshlrev_b32 v170, 4, v1
    v_mov_b32 v171, 0
    buffer_load_dwordx4 v[152:155], v170, s[20:23], s30 offen offset:0
    buffer_load_dwordx4 v[156:159], v170, s[20:23], s30 offen offset:1024
    buffer_load_dwordx4 v[160:163], v170, s[20:23], s30 offen offset:2048
    buffer_load_dwordx4 v[164:167], v170, s[20:23], s30 offen offset:3072
    s_lshr_b32 s34, s3, 1
    s_and_b32 s35, s3, 1
    v_lshlrev_b32 v13, 4, v1
    s_lshl_b32 s30, s34, 12
    v_add_u32 v13, s30, v13
    v_lshrrev_b32 v12, 4, v1
    v_bfe_u32 v112, v1, 2, 2
    v_and_b32 v113, 3, v1
    v_and_b32 v14, 15, v1
    v_lshrrev_b32 v15, 1, v14
    v_xor_b32 v15, v15, v12
    v_lshlrev_b32 v15, 4, v15
    v_lshl_add_u32 v2, v14, 7, v15
    s_lshl_b32 s30, s34, 13
    v_add_u32 v2, s30, v2
    v_xor_b32 v3, 64, v2
    v_mul_u32_u24 v14, 8, v12
    v_add_u32 v14, v14, v112
    v_lshlrev_b32 v14, 7, v14
    v_lshl_add_u32 v14, v113, 3, v14
    v_lshrrev_b32 v15, 1, v112
    v_and_b32 v114, 1, v12
    v_lshl_or_b32 v15, v114, 1, v15
    s_lshl_b32 s30, s35, 1
    v_xor_b32 v15, s30, v15
    v_lshl_add_u32 v4, v15, 5, v14
    v_xor_b32 v15, 1, v15
    v_lshl_add_u32 v5, v15, 5, v14
    v_mov_b32 v16, 0
    v_mov_b32 v17, 0
    v_mov_b32 v18, 0
    v_mov_b32 v19, 0
    v_mov_b32 v20, 0
    v_mov_b32 v21, 0
    v_mov_b32 v22, 0
    v_mov_b32 v23, 0
    v_mov_b32 v24, 0
    v_mov_b32 v25, 0
    v_mov_b32 v26, 0
    v_mov_b32 v27, 0
    v_mov_b32 v28, 0
    v_mov_b32 v29, 0
    v_mov_b32 v30, 0
    v_mov_b32 v31, 0
    v_mov_b32 v32, 0
    v_mov_b32 v33, 0
    v_mov_b32 v34, 0
    v_mov_b32 v35, 0
    v_mov_b32 v36, 0
    v_mov_b32 v37, 0
    v_mov_b32 v38, 0
    v_mov_b32 v39, 0
    v_mov_b32 v40, 0
    v_mov_b32 v41, 0
    v_mov_b32 v42, 0
    v_mov_b32 v43, 0
    v_mov_b32 v44, 0
    v_mov_b32 v45, 0
    v_mov_b32 v46, 0
    v_mov_b32 v47, 0
    v_mov_b32 v48, 0
    v_mov_b32 v49, 0
    v_mov_b32 v50, 0
    v_mov_b32 v51, 0
    v_mov_b32 v52, 0
    v_mov_b32 v53, 0
    v_mov_b32 v54, 0
    v_mov_b32 v55, 0
    v_mov_b32 v56, 0
    v_mov_b32 v57, 0
    v_mov_b32 v58, 0
    v_mov_b32 v59, 0
    v_mov_b32 v60, 0
    v_mov_b32 v61, 0
    v_mov_b32 v62, 0
    v_mov_b32 v63, 0
    v_mov_b32 v64, 0
    v_mov_b32 v65, 0
    v_mov_b32 v66, 0
    v_mov_b32 v67, 0
    v_mov_b32 v68, 0
    v_mov_b32 v69, 0
    v_mov_b32 v70, 0
    v_mov_b32 v71, 0
    v_mov_b32 v72, 0
    v_mov_b32 v73, 0
    v_mov_b32 v74, 0
    v_mov_b32 v75, 0
    v_mov_b32 v76, 0
    v_mov_b32 v77, 0
    v_mov_b32 v78, 0
    v_mov_b32 v79, 0
    v_mov_b32 v80, 0
    v_mov_b32 v81, 0
    v_mov_b32 v82, 0
    v_mov_b32 v83, 0
    v_mov_b32 v84, 0
    v_mov_b32 v85, 0
    v_mov_b32 v86, 0
    v_mov_b32 v87, 0
    v_mov_b32 v88, 0
    v_mov_b32 v89, 0
    v_mov_b32 v90, 0
    v_mov_b32 v91, 0
    v_mov_b32 v92, 0
    v_mov_b32 v93, 0
    v_mov_b32 v94, 0
    v_mov_b32 v95, 0
    v_mov_b32 v96, 0
    v_mov_b32 v97, 0
    v_mov_b32 v98, 0
    v_mov_b32 v99, 0
    v_mov_b32 v100, 0
    v_mov_b32 v101, 0
    v_mov_b32 v102, 0
    v_mov_b32 v103, 0
    v_mov_b32 v104, 0
    v_mov_b32 v105, 0
    v_mov_b32 v106, 0
    v_mov_b32 v107, 0
    v_mov_b32 v108, 0
    v_mov_b32 v109, 0
    v_mov_b32 v110, 0
    v_mov_b32 v111, 0
    s_mov_b32 s27, 0
    s_mov_b32 s32, 49152
    v_add_u32 v7, s27, v2
    v_add_u32 v8, s27, v3
    v_add_u32 v9, s32, v4
    v_add_u32 v10, s32, v5
    s_mov_b32 s26, 15
    buffer_load_dwordx2 v[168:169], v171, s[16:19], 0 offen sc0 sc1
    s_mov_b32 s75, 0x3f803f80
    v_mov_b32 v112, 0
    v_mov_b32 v113, 0
    v_mov_b32 v114, 0
    v_mov_b32 v115, 0
    s_waitcnt vmcnt(1)
    v_dot2c_f32_bf16 v112, s75, v152
    v_dot2c_f32_bf16 v113, v152, v152
    v_dot2c_f32_bf16 v114, s75, v160
    v_dot2c_f32_bf16 v115, v160, v160
    v_dot2c_f32_bf16 v112, s75, v153
    v_dot2c_f32_bf16 v113, v153, v153
    v_dot2c_f32_bf16 v114, s75, v161
    v_dot2c_f32_bf16 v115, v161, v161
    v_dot2c_f32_bf16 v112, s75, v154
    v_dot2c_f32_bf16 v113, v154, v154
    v_dot2c_f32_bf16 v114, s75, v162
    v_dot2c_f32_bf16 v115, v162, v162
    v_dot2c_f32_bf16 v112, s75, v155
    v_dot2c_f32_bf16 v113, v155, v155
    v_dot2c_f32_bf16 v114, s75, v163
    v_dot2c_f32_bf16 v115, v163, v163
    v_dot2c_f32_bf16 v112, s75, v156
    v_dot2c_f32_bf16 v113, v156, v156
    v_dot2c_f32_bf16 v114, s75, v164
    v_dot2c_f32_bf16 v115, v164, v164
    v_dot2c_f32_bf16 v112, s75, v157
    v_dot2c_f32_bf16 v113, v157, v157
    v_dot2c_f32_bf16 v114, s75, v165
    v_dot2c_f32_bf16 v115, v165, v165
    v_dot2c_f32_bf16 v112, s75, v158
    v_dot2c_f32_bf16 v113, v158, v158
    v_dot2c_f32_bf16 v114, s75, v166
    v_dot2c_f32_bf16 v115, v166, v166
    v_dot2c_f32_bf16 v112, s75, v159
    v_dot2c_f32_bf16 v113, v159, v159
    v_dot2c_f32_bf16 v114, s75, v167
    v_dot2c_f32_bf16 v115, v167, v167
    s_nop 0
    v_permlane32_swap_b32 v112, v113
    s_nop 0
    v_permlane32_swap_b32 v114, v115
    v_add_f32 v112, v112, v113
    v_add_f32 v114, v114, v115
    s_nop 1
    v_permlane16_swap_b32 v112, v114
    v_add_f32 v112, v112, v114
    s_nop 1
    v_add_f32_dpp v112, v112, v112 quad_perm:[1,0,3,2] row_mask:0xf bank_mask:0xf
    s_nop 1
    v_add_f32_dpp v112, v112, v112 quad_perm:[2,3,0,1] row_mask:0xf bank_mask:0xf
    s_nop 1
    v_add_f32_dpp v112, v112, v112 row_half_mirror row_mask:0xf bank_mask:0xf
    s_nop 1
    v_add_f32_dpp v112, v112, v112 row_mirror row_mask:0xf bank_mask:0xf
    v_mov_b32 v113, v112
    s_nop 1
    v_permlane32_swap_b32 v112, v113
    v_mul_f32 v112, 0x3a800000, v112
    v_mul_f32 v113, 0x3a800000, v113
    v_fma_f32 v113, -v112, v112, v113
    v_max_f32 v113, 0, v113
    v_add_f32 v113, 0x3727c5ac, v113
    v_rsq_f32 v113, v113
    s_mov_b32 s39, 0x100000
tagp_4:
    s_waitcnt vmcnt(0)
    v_readfirstlane_b32 s72, v168
    v_readfirstlane_b32 s73, v169
    s_nop 3
    s_cmp_lg_u32 s72, 0
    s_cbranch_scc1 tagd_5
    s_sleep 1
    buffer_load_dwordx2 v[168:169], v171, s[16:19], 0 offen sc0 sc1
    s_sub_u32 s39, s39, 1
    s_cmp_lg_u32 s39, 0
    s_cbranch_scc1 tagp_4
tagd_5:
    s_add_u32 s20, s4, 42991616
    s_addc_u32 s21, s5, 0
    s_mov_b32 s22, 32768
    s_mov_b32 s23, 0x20000
    v_mov_b32 v114, s72
    v_mov_b32 v115, s73
    v_and_b32 v116, 16, v1
    s_lshl_b32 s30, s33, 4
    v_mov_b32 v117, 159744
    s_mov_b64 exec, 0x10001
    buffer_store_dwordx4 v[112:115], v116, s[20:23], s30 offen sc0 sc1
    ds_write_b64 v117, v[114:115]
    s_mov_b64 exec, -1
    s_waitcnt lgkmcnt(0)
    s_barrier
    ds_read_b64_tr_b16 v[128:129], v9 offset:0
    ds_read_b64_tr_b16 v[130:131], v9 offset:512
    ds_read_b128 v[112:115], v7 offset:0
    ds_read_b128 v[116:119], v7 offset:2048
    ds_read_b128 v[120:123], v7 offset:4096
    ds_read_b128 v[124:127], v7 offset:6144
    ds_read_b64_tr_b16 v[132:133], v10 offset:0
    ds_read_b64_tr_b16 v[134:135], v10 offset:512
    ds_read_b64_tr_b16 v[136:137], v9 offset:8192
    ds_read_b64_tr_b16 v[138:139], v9 offset:8704
    ds_read_b64_tr_b16 v[140:141], v10 offset:8192
    ds_read_b64_tr_b16 v[142:143], v10 offset:8704
    ds_read_b64_tr_b16 v[144:145], v9 offset:16384
    ds_read_b64_tr_b16 v[146:147], v9 offset:16896
    ds_read_b64_tr_b16 v[148:149], v10 offset:16384
    ds_read_b64_tr_b16 v[150:151], v10 offset:16896
c_loop_3:
    s_waitcnt lgkmcnt(0)
    v_mfma_f32_16x16x32_bf16 v[16:19], v[128:131], v[112:115], v[16:19]
    ds_read_b64_tr_b16 v[168:169], v9 offset:4096
    v_mfma_f32_16x16x32_bf16 v[20:23], v[128:131], v[116:119], v[20:23]
    ds_read_b64_tr_b16 v[170:171], v9 offset:4608
    v_mfma_f32_16x16x32_bf16 v[24:27], v[128:131], v[120:123], v[24:27]
    ds_read_b128 v[152:155], v8 offset:0
    v_mfma_f32_16x16x32_bf16 v[28:31], v[128:131], v[124:127], v[28:31]
    ds_read_b128 v[156:159], v8 offset:2048
    v_mfma_f32_16x16x32_bf16 v[44:47], v[132:135], v[124:127], v[44:47]
    ds_read_b128 v[160:163], v8 offset:4096
    v_mfma_f32_16x16x32_bf16 v[40:43], v[132:135], v[120:123], v[40:43]
    ds_read_b128 v[164:167], v8 offset:6144
    v_mfma_f32_16x16x32_bf16 v[36:39], v[132:135], v[116:119], v[36:39]
    ds_read_b64_tr_b16 v[172:173], v10 offset:4096
    v_mfma_f32_16x16x32_bf16 v[32:35], v[132:135], v[112:115], v[32:35]
    ds_read_b64_tr_b16 v[174:175], v10 offset:4608
    v_mfma_f32_16x16x32_bf16 v[48:51], v[136:139], v[112:115], v[48:51]
    ds_read_b64_tr_b16 v[176:177], v9 offset:12288
    v_mfma_f32_16x16x32_bf16 v[52:55], v[136:139], v[116:119], v[52:55]
    ds_read_b64_tr_b16 v[178:179], v9 offset:12800
    v_mfma_f32_16x16x32_bf16 v[56:59], v[136:139], v[120:123], v[56:59]
    ds_read_b64_tr_b16 v[180:181], v10 offset:12288
    v_mfma_f32_16x16x32_bf16 v[60:63], v[136:139], v[124:127], v[60:63]
    ds_read_b64_tr_b16 v[182:183], v10 offset:12800
    v_mfma_f32_16x16x32_bf16 v[76:79], v[140:143], v[124:127], v[76:79]
    ds_read_b64_tr_b16 v[184:185], v9 offset:20480
    v_mfma_f32_16x16x32_bf16 v[72:75], v[140:143], v[120:123], v[72:75]
    ds_read_b64_tr_b16 v[186:187], v9 offset:20992
    v_mfma_f32_16x16x32_bf16 v[68:71], v[140:143], v[116:119], v[68:71]
    ds_read_b64_tr_b16 v[188:189], v10 offset:20480
    v_mfma_f32_16x16x32_bf16 v[64:67], v[140:143], v[112:115], v[64:67]
    ds_read_b64_tr_b16 v[190:191], v10 offset:20992
    v_mfma_f32_16x16x32_bf16 v[80:83], v[112:115], v[144:147], v[80:83]
    s_add_u32 s27, s27, 16384
    v_mfma_f32_16x16x32_bf16 v[84:87], v[116:119], v[144:147], v[84:87]
    s_add_u32 s32, s32, 24576
    v_mfma_f32_16x16x32_bf16 v[88:91], v[120:123], v[144:147], v[88:91]
    s_cmp_eq_u32 s27, 49152
    v_mfma_f32_16x16x32_bf16 v[92:95], v[124:127], v[144:147], v[92:95]
    s_cselect_b32 s27, 0, s27
    v_mfma_f32_16x16x32_bf16 v[108:111], v[124:127], v[148:151], v[108:111]
    s_cselect_b32 s32, 49152, s32
    v_mfma_f32_16x16x32_bf16 v[104:107], v[120:123], v[148:151], v[104:107]
    v_add_u32 v7, s27, v2
    v_mfma_f32_16x16x32_bf16 v[100:103], v[116:119], v[148:151], v[100:103]
    v_add_u32 v8, s27, v3
    v_mfma_f32_16x16x32_bf16 v[96:99], v[112:115], v[148:151], v[96:99]
    v_add_u32 v9, s32, v4
    v_add_u32 v10, s32, v5
    s_waitcnt lgkmcnt(0)
    s_barrier
    v_mfma_f32_16x16x32_bf16 v[16:19], v[168:171], v[152:155], v[16:19]
    ds_read_b64_tr_b16 v[128:129], v9 offset:0
    v_mfma_f32_16x16x32_bf16 v[20:23], v[168:171], v[156:159], v[20:23]
    ds_read_b64_tr_b16 v[130:131], v9 offset:512
    v_mfma_f32_16x16x32_bf16 v[24:27], v[168:171], v[160:163], v[24:27]
    ds_read_b128 v[112:115], v7 offset:0
    v_mfma_f32_16x16x32_bf16 v[28:31], v[168:171], v[164:167], v[28:31]
    ds_read_b128 v[116:119], v7 offset:2048
    v_mfma_f32_16x16x32_bf16 v[44:47], v[172:175], v[164:167], v[44:47]
    ds_read_b128 v[120:123], v7 offset:4096
    v_mfma_f32_16x16x32_bf16 v[40:43], v[172:175], v[160:163], v[40:43]
    ds_read_b128 v[124:127], v7 offset:6144
    v_mfma_f32_16x16x32_bf16 v[36:39], v[172:175], v[156:159], v[36:39]
    ds_read_b64_tr_b16 v[132:133], v10 offset:0
    v_mfma_f32_16x16x32_bf16 v[32:35], v[172:175], v[152:155], v[32:35]
    ds_read_b64_tr_b16 v[134:135], v10 offset:512
    v_mfma_f32_16x16x32_bf16 v[48:51], v[176:179], v[152:155], v[48:51]
    ds_read_b64_tr_b16 v[136:137], v9 offset:8192
    v_mfma_f32_16x16x32_bf16 v[52:55], v[176:179], v[156:159], v[52:55]
    ds_read_b64_tr_b16 v[138:139], v9 offset:8704
    v_mfma_f32_16x16x32_bf16 v[56:59], v[176:179], v[160:163], v[56:59]
    ds_read_b64_tr_b16 v[140:141], v10 offset:8192
    v_mfma_f32_16x16x32_bf16 v[60:63], v[176:179], v[164:167], v[60:63]
    ds_read_b64_tr_b16 v[142:143], v10 offset:8704
    v_mfma_f32_16x16x32_bf16 v[76:79], v[180:183], v[164:167], v[76:79]
    ds_read_b64_tr_b16 v[144:145], v9 offset:16384
    v_mfma_f32_16x16x32_bf16 v[72:75], v[180:183], v[160:163], v[72:75]
    ds_read_b64_tr_b16 v[146:147], v9 offset:16896
    v_mfma_f32_16x16x32_bf16 v[68:71], v[180:183], v[156:159], v[68:71]
    ds_read_b64_tr_b16 v[148:149], v10 offset:16384
    v_mfma_f32_16x16x32_bf16 v[64:67], v[180:183], v[152:155], v[64:67]
    ds_read_b64_tr_b16 v[150:151], v10 offset:16896
    v_mfma_f32_16x16x32_bf16 v[80:83], v[152:155], v[184:187], v[80:83]
    s_sub_u32 s26, s26, 1
    v_mfma_f32_16x16x32_bf16 v[84:87], v[156:159], v[184:187], v[84:87]
    s_cmp_lg_u32 s26, 0
    v_mfma_f32_16x16x32_bf16 v[88:91], v[160:163], v[184:187], v[88:91]
    v_mfma_f32_16x16x32_bf16 v[92:95], v[164:167], v[184:187], v[92:95]
    v_mfma_f32_16x16x32_bf16 v[108:111], v[164:167], v[188:191], v[108:111]
    v_mfma_f32_16x16x32_bf16 v[104:107], v[160:163], v[188:191], v[104:107]
    v_mfma_f32_16x16x32_bf16 v[100:103], v[156:159], v[188:191], v[100:103]
    v_mfma_f32_16x16x32_bf16 v[96:99], v[152:155], v[188:191], v[96:99]
    s_cbranch_scc1 c_loop_3
    s_waitcnt lgkmcnt(0)
    v_mfma_f32_16x16x32_bf16 v[16:19], v[128:131], v[112:115], v[16:19]
    ds_read_b64_tr_b16 v[168:169], v9 offset:4096
    v_mfma_f32_16x16x32_bf16 v[20:23], v[128:131], v[116:119], v[20:23]
    ds_read_b64_tr_b16 v[170:171], v9 offset:4608
    v_mfma_f32_16x16x32_bf16 v[24:27], v[128:131], v[120:123], v[24:27]
    ds_read_b128 v[152:155], v8 offset:0
    v_mfma_f32_16x16x32_bf16 v[28:31], v[128:131], v[124:127], v[28:31]
    ds_read_b128 v[156:159], v8 offset:2048
    v_mfma_f32_16x16x32_bf16 v[44:47], v[132:135], v[124:127], v[44:47]
    ds_read_b128 v[160:163], v8 offset:4096
    v_mfma_f32_16x16x32_bf16 v[40:43], v[132:135], v[120:123], v[40:43]
    ds_read_b128 v[164:167], v8 offset:6144
    v_mfma_f32_16x16x32_bf16 v[36:39], v[132:135], v[116:119], v[36:39]
    ds_read_b64_tr_b16 v[172:173], v10 offset:4096
    v_mfma_f32_16x16x32_bf16 v[32:35], v[132:135], v[112:115], v[32:35]
    ds_read_b64_tr_b16 v[174:175], v10 offset:4608
    v_mfma_f32_16x16x32_bf16 v[48:51], v[136:139], v[112:115], v[48:51]
    ds_read_b64_tr_b16 v[176:177], v9 offset:12288
    v_mfma_f32_16x16x32_bf16 v[52:55], v[136:139], v[116:119], v[52:55]
    ds_read_b64_tr_b16 v[178:179], v9 offset:12800
    v_mfma_f32_16x16x32_bf16 v[56:59], v[136:139], v[120:123], v[56:59]
    ds_read_b64_tr_b16 v[180:181], v10 offset:12288
    v_mfma_f32_16x16x32_bf16 v[60:63], v[136:139], v[124:127], v[60:63]
    ds_read_b64_tr_b16 v[182:183], v10 offset:12800
    v_mfma_f32_16x16x32_bf16 v[76:79], v[140:143], v[124:127], v[76:79]
    ds_read_b64_tr_b16 v[184:185], v9 offset:20480
    v_mfma_f32_16x16x32_bf16 v[72:75], v[140:143], v[120:123], v[72:75]
    ds_read_b64_tr_b16 v[186:187], v9 offset:20992
    v_mfma_f32_16x16x32_bf16 v[68:71], v[140:143], v[116:119], v[68:71]
    ds_read_b64_tr_b16 v[188:189], v10 offset:20480
    v_mfma_f32_16x16x32_bf16 v[64:67], v[140:143], v[112:115], v[64:67]
    ds_read_b64_tr_b16 v[190:191], v10 offset:20992
    v_mfma_f32_16x16x32_bf16 v[80:83], v[112:115], v[144:147], v[80:83]
    v_mfma_f32_16x16x32_bf16 v[84:87], v[116:119], v[144:147], v[84:87]
    v_mfma_f32_16x16x32_bf16 v[88:91], v[120:123], v[144:147], v[88:91]
    v_mfma_f32_16x16x32_bf16 v[92:95], v[124:127], v[144:147], v[92:95]
    v_mfma_f32_16x16x32_bf16 v[108:111], v[124:127], v[148:151], v[108:111]
    v_mfma_f32_16x16x32_bf16 v[104:107], v[120:123], v[148:151], v[104:107]
    v_mfma_f32_16x16x32_bf16 v[100:103], v[116:119], v[148:151], v[100:103]
    v_mfma_f32_16x16x32_bf16 v[96:99], v[112:115], v[148:151], v[96:99]
    s_waitcnt lgkmcnt(0)
    v_mfma_f32_16x16x32_bf16 v[48:51], v[176:179], v[152:155], v[48:51]
    v_and_b32 v14, 15, v1
    v_lshlrev_b32 v7, 4, v14
    v_mfma_f32_16x16x32_bf16 v[52:55], v[176:179], v[156:159], v[52:55]
    s_lshl_b32 s30, s34, 10
    s_add_u32 s30, s30, 155648
    v_mfma_f32_16x16x32_bf16 v[56:59], v[176:179], v[160:163], v[56:59]
    v_add_u32 v7, s30, v7
    v_lshlrev_b32 v8, 4, v12
    v_mfma_f32_16x16x32_bf16 v[60:63], v[176:179], v[164:167], v[60:63]
    s_lshl_b32 s30, s35, 7
    s_add_u32 s30, s30, 158720
    v_mfma_f32_16x16x32_bf16 v[76:79], v[180:183], v[164:167], v[76:79]
    v_add_u32 v9, s30, v8
    v_lshlrev_b32 v10, 2, v14
    v_mfma_f32_16x16x32_bf16 v[72:75], v[180:183], v[160:163], v[72:75]
    v_add_u32 v10, s30, v10
    s_lshl_b32 s30, s34, 8
    v_mfma_f32_16x16x32_bf16 v[68:71], v[180:183], v[156:159], v[68:71]
    s_add_u32 s30, s30, 157696
    v_add_u32 v8, s30, v8
    v_mfma_f32_16x16x32_bf16 v[64:67], v[180:183], v[152:155], v[64:67]
    s_add_u32 s16, s4, 8388608
    s_addc_u32 s17, s5, 0
    v_mfma_f32_16x16x32_bf16 v[80:83], v[152:155], v[184:187], v[80:83]
    s_mov_b32 s18, 8388608
    s_mov_b32 s19, 0x20000
    v_mfma_f32_16x16x32_bf16 v[84:87], v[156:159], v[184:187], v[84:87]
    s_lshl_b32 s30, s25, 1
    s_add_u32 s30, s30, s35
    v_mfma_f32_16x16x32_bf16 v[88:91], v[160:163], v[184:187], v[88:91]
    s_lshl_b32 s30, s30, 17
    s_lshl_b32 s31, s24, 13
    v_mfma_f32_16x16x32_bf16 v[92:95], v[164:167], v[184:187], v[92:95]
    s_add_u32 s30, s30, s31
    s_add_u32 s31, s30, 4194304
    v_mfma_f32_16x16x32_bf16 v[108:111], v[164:167], v[188:191], v[108:111]
    s_mul_i32 s33, s35, 57344
    v_add_u32 v11, s33, v13
    v_mfma_f32_16x16x32_bf16 v[104:107], v[160:163], v[188:191], v[104:107]
    v_mfma_f32_16x16x32_bf16 v[100:103], v[156:159], v[188:191], v[100:103]
    v_mfma_f32_16x16x32_bf16 v[96:99], v[152:155], v[188:191], v[96:99]
    s_barrier
    v_mfma_f32_16x16x32_bf16 v[16:19], v[168:171], v[152:155], v[16:19]
    ds_read_b128 v[112:115], v7 offset:0
    ds_read_b128 v[116:119], v7 offset:256
    v_mfma_f32_16x16x32_bf16 v[20:23], v[168:171], v[156:159], v[20:23]
    ds_read_b128 v[120:123], v7 offset:512
    ds_read_b128 v[124:127], v7 offset:768
    v_mfma_f32_16x16x32_bf16 v[24:27], v[168:171], v[160:163], v[24:27]
    ds_read_b128 v[128:131], v9 offset:0
    ds_read_b128 v[132:135], v9 offset:64
    v_mfma_f32_16x16x32_bf16 v[28:31], v[168:171], v[164:167], v[28:31]
    ds_read_b128 v[136:139], v9 offset:256
    ds_read_b128 v[140:143], v9 offset:320
    v_mfma_f32_16x16x32_bf16 v[44:47], v[172:175], v[164:167], v[44:47]
    ds_read_b128 v[192:195], v8 offset:0
    ds_read_b128 v[208:211], v8 offset:512
    v_mfma_f32_16x16x32_bf16 v[40:43], v[172:175], v[160:163], v[40:43]
    ds_read_b128 v[196:199], v8 offset:64
    ds_read_b128 v[212:215], v8 offset:576
    v_mfma_f32_16x16x32_bf16 v[36:39], v[172:175], v[156:159], v[36:39]
    ds_read_b128 v[200:203], v8 offset:128
    ds_read_b128 v[216:219], v8 offset:640
    v_mfma_f32_16x16x32_bf16 v[32:35], v[172:175], v[152:155], v[32:35]
    ds_read_b128 v[204:207], v8 offset:192
    ds_read_b128 v[220:223], v8 offset:704
    ds_read_b32 v224, v10 offset:512
    ds_read_b32 v226, v10 offset:576
    s_waitcnt lgkmcnt(10)
    v_pk_fma_f32 v[48:49], v[112:113], v[136:137], v[48:49] op_sel_hi:[0,1,1] neg_lo:[1,0,0] neg_hi:[1,0,0]
    v_pk_fma_f32 v[50:51], v[112:113], v[138:139], v[50:51] op_sel_hi:[0,1,1] neg_lo:[1,0,0] neg_hi:[1,0,0]
    v_pk_mul_f32 v[48:49], v[112:113], v[48:49] op_sel:[1,0] op_sel_hi:[1,1]
    v_pk_mul_f32 v[50:51], v[112:113], v[50:51] op_sel:[1,0] op_sel_hi:[1,1]
    v_pk_fma_f32 v[64:65], v[112:113], v[140:141], v[64:65] op_sel_hi:[0,1,1] neg_lo:[1,0,0] neg_hi:[1,0,0]
    v_pk_fma_f32 v[66:67], v[112:113], v[142:143], v[66:67] op_sel_hi:[0,1,1] neg_lo:[1,0,0] neg_hi:[1,0,0]
    v_pk_mul_f32 v[64:65], v[112:113], v[64:65] op_sel:[1,0] op_sel_hi:[1,1]
    v_pk_mul_f32 v[66:67], v[112:113], v[66:67] op_sel:[1,0] op_sel_hi:[1,1]
    v_cvt_pk_bf16_f32 v48, v48, v49
    v_cvt_pk_bf16_f32 v49, v50, v51
    v_cvt_pk_bf16_f32 v50, v64, v65
    v_cvt_pk_bf16_f32 v51, v66, v67
    buffer_store_dwordx4 v[48:51], v13, s[16:19], s30 offen offset:0 sc0 sc1
    ds_write_b128 v11, v[48:51] offset:16384
    v_pk_fma_f32 v[52:53], v[116:117], v[136:137], v[52:53] op_sel_hi:[0,1,1] neg_lo:[1,0,0] neg_hi:[1,0,0]
    v_pk_fma_f32 v[54:55], v[116:117], v[138:139], v[54:55] op_sel_hi:[0,1,1] neg_lo:[1,0,0] neg_hi:[1,0,0]
    v_pk_mul_f32 v[52:53], v[116:117], v[52:53] op_sel:[1,0] op_sel_hi:[1,1]
    v_pk_mul_f32 v[54:55], v[116:117], v[54:55] op_sel:[1,0] op_sel_hi:[1,1]
    v_pk_fma_f32 v[68:69], v[116:117], v[140:141], v[68:69] op_sel_hi:[0,1,1] neg_lo:[1,0,0] neg_hi:[1,0,0]
    v_pk_fma_f32 v[70:71], v[116:117], v[142:143], v[70:71] op_sel_hi:[0,1,1] neg_lo:[1,0,0] neg_hi:[1,0,0]
    v_pk_mul_f32 v[68:69], v[116:117], v[68:69] op_sel:[1,0] op_sel_hi:[1,1]
    v_pk_mul_f32 v[70:71], v[116:117], v[70:71] op_sel:[1,0] op_sel_hi:[1,1]
    v_cvt_pk_bf16_f32 v52, v52, v53
    v_cvt_pk_bf16_f32 v53, v54, v55
    v_cvt_pk_bf16_f32 v54, v68, v69
    v_cvt_pk_bf16_f32 v55, v70, v71
    buffer_store_dwordx4 v[52:55], v13, s[16:19], s30 offen offset:1024 sc0 sc1
    ds_write_b128 v11, v[52:55] offset:17408
    v_pk_fma_f32 v[56:57], v[120:121], v[136:137], v[56:57] op_sel_hi:[0,1,1] neg_lo:[1,0,0] neg_hi:[1,0,0]
    v_pk_fma_f32 v[58:59], v[120:121], v[138:139], v[58:59] op_sel_hi:[0,1,1] neg_lo:[1,0,0] neg_hi:[1,0,0]
    v_pk_mul_f32 v[56:57], v[120:121], v[56:57] op_sel:[1,0] op_sel_hi:[1,1]
    v_pk_mul_f32 v[58:59], v[120:121], v[58:59] op_sel:[1,0] op_sel_hi:[1,1]
    v_pk_fma_f32 v[72:73], v[120:121], v[140:141], v[72:73] op_sel_hi:[0,1,1] neg_lo:[1,0,0] neg_hi:[1,0,0]
    v_pk_fma_f32 v[74:75], v[120:121], v[142:143], v[74:75] op_sel_hi:[0,1,1] neg_lo:[1,0,0] neg_hi:[1,0,0]
    v_pk_mul_f32 v[72:73], v[120:121], v[72:73] op_sel:[1,0] op_sel_hi:[1,1]
    v_pk_mul_f32 v[74:75], v[120:121], v[74:75] op_sel:[1,0] op_sel_hi:[1,1]
    v_cvt_pk_bf16_f32 v56, v56, v57
    v_cvt_pk_bf16_f32 v57, v58, v59
    v_cvt_pk_bf16_f32 v58, v72, v73
    v_cvt_pk_bf16_f32 v59, v74, v75
    buffer_store_dwordx4 v[56:59], v13, s[16:19], s30 offen offset:2048 sc0 sc1
    ds_write_b128 v11, v[56:59] offset:18432
    v_pk_fma_f32 v[60:61], v[124:125], v[136:137], v[60:61] op_sel_hi:[0,1,1] neg_lo:[1,0,0] neg_hi:[1,0,0]
    v_pk_fma_f32 v[62:63], v[124:125], v[138:139], v[62:63] op_sel_hi:[0,1,1] neg_lo:[1,0,0] neg_hi:[1,0,0]
    v_pk_mul_f32 v[60:61], v[124:125], v[60:61] op_sel:[1,0] op_sel_hi:[1,1]
    v_pk_mul_f32 v[62:63], v[124:125], v[62:63] op_sel:[1,0] op_sel_hi:[1,1]
    v_pk_fma_f32 v[76:77], v[124:125], v[140:141], v[76:77] op_sel_hi:[0,1,1] neg_lo:[1,0,0] neg_hi:[1,0,0]
    v_pk_fma_f32 v[78:79], v[124:125], v[142:143], v[78:79] op_sel_hi:[0,1,1] neg_lo:[1,0,0] neg_hi:[1,0,0]
    v_pk_mul_f32 v[76:77], v[124:125], v[76:77] op_sel:[1,0] op_sel_hi:[1,1]
    v_pk_mul_f32 v[78:79], v[124:125], v[78:79] op_sel:[1,0] op_sel_hi:[1,1]
    v_cvt_pk_bf16_f32 v60, v60, v61
    v_cvt_pk_bf16_f32 v61, v62, v63
    v_cvt_pk_bf16_f32 v62, v76, v77
    v_cvt_pk_bf16_f32 v63, v78, v79
    buffer_store_dwordx4 v[60:63], v13, s[16:19], s30 offen offset:3072 sc0 sc1
    ds_write_b128 v11, v[60:63] offset:19456
    s_waitcnt lgkmcnt(4)
    v_pk_fma_f32 v[80:81], v[192:193], v[224:225], v[80:81] op_sel_hi:[1,0,1] neg_lo:[1,0,0] neg_hi:[1,0,0]
    v_pk_fma_f32 v[82:83], v[194:195], v[224:225], v[82:83] op_sel_hi:[1,0,1] neg_lo:[1,0,0] neg_hi:[1,0,0]
    v_pk_mul_f32 v[80:81], v[208:209], v[80:81]
    v_pk_mul_f32 v[82:83], v[210:211], v[82:83]
    v_pk_fma_f32 v[84:85], v[196:197], v[224:225], v[84:85] op_sel_hi:[1,0,1] neg_lo:[1,0,0] neg_hi:[1,0,0]
    v_pk_fma_f32 v[86:87], v[198:199], v[224:225], v[86:87] op_sel_hi:[1,0,1] neg_lo:[1,0,0] neg_hi:[1,0,0]
    v_pk_mul_f32 v[84:85], v[212:213], v[84:85]
    v_pk_mul_f32 v[86:87], v[214:215], v[86:87]
    v_cvt_pk_bf16_f32 v80, v80, v81
    v_cvt_pk_bf16_f32 v81, v82, v83
    v_cvt_pk_bf16_f32 v82, v84, v85
    v_cvt_pk_bf16_f32 v83, v86, v87
    buffer_store_dwordx4 v[80:83], v13, s[16:19], s31 offen offset:0 sc0 sc1
    ds_write_b128 v11, v[80:83] offset:40960
    v_pk_fma_f32 v[96:97], v[192:193], v[226:227], v[96:97] op_sel_hi:[1,0,1] neg_lo:[1,0,0] neg_hi:[1,0,0]
    v_pk_fma_f32 v[98:99], v[194:195], v[226:227], v[98:99] op_sel_hi:[1,0,1] neg_lo:[1,0,0] neg_hi:[1,0,0]
    v_pk_mul_f32 v[96:97], v[208:209], v[96:97]
    v_pk_mul_f32 v[98:99], v[210:211], v[98:99]
    v_pk_fma_f32 v[100:101], v[196:197], v[226:227], v[100:101] op_sel_hi:[1,0,1] neg_lo:[1,0,0] neg_hi:[1,0,0]
    v_pk_fma_f32 v[102:103], v[198:199], v[226:227], v[102:103] op_sel_hi:[1,0,1] neg_lo:[1,0,0] neg_hi:[1,0,0]
    v_pk_mul_f32 v[100:101], v[212:213], v[100:101]
    v_pk_mul_f32 v[102:103], v[214:215], v[102:103]
    v_cvt_pk_bf16_f32 v96, v96, v97
    v_cvt_pk_bf16_f32 v97, v98, v99
    v_cvt_pk_bf16_f32 v98, v100, v101
    v_cvt_pk_bf16_f32 v99, v102, v103
    buffer_store_dwordx4 v[96:99], v13, s[16:19], s31 offen offset:1024 sc0 sc1
    ds_write_b128 v11, v[96:99] offset:41984
    v_pk_fma_f32 v[88:89], v[200:201], v[224:225], v[88:89] op_sel_hi:[1,0,1] neg_lo:[1,0,0] neg_hi:[1,0,0]
    v_pk_fma_f32 v[90:91], v[202:203], v[224:225], v[90:91] op_sel_hi:[1,0,1] neg_lo:[1,0,0] neg_hi:[1,0,0]
    v_pk_mul_f32 v[88:89], v[216:217], v[88:89]
    v_pk_mul_f32 v[90:91], v[218:219], v[90:91]
    v_pk_fma_f32 v[92:93], v[204:205], v[224:225], v[92:93] op_sel_hi:[1,0,1] neg_lo:[1,0,0] neg_hi:[1,0,0]
    v_pk_fma_f32 v[94:95], v[206:207], v[224:225], v[94:95] op_sel_hi:[1,0,1] neg_lo:[1,0,0] neg_hi:[1,0,0]
    v_pk_mul_f32 v[92:93], v[220:221], v[92:93]
    v_pk_mul_f32 v[94:95], v[222:223], v[94:95]
    v_cvt_pk_bf16_f32 v88, v88, v89
    v_cvt_pk_bf16_f32 v89, v90, v91
    v_cvt_pk_bf16_f32 v90, v92, v93
    v_cvt_pk_bf16_f32 v91, v94, v95
    buffer_store_dwordx4 v[88:91], v13, s[16:19], s31 offen offset:2048 sc0 sc1
    ds_write_b128 v11, v[88:91] offset:43008
    v_pk_fma_f32 v[104:105], v[200:201], v[226:227], v[104:105] op_sel_hi:[1,0,1] neg_lo:[1,0,0] neg_hi:[1,0,0]
    v_pk_fma_f32 v[106:107], v[202:203], v[226:227], v[106:107] op_sel_hi:[1,0,1] neg_lo:[1,0,0] neg_hi:[1,0,0]
    v_pk_mul_f32 v[104:105], v[216:217], v[104:105]
    v_pk_mul_f32 v[106:107], v[218:219], v[106:107]
    v_pk_fma_f32 v[108:109], v[204:205], v[226:227], v[108:109] op_sel_hi:[1,0,1] neg_lo:[1,0,0] neg_hi:[1,0,0]
    v_pk_fma_f32 v[110:111], v[206:207], v[226:227], v[110:111] op_sel_hi:[1,0,1] neg_lo:[1,0,0] neg_hi:[1,0,0]
    v_pk_mul_f32 v[108:109], v[220:221], v[108:109]
    v_pk_mul_f32 v[110:111], v[222:223], v[110:111]
    v_cvt_pk_bf16_f32 v104, v104, v105
    v_cvt_pk_bf16_f32 v105, v106, v107
    v_cvt_pk_bf16_f32 v106, v108, v109
    v_cvt_pk_bf16_f32 v107, v110, v111
    buffer_store_dwordx4 v[104:107], v13, s[16:19], s31 offen offset:3072 sc0 sc1
    ds_write_b128 v11, v[104:107] offset:44032
    v_pk_fma_f32 v[16:17], v[112:113], v[128:129], v[16:17] op_sel_hi:[0,1,1] neg_lo:[1,0,0] neg_hi:[1,0,0]
    v_pk_fma_f32 v[18:19], v[112:113], v[130:131], v[18:19] op_sel_hi:[0,1,1] neg_lo:[1,0,0] neg_hi:[1,0,0]
    v_pk_mul_f32 v[16:17], v[112:113], v[16:17] op_sel:[1,0] op_sel_hi:[1,1]
    v_pk_mul_f32 v[18:19], v[112:113], v[18:19] op_sel:[1,0] op_sel_hi:[1,1]
    v_pk_fma_f32 v[32:33], v[112:113], v[132:133], v[32:33] op_sel_hi:[0,1,1] neg_lo:[1,0,0] neg_hi:[1,0,0]
    v_pk_fma_f32 v[34:35], v[112:113], v[134:135], v[34:35] op_sel_hi:[0,1,1] neg_lo:[1,0,0] neg_hi:[1,0,0]
    v_pk_mul_f32 v[32:33], v[112:113], v[32:33] op_sel:[1,0] op_sel_hi:[1,1]
    v_pk_mul_f32 v[34:35], v[112:113], v[34:35] op_sel:[1,0] op_sel_hi:[1,1]
    v_cvt_pk_bf16_f32 v16, v16, v17
    v_cvt_pk_bf16_f32 v17, v18, v19
    v_cvt_pk_bf16_f32 v18, v32, v33
    v_cvt_pk_bf16_f32 v19, v34, v35
    ds_write_b128 v11, v[16:19] offset:49152
    v_pk_fma_f32 v[20:21], v[116:117], v[128:129], v[20:21] op_sel_hi:[0,1,1] neg_lo:[1,0,0] neg_hi:[1,0,0]
    v_pk_fma_f32 v[22:23], v[116:117], v[130:131], v[22:23] op_sel_hi:[0,1,1] neg_lo:[1,0,0] neg_hi:[1,0,0]
    v_pk_mul_f32 v[20:21], v[116:117], v[20:21] op_sel:[1,0] op_sel_hi:[1,1]
    v_pk_mul_f32 v[22:23], v[116:117], v[22:23] op_sel:[1,0] op_sel_hi:[1,1]
    v_pk_fma_f32 v[36:37], v[116:117], v[132:133], v[36:37] op_sel_hi:[0,1,1] neg_lo:[1,0,0] neg_hi:[1,0,0]
    v_pk_fma_f32 v[38:39], v[116:117], v[134:135], v[38:39] op_sel_hi:[0,1,1] neg_lo:[1,0,0] neg_hi:[1,0,0]
    v_pk_mul_f32 v[36:37], v[116:117], v[36:37] op_sel:[1,0] op_sel_hi:[1,1]
    v_pk_mul_f32 v[38:39], v[116:117], v[38:39] op_sel:[1,0] op_sel_hi:[1,1]
    v_cvt_pk_bf16_f32 v20, v20, v21
    v_cvt_pk_bf16_f32 v21, v22, v23
    v_cvt_pk_bf16_f32 v22, v36, v37
    v_cvt_pk_bf16_f32 v23, v38, v39
    ds_write_b128 v11, v[20:23] offset:50176
    v_pk_fma_f32 v[24:25], v[120:121], v[128:129], v[24:25] op_sel_hi:[0,1,1] neg_lo:[1,0,0] neg_hi:[1,0,0]
    v_pk_fma_f32 v[26:27], v[120:121], v[130:131], v[26:27] op_sel_hi:[0,1,1] neg_lo:[1,0,0] neg_hi:[1,0,0]
    v_pk_mul_f32 v[24:25], v[120:121], v[24:25] op_sel:[1,0] op_sel_hi:[1,1]
    v_pk_mul_f32 v[26:27], v[120:121], v[26:27] op_sel:[1,0] op_sel_hi:[1,1]
    v_pk_fma_f32 v[40:41], v[120:121], v[132:133], v[40:41] op_sel_hi:[0,1,1] neg_lo:[1,0,0] neg_hi:[1,0,0]
    v_pk_fma_f32 v[42:43], v[120:121], v[134:135], v[42:43] op_sel_hi:[0,1,1] neg_lo:[1,0,0] neg_hi:[1,0,0]
    v_pk_mul_f32 v[40:41], v[120:121], v[40:41] op_sel:[1,0] op_sel_hi:[1,1]
    v_pk_mul_f32 v[42:43], v[120:121], v[42:43] op_sel:[1,0] op_sel_hi:[1,1]
    v_cvt_pk_bf16_f32 v24, v24, v25
    v_cvt_pk_bf16_f32 v25, v26, v27
    v_cvt_pk_bf16_f32 v26, v40, v41
    v_cvt_pk_bf16_f32 v27, v42, v43
    ds_write_b128 v11, v[24:27] offset:51200
    v_pk_fma_f32 v[28:29], v[124:125], v[128:129], v[28:29] op_sel_hi:[0,1,1] neg_lo:[1,0,0] neg_hi:[1,0,0]
    v_pk_fma_f32 v[30:31], v[124:125], v[130:131], v[30:31] op_sel_hi:[0,1,1] neg_lo:[1,0,0] neg_hi:[1,0,0]
    v_pk_mul_f32 v[28:29], v[124:125], v[28:29] op_sel:[1,0] op_sel_hi:[1,1]
    v_pk_mul_f32 v[30:31], v[124:125], v[30:31] op_sel:[1,0] op_sel_hi:[1,1]
    v_pk_fma_f32 v[44:45], v[124:125], v[132:133], v[44:45] op_sel_hi:[0,1,1] neg_lo:[1,0,0] neg_hi:[1,0,0]
    v_pk_fma_f32 v[46:47], v[124:125], v[134:135], v[46:47] op_sel_hi:[0,1,1] neg_lo:[1,0,0] neg_hi:[1,0,0]
    v_pk_mul_f32 v[44:45], v[124:125], v[44:45] op_sel:[1,0] op_sel_hi:[1,1]
    v_pk_mul_f32 v[46:47], v[124:125], v[46:47] op_sel:[1,0] op_sel_hi:[1,1]
    v_cvt_pk_bf16_f32 v28, v28, v29
    v_cvt_pk_bf16_f32 v29, v30, v31
    v_cvt_pk_bf16_f32 v30, v44, v45
    v_cvt_pk_bf16_f32 v31, v46, v47
    ds_write_b128 v11, v[28:31] offset:52224
    s_lshl_b32 s40, s24, 11
    s_lshl_b32 s41, s25, 7
    s_add_u32 s40, s40, s41
    s_lshl_b32 s41, s3, 3
    s_add_u32 s40, s40, s41
    s_add_u32 s40, s40, 65536
    v_mov_b32 v112, s72
    v_mov_b32 v113, s73
    v_mov_b32 v114, 0
    s_waitcnt vmcnt(0)
    s_mov_b64 exec, 1
    buffer_store_dwordx2 v[112:113], v114, s[76:79], s40 offen sc0 sc1
    s_mov_b64 exec, -1
    s_waitcnt lgkmcnt(0)
    s_barrier
L_attn:
    v_bfe_u32 v6, v1, 4, 1
    v_lshlrev_b32 v2, 10, v6
    v_lshrrev_b32 v6, 5, v1
    v_lshl_add_u32 v2, v6, 8, v2
    v_and_b32 v7, 15, v1
    v_lshl_add_u32 v2, v7, 4, v2
    s_lshr_b32 s34, s3, 2
    s_and_b32 s35, s3, 3
    s_mul_i32 s30, s34, 57344
    s_lshl_b32 s31, s35, 11
    s_add_u32 s30, s30, s31
    v_add_u32 v4, s30, v2
    ds_read_b128 v[8:11], v4 offset:49152
    ds_read_b128 v[12:15], v4 offset:49664
    ds_read_b128 v[176:179], v4 offset:0
    ds_read_b128 v[180:183], v4 offset:512
    ds_read_b128 v[240:243], v4 offset:16384
    ds_read_b128 v[244:247], v4 offset:16896
    ds_read_b128 v[184:187], v4 offset:2048
    ds_read_b128 v[188:191], v4 offset:2560
    ds_read_b128 v[192:195], v4 offset:4096
    ds_read_b128 v[196:199], v4 offset:4608
    v_and_b32 v7, 31, v1
    v_lshlrev_b32 v6, 2, v6
    v_sub_u32 v5, v7, v6
    v_mov_b32 v6, 0xffff0000
    v_cmp_gt_i32 s[40:41], 0, v5
    v_cmp_gt_i32 s[42:43], 1, v5
    v_cmp_gt_i32 s[44:45], 2, v5
    v_cmp_gt_i32 s[46:47], 3, v5
    v_cmp_gt_i32 s[48:49], 8, v5
    v_cmp_gt_i32 s[50:51], 9, v5
    v_cmp_gt_i32 s[52:53], 10, v5
    v_cmp_gt_i32 s[54:55], 11, v5
    v_cmp_gt_i32 s[56:57], 16, v5
    v_cmp_gt_i32 s[58:59], 17, v5
    v_cmp_gt_i32 s[60:61], 18, v5
    v_cmp_gt_i32 s[62:63], 19, v5
    v_cmp_gt_i32 s[64:65], 24, v5
    v_cmp_gt_i32 s[66:67], 25, v5
    v_cmp_gt_i32 s[68:69], 26, v5
    v_cmp_gt_i32 s[70:71], 27, v5
    s_waitcnt lgkmcnt(6)
    v_mfma_f32_32x32x16_bf16 v[32:47], v[176:179], v[8:11], 0
    ds_read_b128 v[200:203], v4 offset:6144
    v_cndmask_b32 v24, 0, v6, s[42:43]
    v_cndmask_b32 v24, v24, -1, s[40:41]
    v_cndmask_b32 v25, 0, v6, s[46:47]
    v_cndmask_b32 v25, v25, -1, s[44:45]
    v_mfma_f32_32x32x16_bf16 v[32:47], v[180:183], v[12:15], v[32:47]
    ds_read_b128 v[204:207], v4 offset:6656
    v_cndmask_b32 v26, 0, v6, s[58:59]
    v_cndmask_b32 v26, v26, -1, s[56:57]
    v_cndmask_b32 v27, 0, v6, s[62:63]
    v_cndmask_b32 v27, v27, -1, s[60:61]
    s_waitcnt lgkmcnt(6)
    v_mfma_f32_32x32x16_bf16 v[160:175], v[240:243], v[8:11], 0
    ds_read_b128 v[208:211], v4 offset:8192
    v_cndmask_b32 v28, 0, v6, s[50:51]
    v_cndmask_b32 v28, v28, -1, s[48:49]
    v_cndmask_b32 v29, 0, v6, s[54:55]
    v_cndmask_b32 v29, v29, -1, s[52:53]
    v_mfma_f32_32x32x16_bf16 v[160:175], v[244:247], v[12:15], v[160:175]
    ds_read_b128 v[212:215], v4 offset:8704
    v_cndmask_b32 v30, 0, v6, s[66:67]
    v_cndmask_b32 v30, v30, -1, s[64:65]
    v_cndmask_b32 v31, 0, v6, s[70:71]
    v_cndmask_b32 v31, v31, -1, s[68:69]
    s_waitcnt lgkmcnt(6)
    v_mfma_f32_32x32x16_bf16 v[48:63], v[184:187], v[8:11], 0
    ds_read_b128 v[216:219], v4 offset:10240
    v_mfma_f32_32x32x16_bf16 v[48:63], v[188:191], v[12:15], v[48:63]
    ds_read_b128 v[220:223], v4 offset:10752
    s_waitcnt lgkmcnt(6)
    v_mfma_f32_32x32x16_bf16 v[64:79], v[192:195], v[8:11], 0
    ds_read_b128 v[224:227], v4 offset:12288
    v_cndmask_b32 v32, v160, v32, s[40:41]
    v_cndmask_b32 v33, v161, v33, s[42:43]
    v_cndmask_b32 v34, v162, v34, s[44:45]
    v_cndmask_b32 v35, v163, v35, s[46:47]
    v_mfma_f32_32x32x16_bf16 v[64:79], v[196:199], v[12:15], v[64:79]
    ds_read_b128 v[228:231], v4 offset:12800
    v_cndmask_b32 v36, v164, v36, s[48:49]
    v_cndmask_b32 v37, v165, v37, s[50:51]
    v_cndmask_b32 v38, v166, v38, s[52:53]
    v_cndmask_b32 v39, v167, v39, s[54:55]
    s_waitcnt lgkmcnt(6)
    v_mfma_f32_32x32x16_bf16 v[80:95], v[200:203], v[8:11], 0
    ds_read_b128 v[232:235], v4 offset:14336
    v_cndmask_b32 v40, v168, v40, s[56:57]
    v_cndmask_b32 v41, v169, v41, s[58:59]
    v_cndmask_b32 v42, v170, v42, s[60:61]
    v_cndmask_b32 v43, v171, v43, s[62:63]
    v_cndmask_b32 v44, v172, v44, s[64:65]
    v_cndmask_b32 v45, v173, v45, s[66:67]
    v_mfma_f32_32x32x16_bf16 v[80:95], v[204:207], v[12:15], v[80:95]
    ds_read_b128 v[236:239], v4 offset:14848
    v_cndmask_b32 v46, v174, v46, s[68:69]
    v_cndmask_b32 v47, v175, v47, s[70:71]
    v_max_f32 v248, v48, v49
    v_max_f32 v249, v50, v51
    v_max3_f32 v248, v52, v53, v248
    v_max3_f32 v249, v54, v55, v249
    s_waitcnt lgkmcnt(6)
    v_mfma_f32_32x32x16_bf16 v[96:111], v[208:211], v[8:11], 0
    v_max3_f32 v248, v56, v57, v248
    v_max3_f32 v249, v58, v59, v249
    v_max3_f32 v248, v60, v61, v248
    v_max3_f32 v249, v62, v63, v249
    v_max3_f32 v248, v32, v33, v248
    v_max3_f32 v249, v34, v35, v249
    v_mfma_f32_32x32x16_bf16 v[96:111], v[212:215], v[12:15], v[96:111]
    v_max3_f32 v248, v36, v37, v248
    v_max3_f32 v249, v38, v39, v249
    v_max3_f32 v248, v40, v41, v248
    v_max3_f32 v249, v42, v43, v249
    v_max3_f32 v248, v44, v45, v248
    v_max3_f32 v249, v46, v47, v249
    s_waitcnt lgkmcnt(4)
    v_mfma_f32_32x32x16_bf16 v[112:127], v[216:219], v[8:11], 0
    v_max3_f32 v248, v64, v65, v248
    v_max3_f32 v249, v66, v67, v249
    v_max3_f32 v248, v68, v69, v248
    v_max3_f32 v249, v70, v71, v249
    v_max3_f32 v248, v72, v73, v248
    v_max3_f32 v249, v74, v75, v249
    v_mfma_f32_32x32x16_bf16 v[112:127], v[220:223], v[12:15], v[112:127]
    v_max3_f32 v248, v76, v77, v248
    v_max3_f32 v249, v78, v79, v249
    v_max3_f32 v248, v80, v81, v248
    v_max3_f32 v249, v82, v83, v249
    v_max3_f32 v248, v84, v85, v248
    v_max3_f32 v249, v86, v87, v249
    s_waitcnt lgkmcnt(2)
    v_mfma_f32_32x32x16_bf16 v[128:143], v[224:227], v[8:11], 0
    v_max3_f32 v248, v88, v89, v248
    v_max3_f32 v249, v90, v91, v249
    v_max3_f32 v248, v92, v93, v248
    v_max3_f32 v249, v94, v95, v249
    v_max3_f32 v248, v96, v97, v248
    v_max3_f32 v249, v98, v99, v249
    v_mfma_f32_32x32x16_bf16 v[128:143], v[228:231], v[12:15], v[128:143]
    v_max3_f32 v248, v100, v101, v248
    v_max3_f32 v249, v102, v103, v249
    v_max3_f32 v248, v104, v105, v248
    v_max3_f32 v249, v106, v107, v249
    v_max3_f32 v248, v108, v109, v248
    v_max3_f32 v249, v110, v111, v249
    s_waitcnt lgkmcnt(0)
    v_mfma_f32_32x32x16_bf16 v[144:159], v[232:235], v[8:11], 0
    v_max3_f32 v248, v112, v113, v248
    v_max3_f32 v249, v114, v115, v249
    v_max3_f32 v248, v116, v117, v248
    v_max3_f32 v249, v118, v119, v249
    v_mfma_f32_32x32x16_bf16 v[144:159], v[236:239], v[12:15], v[144:159]
    v_max3_f32 v248, v120, v121, v248
    v_max3_f32 v249, v122, v123, v249
    v_max3_f32 v248, v124, v125, v248
    v_max3_f32 v249, v126, v127, v249
    ds_read_b128 v[176:179], v4 offset:24576
    ds_read_b128 v[180:183], v4 offset:25088
    ds_read_b128 v[240:243], v4 offset:40960
    ds_read_b128 v[244:247], v4 offset:41472
    ds_read_b128 v[184:187], v4 offset:26624
    ds_read_b128 v[188:191], v4 offset:27136
    ds_read_b128 v[192:195], v4 offset:28672
    ds_read_b128 v[196:199], v4 offset:29184
    ds_read_b128 v[200:203], v4 offset:30720
    ds_read_b128 v[204:207], v4 offset:31232
    ds_read_b128 v[208:211], v4 offset:32768
    ds_read_b128 v[212:215], v4 offset:33280
    v_max3_f32 v248, v128, v129, v248
    v_max3_f32 v249, v130, v131, v249
    v_max3_f32 v248, v132, v133, v248
    v_max3_f32 v249, v134, v135, v249
    v_max3_f32 v248, v136, v137, v248
    v_max3_f32 v249, v138, v139, v249
    v_max3_f32 v248, v140, v141, v248
    v_max3_f32 v249, v142, v143, v249
    v_max3_f32 v248, v144, v145, v248
    v_max3_f32 v249, v146, v147, v249
    v_max3_f32 v248, v148, v149, v248
    v_max3_f32 v249, v150, v151, v249
    v_max3_f32 v248, v152, v153, v248
    v_max3_f32 v249, v154, v155, v249
    v_max3_f32 v248, v156, v157, v248
    v_max3_f32 v249, v158, v159, v249
    s_lshl_b32 s30, s24, 2
    s_add_u32 s30, s30, s35
    s_cmp_ge_u32 s30, 8
    s_cbranch_scc1 at_valid_6
    v_mov_b32 v7, 0xff800000
    v_cndmask_b32 v32, v32, v7, s[40:41]
    v_cndmask_b32 v33, v33, v7, s[42:43]
    v_cndmask_b32 v34, v34, v7, s[44:45]
    v_cndmask_b32 v35, v35, v7, s[46:47]
    v_cndmask_b32 v36, v36, v7, s[48:49]
    v_cndmask_b32 v37, v37, v7, s[50:51]
    v_cndmask_b32 v38, v38, v7, s[52:53]
    v_cndmask_b32 v39, v39, v7, s[54:55]
    v_cndmask_b32 v40, v40, v7, s[56:57]
    v_cndmask_b32 v41, v41, v7, s[58:59]
    v_cndmask_b32 v42, v42, v7, s[60:61]
    v_cndmask_b32 v43, v43, v7, s[62:63]
    v_cndmask_b32 v44, v44, v7, s[64:65]
    v_cndmask_b32 v45, v45, v7, s[66:67]
    v_cndmask_b32 v46, v46, v7, s[68:69]
    v_cndmask_b32 v47, v47, v7, s[70:71]
    s_cmp_ge_u32 s30, 7
    s_cbranch_scc1 at_nb_7
    v_mov_b32 v48, v7
    v_mov_b32 v49, v7
    v_mov_b32 v50, v7
    v_mov_b32 v51, v7
    v_mov_b32 v52, v7
    v_mov_b32 v53, v7
    v_mov_b32 v54, v7
    v_mov_b32 v55, v7
    v_mov_b32 v56, v7
    v_mov_b32 v57, v7
    v_mov_b32 v58, v7
    v_mov_b32 v59, v7
    v_mov_b32 v60, v7
    v_mov_b32 v61, v7
    v_mov_b32 v62, v7
    v_mov_b32 v63, v7
at_nb_7:
    s_cmp_ge_u32 s30, 6
    s_cbranch_scc1 at_nb_8
    v_mov_b32 v64, v7
    v_mov_b32 v65, v7
    v_mov_b32 v66, v7
    v_mov_b32 v67, v7
    v_mov_b32 v68, v7
    v_mov_b32 v69, v7
    v_mov_b32 v70, v7
    v_mov_b32 v71, v7
    v_mov_b32 v72, v7
    v_mov_b32 v73, v7
    v_mov_b32 v74, v7
    v_mov_b32 v75, v7
    v_mov_b32 v76, v7
    v_mov_b32 v77, v7
    v_mov_b32 v78, v7
    v_mov_b32 v79, v7
at_nb_8:
    s_cmp_ge_u32 s30, 5
    s_cbranch_scc1 at_nb_9
    v_mov_b32 v80, v7
    v_mov_b32 v81, v7
    v_mov_b32 v82, v7
    v_mov_b32 v83, v7
    v_mov_b32 v84, v7
    v_mov_b32 v85, v7
    v_mov_b32 v86, v7
    v_mov_b32 v87, v7
    v_mov_b32 v88, v7
    v_mov_b32 v89, v7
    v_mov_b32 v90, v7
    v_mov_b32 v91, v7
    v_mov_b32 v92, v7
    v_mov_b32 v93, v7
    v_mov_b32 v94, v7
    v_mov_b32 v95, v7
at_nb_9:
    s_cmp_ge_u32 s30, 4
    s_cbranch_scc1 at_nb_10
    v_mov_b32 v96, v7
    v_mov_b32 v97, v7
    v_mov_b32 v98, v7
    v_mov_b32 v99, v7
    v_mov_b32 v100, v7
    v_mov_b32 v101, v7
    v_mov_b32 v102, v7
    v_mov_b32 v103, v7
    v_mov_b32 v104, v7
    v_mov_b32 v105, v7
    v_mov_b32 v106, v7
    v_mov_b32 v107, v7
    v_mov_b32 v108, v7
    v_mov_b32 v109, v7
    v_mov_b32 v110, v7
    v_mov_b32 v111, v7
at_nb_10:
    s_cmp_ge_u32 s30, 3
    s_cbranch_scc1 at_nb_11
    v_mov_b32 v112, v7
    v_mov_b32 v113, v7
    v_mov_b32 v114, v7
    v_mov_b32 v115, v7
    v_mov_b32 v116, v7
    v_mov_b32 v117, v7
    v_mov_b32 v118, v7
    v_mov_b32 v119, v7
    v_mov_b32 v120, v7
    v_mov_b32 v121, v7
    v_mov_b32 v122, v7
    v_mov_b32 v123, v7
    v_mov_b32 v124, v7
    v_mov_b32 v125, v7
    v_mov_b32 v126, v7
    v_mov_b32 v127, v7
at_nb_11:
    s_cmp_ge_u32 s30, 2
    s_cbranch_scc1 at_nb_12
    v_mov_b32 v128, v7
    v_mov_b32 v129, v7
    v_mov_b32 v130, v7
    v_mov_b32 v131, v7
    v_mov_b32 v132, v7
    v_mov_b32 v133, v7
    v_mov_b32 v134, v7
    v_mov_b32 v135, v7
    v_mov_b32 v136, v7
    v_mov_b32 v137, v7
    v_mov_b32 v138, v7
    v_mov_b32 v139, v7
    v_mov_b32 v140, v7
    v_mov_b32 v141, v7
    v_mov_b32 v142, v7
    v_mov_b32 v143, v7
at_nb_12:
    s_cmp_ge_u32 s30, 1
    s_cbranch_scc1 at_nb_13
    v_mov_b32 v144, v7
    v_mov_b32 v145, v7
    v_mov_b32 v146, v7
    v_mov_b32 v147, v7
    v_mov_b32 v148, v7
    v_mov_b32 v149, v7
    v_mov_b32 v150, v7
    v_mov_b32 v151, v7
    v_mov_b32 v152, v7
    v_mov_b32 v153, v7
    v_mov_b32 v154, v7
    v_mov_b32 v155, v7
    v_mov_b32 v156, v7
    v_mov_b32 v157, v7
    v_mov_b32 v158, v7
    v_mov_b32 v159, v7
at_nb_13:
    v_max_f32 v248, v32, v33
    v_max_f32 v249, v34, v35
    v_max3_f32 v248, v36, v37, v248
    v_max3_f32 v249, v38, v39, v249
    v_max3_f32 v248, v40, v41, v248
    v_max3_f32 v249, v42, v43, v249
    v_max3_f32 v248, v44, v45, v248
    v_max3_f32 v249, v46, v47, v249
    v_max3_f32 v248, v48, v49, v248
    v_max3_f32 v249, v50, v51, v249
    v_max3_f32 v248, v52, v53, v248
    v_max3_f32 v249, v54, v55, v249
    v_max3_f32 v248, v56, v57, v248
    v_max3_f32 v249, v58, v59, v249
    v_max3_f32 v248, v60, v61, v248
    v_max3_f32 v249, v62, v63, v249
    v_max3_f32 v248, v64, v65, v248
    v_max3_f32 v249, v66, v67, v249
    v_max3_f32 v248, v68, v69, v248
    v_max3_f32 v249, v70, v71, v249
    v_max3_f32 v248, v72, v73, v248
    v_max3_f32 v249, v74, v75, v249
    v_max3_f32 v248, v76, v77, v248
    v_max3_f32 v249, v78, v79, v249
    v_max3_f32 v248, v80, v81, v248
    v_max3_f32 v249, v82, v83, v249
    v_max3_f32 v248, v84, v85, v248
    v_max3_f32 v249, v86, v87, v249
    v_max3_f32 v248, v88, v89, v248
    v_max3_f32 v249, v90, v91, v249
    v_max3_f32 v248, v92, v93, v248
    v_max3_f32 v249, v94, v95, v249
    v_max3_f32 v248, v96, v97, v248
    v_max3_f32 v249, v98, v99, v249
    v_max3_f32 v248, v100, v101, v248
    v_max3_f32 v249, v102, v103, v249
    v_max3_f32 v248, v104, v105, v248
    v_max3_f32 v249, v106, v107, v249
    v_max3_f32 v248, v108, v109, v248
    v_max3_f32 v249, v110, v111, v249
    v_max3_f32 v248, v112, v113, v248
    v_max3_f32 v249, v114, v115, v249
    v_max3_f32 v248, v116, v117, v248
    v_max3_f32 v249, v118, v119, v249
    v_max3_f32 v248, v120, v121, v248
    v_max3_f32 v249, v122, v123, v249
    v_max3_f32 v248, v124, v125, v248
    v_max3_f32 v249, v126, v127, v249
    v_max3_f32 v248, v128, v129, v248
    v_max3_f32 v249, v130, v131, v249
    v_max3_f32 v248, v132, v133, v248
    v_max3_f32 v249, v134, v135, v249
    v_max3_f32 v248, v136, v137, v248
    v_max3_f32 v249, v138, v139, v249
    v_max3_f32 v248, v140, v141, v248
    v_max3_f32 v249, v142, v143, v249
    v_max3_f32 v248, v144, v145, v248
    v_max3_f32 v249, v146, v147, v249
    v_max3_f32 v248, v148, v149, v248
    v_max3_f32 v249, v150, v151, v249
    v_max3_f32 v248, v152, v153, v248
    v_max3_f32 v249, v154, v155, v249
    v_max3_f32 v248, v156, v157, v248
    v_max3_f32 v249, v158, v159, v249
at_valid_6:
    ds_read_b128 v[216:219], v4 offset:34816
    ds_read_b128 v[220:223], v4 offset:35328
    ds_read_b128 v[224:227], v4 offset:36864
    ds_read_b128 v[228:231], v4 offset:37376
    ds_read_b128 v[232:235], v4 offset:38912
    ds_read_b128 v[236:239], v4 offset:39424
    v_max_f32 v248, v248, v249
    v_mov_b32 v8, 0x3e8293ee
    v_mov_b32 v9, 0x3e8293ee
    v_mov_b32 v249, v248
    v_mov_b32 v12, 0x3f803f80
    v_mov_b32 v13, 0x3f803f80
    v_mov_b32 v14, 0x3f803f80
    v_mov_b32 v15, 0x3f803f80
    v_permlane32_swap_b32 v248, v249
    v_max_f32 v248, v248, v249
    v_mul_f32 v10, 0xbe8293ee, v248
    v_mul_f32 v11, 0xbe8293ee, v248
    v_pk_fma_f32 v[32:33], v[32:33], v[8:9], v[10:11]
    v_pk_fma_f32 v[34:35], v[34:35], v[8:9], v[10:11]
    v_pk_fma_f32 v[36:37], v[36:37], v[8:9], v[10:11]
    v_pk_fma_f32 v[38:39], v[38:39], v[8:9], v[10:11]
    v_pk_fma_f32 v[40:41], v[40:41], v[8:9], v[10:11]
    v_pk_fma_f32 v[42:43], v[42:43], v[8:9], v[10:11]
    v_pk_fma_f32 v[44:45], v[44:45], v[8:9], v[10:11]
    v_pk_fma_f32 v[46:47], v[46:47], v[8:9], v[10:11]
    v_exp_f32 v32, v32
    v_exp_f32 v33, v33
    v_exp_f32 v34, v34
    v_exp_f32 v35, v35
    v_exp_f32 v36, v36
    v_exp_f32 v37, v37
    v_exp_f32 v38, v38
    v_exp_f32 v39, v39
    v_exp_f32 v40, v40
    v_exp_f32 v41, v41
    v_exp_f32 v42, v42
    v_exp_f32 v43, v43
    v_exp_f32 v44, v44
    v_exp_f32 v45, v45
    v_exp_f32 v46, v46
    v_exp_f32 v47, v47
    v_cvt_pk_bf16_f32 v32, v32, v33
    v_cvt_pk_bf16_f32 v33, v34, v35
    v_cvt_pk_bf16_f32 v34, v40, v41
    v_cvt_pk_bf16_f32 v35, v42, v43
    v_cvt_pk_bf16_f32 v36, v36, v37
    v_cvt_pk_bf16_f32 v37, v38, v39
    v_cvt_pk_bf16_f32 v38, v44, v45
    v_cvt_pk_bf16_f32 v39, v46, v47
    v_and_b32 v40, v24, v32
    v_and_b32 v41, v25, v33
    v_and_b32 v42, v26, v34
    v_and_b32 v43, v27, v35
    v_and_b32 v44, v28, v36
    v_and_b32 v45, v29, v37
    v_and_b32 v46, v30, v38
    v_and_b32 v47, v31, v39
    v_xor_b32 v32, v40, v32
    v_xor_b32 v33, v41, v33
    v_xor_b32 v34, v42, v34
    v_xor_b32 v35, v43, v35
    v_xor_b32 v36, v44, v36
    v_xor_b32 v37, v45, v37
    v_xor_b32 v38, v46, v38
    v_xor_b32 v39, v47, v39
    s_waitcnt lgkmcnt(0)
    s_barrier
    s_cmp_lt_u32 s3, 4
    s_cbranch_scc1 skip_x1_14
    s_mul_i32 s30, s24, 458752
    s_mul_i32 s31, s38, 7168
    s_add_u32 m0, s31, 81920
    s_nop 0
    buffer_load_dwordx4 v16, s[20:23], s30 offen offset:0 lds
    buffer_load_dwordx4 v17, s[20:23], s30 offen offset:1024 lds
    buffer_load_dwordx4 v18, s[20:23], s30 offen offset:2048 lds
    buffer_load_dwordx4 v19, s[20:23], s30 offen offset:3072 lds
    s_add_u32 m0, s31, 86016
    s_nop 0
    buffer_load_dwordx4 v20, s[20:23], s30 offen offset:0 lds
    buffer_load_dwordx4 v21, s[20:23], s30 offen offset:1024 lds
    buffer_load_dwordx4 v22, s[20:23], s30 offen offset:2048 lds
skip_x1_14:
    v_pk_fma_f32 v[48:49], v[48:49], v[8:9], v[10:11]
    v_pk_fma_f32 v[50:51], v[50:51], v[8:9], v[10:11]
    v_pk_fma_f32 v[52:53], v[52:53], v[8:9], v[10:11]
    v_pk_fma_f32 v[54:55], v[54:55], v[8:9], v[10:11]
    v_pk_fma_f32 v[56:57], v[56:57], v[8:9], v[10:11]
    v_pk_fma_f32 v[58:59], v[58:59], v[8:9], v[10:11]
    v_pk_fma_f32 v[60:61], v[60:61], v[8:9], v[10:11]
    v_pk_fma_f32 v[62:63], v[62:63], v[8:9], v[10:11]
    v_mfma_f32_32x32x16_bf16 v[160:175], v[12:15], v[40:43], 0
    v_exp_f32 v48, v48
    v_exp_f32 v49, v49
    v_exp_f32 v50, v50
    v_mfma_f32_32x32x16_bf16 v[160:175], v[12:15], v[44:47], v[160:175]
    v_exp_f32 v51, v51
    v_exp_f32 v52, v52
    v_exp_f32 v53, v53
    v_mfma_f32_32x32x16_bf16 v[160:175], v[12:15], v[32:35], v[160:175]
    v_exp_f32 v54, v54
    v_exp_f32 v55, v55
    v_exp_f32 v56, v56
    v_mfma_f32_32x32x16_bf16 v[160:175], v[12:15], v[36:39], v[160:175]
    v_exp_f32 v57, v57
    v_exp_f32 v58, v58
    v_exp_f32 v59, v59
    v_mfma_f32_32x32x16_bf16 v[16:31], v[176:179], v[40:43], 0
    v_exp_f32 v60, v60
    v_exp_f32 v61, v61
    v_exp_f32 v62, v62
    v_mfma_f32_32x32x16_bf16 v[16:31], v[180:183], v[44:47], v[16:31]
    v_exp_f32 v63, v63
    v_cvt_pk_bf16_f32 v48, v48, v49
    v_cvt_pk_bf16_f32 v49, v50, v51
    v_cvt_pk_bf16_f32 v50, v56, v57
    v_cvt_pk_bf16_f32 v51, v58, v59
    v_cvt_pk_bf16_f32 v52, v52, v53
    v_cvt_pk_bf16_f32 v53, v54, v55
    v_cvt_pk_bf16_f32 v54, v60, v61
    v_cvt_pk_bf16_f32 v55, v62, v63
    v_pk_fma_f32 v[64:65], v[64:65], v[8:9], v[10:11]
    v_pk_fma_f32 v[66:67], v[66:67], v[8:9], v[10:11]
    v_pk_fma_f32 v[68:69], v[68:69], v[8:9], v[10:11]
    v_pk_fma_f32 v[70:71], v[70:71], v[8:9], v[10:11]
    v_pk_fma_f32 v[72:73], v[72:73], v[8:9], v[10:11]
    v_pk_fma_f32 v[74:75], v[74:75], v[8:9], v[10:11]
    v_pk_fma_f32 v[76:77], v[76:77], v[8:9], v[10:11]
    v_pk_fma_f32 v[78:79], v[78:79], v[8:9], v[10:11]
    v_mfma_f32_32x32x16_bf16 v[16:31], v[240:243], v[32:35], v[16:31]
    v_exp_f32 v64, v64
    v_exp_f32 v65, v65
    v_exp_f32 v66, v66
    v_mfma_f32_32x32x16_bf16 v[16:31], v[244:247], v[36:39], v[16:31]
    v_exp_f32 v67, v67
    v_exp_f32 v68, v68
    v_exp_f32 v69, v69
    v_mfma_f32_32x32x16_bf16 v[160:175], v[12:15], v[48:51], v[160:175]
    v_exp_f32 v70, v70
    v_exp_f32 v71, v71
    v_exp_f32 v72, v72
    v_mfma_f32_32x32x16_bf16 v[160:175], v[12:15], v[52:55], v[160:175]
    v_exp_f32 v73, v73
    v_exp_f32 v74, v74
    v_exp_f32 v75, v75
    v_mfma_f32_32x32x16_bf16 v[16:31], v[184:187], v[48:51], v[16:31]
    v_exp_f32 v76, v76
    v_exp_f32 v77, v77
    v_exp_f32 v78, v78
    v_mfma_f32_32x32x16_bf16 v[16:31], v[188:191], v[52:55], v[16:31]
    v_exp_f32 v79, v79
    v_cvt_pk_bf16_f32 v64, v64, v65
    v_cvt_pk_bf16_f32 v65, v66, v67
    v_cvt_pk_bf16_f32 v66, v72, v73
    v_cvt_pk_bf16_f32 v67, v74, v75
    v_cvt_pk_bf16_f32 v68, v68, v69
    v_cvt_pk_bf16_f32 v69, v70, v71
    v_cvt_pk_bf16_f32 v70, v76, v77
    v_cvt_pk_bf16_f32 v71, v78, v79
    v_pk_fma_f32 v[80:81], v[80:81], v[8:9], v[10:11]
    v_pk_fma_f32 v[82:83], v[82:83], v[8:9], v[10:11]
    v_pk_fma_f32 v[84:85], v[84:85], v[8:9], v[10:11]
    v_pk_fma_f32 v[86:87], v[86:87], v[8:9], v[10:11]
    v_pk_fma_f32 v[88:89], v[88:89], v[8:9], v[10:11]
    v_pk_fma_f32 v[90:91], v[90:91], v[8:9], v[10:11]
    v_pk_fma_f32 v[92:93], v[92:93], v[8:9], v[10:11]
    v_pk_fma_f32 v[94:95], v[94:95], v[8:9], v[10:11]
    v_mfma_f32_32x32x16_bf16 v[160:175], v[12:15], v[64:67], v[160:175]
    v_exp_f32 v80, v80
    v_exp_f32 v81, v81
    v_exp_f32 v82, v82
    v_mfma_f32_32x32x16_bf16 v[160:175], v[12:15], v[68:71], v[160:175]
    v_exp_f32 v83, v83
    v_exp_f32 v84, v84
    v_exp_f32 v85, v85
    v_mfma_f32_32x32x16_bf16 v[16:31], v[192:195], v[64:67], v[16:31]
    v_exp_f32 v86, v86
    v_exp_f32 v87, v87
    v_exp_f32 v88, v88
    v_mfma_f32_32x32x16_bf16 v[16:31], v[196:199], v[68:71], v[16:31]
    v_exp_f32 v89, v89
    v_exp_f32 v90, v90
    v_exp_f32 v91, v91
    v_exp_f32 v92, v92
    v_exp_f32 v93, v93
    v_exp_f32 v94, v94
    v_exp_f32 v95, v95
    v_cvt_pk_bf16_f32 v80, v80, v81
    v_cvt_pk_bf16_f32 v81, v82, v83
    v_cvt_pk_bf16_f32 v82, v88, v89
    v_cvt_pk_bf16_f32 v83, v90, v91
    v_cvt_pk_bf16_f32 v84, v84, v85
    v_cvt_pk_bf16_f32 v85, v86, v87
    v_cvt_pk_bf16_f32 v86, v92, v93
    v_cvt_pk_bf16_f32 v87, v94, v95
    v_pk_fma_f32 v[96:97], v[96:97], v[8:9], v[10:11]
    v_pk_fma_f32 v[98:99], v[98:99], v[8:9], v[10:11]
    v_pk_fma_f32 v[100:101], v[100:101], v[8:9], v[10:11]
    v_pk_fma_f32 v[102:103], v[102:103], v[8:9], v[10:11]
    v_pk_fma_f32 v[104:105], v[104:105], v[8:9], v[10:11]
    v_pk_fma_f32 v[106:107], v[106:107], v[8:9], v[10:11]
    v_pk_fma_f32 v[108:109], v[108:109], v[8:9], v[10:11]
    v_pk_fma_f32 v[110:111], v[110:111], v[8:9], v[10:11]
    v_mfma_f32_32x32x16_bf16 v[160:175], v[12:15], v[80:83], v[160:175]
    v_exp_f32 v96, v96
    v_exp_f32 v97, v97
    v_exp_f32 v98, v98
    v_mfma_f32_32x32x16_bf16 v[160:175], v[12:15], v[84:87], v[160:175]
    v_exp_f32 v99, v99
    v_exp_f32 v100, v100
    v_exp_f32 v101, v101
    v_mfma_f32_32x32x16_bf16 v[16:31], v[200:203], v[80:83], v[16:31]
    v_exp_f32 v102, v102
    v_exp_f32 v103, v103
    v_exp_f32 v104, v104
    v_mfma_f32_32x32x16_bf16 v[16:31], v[204:207], v[84:87], v[16:31]
    v_exp_f32 v105, v105
    v_exp_f32 v106, v106
    v_exp_f32 v107, v107
    v_exp_f32 v108, v108
    v_exp_f32 v109, v109
    v_exp_f32 v110, v110
    v_exp_f32 v111, v111
    v_cvt_pk_bf16_f32 v96, v96, v97
    v_cvt_pk_bf16_f32 v97, v98, v99
    v_cvt_pk_bf16_f32 v98, v104, v105
    v_cvt_pk_bf16_f32 v99, v106, v107
    v_cvt_pk_bf16_f32 v100, v100, v101
    v_cvt_pk_bf16_f32 v101, v102, v103
    v_cvt_pk_bf16_f32 v102, v108, v109
    v_cvt_pk_bf16_f32 v103, v110, v111
    v_pk_fma_f32 v[112:113], v[112:113], v[8:9], v[10:11]
    v_pk_fma_f32 v[114:115], v[114:115], v[8:9], v[10:11]
    v_pk_fma_f32 v[116:117], v[116:117], v[8:9], v[10:11]
    v_pk_fma_f32 v[118:119], v[118:119], v[8:9], v[10:11]
    v_pk_fma_f32 v[120:121], v[120:121], v[8:9], v[10:11]
    v_pk_fma_f32 v[122:123], v[122:123], v[8:9], v[10:11]
    v_pk_fma_f32 v[124:125], v[124:125], v[8:9], v[10:11]
    v_pk_fma_f32 v[126:127], v[126:127], v[8:9], v[10:11]
    v_mfma_f32_32x32x16_bf16 v[160:175], v[12:15], v[96:99], v[160:175]
    v_exp_f32 v112, v112
    v_exp_f32 v113, v113
    v_exp_f32 v114, v114
    v_mfma_f32_32x32x16_bf16 v[160:175], v[12:15], v[100:103], v[160:175]
    v_exp_f32 v115, v115
    v_exp_f32 v116, v116
    v_exp_f32 v117, v117
    v_mfma_f32_32x32x16_bf16 v[16:31], v[208:211], v[96:99], v[16:31]
    v_exp_f32 v118, v118
    v_exp_f32 v119, v119
    v_exp_f32 v120, v120
    v_mfma_f32_32x32x16_bf16 v[16:31], v[212:215], v[100:103], v[16:31]
    v_exp_f32 v121, v121
    v_exp_f32 v122, v122
    v_exp_f32 v123, v123
    v_exp_f32 v124, v124
    v_exp_f32 v125, v125
    v_exp_f32 v126, v126
    v_exp_f32 v127, v127
    v_cvt_pk_bf16_f32 v112, v112, v113
    v_cvt_pk_bf16_f32 v113, v114, v115
    v_cvt_pk_bf16_f32 v114, v120, v121
    v_cvt_pk_bf16_f32 v115, v122, v123
    v_cvt_pk_bf16_f32 v116, v116, v117
    v_cvt_pk_bf16_f32 v117, v118, v119
    v_cvt_pk_bf16_f32 v118, v124, v125
    v_cvt_pk_bf16_f32 v119, v126, v127
    v_pk_fma_f32 v[128:129], v[128:129], v[8:9], v[10:11]
    v_pk_fma_f32 v[130:131], v[130:131], v[8:9], v[10:11]
    v_pk_fma_f32 v[132:133], v[132:133], v[8:9], v[10:11]
    v_pk_fma_f32 v[134:135], v[134:135], v[8:9], v[10:11]
    v_pk_fma_f32 v[136:137], v[136:137], v[8:9], v[10:11]
    v_pk_fma_f32 v[138:139], v[138:139], v[8:9], v[10:11]
    v_pk_fma_f32 v[140:141], v[140:141], v[8:9], v[10:11]
    v_pk_fma_f32 v[142:143], v[142:143], v[8:9], v[10:11]
    v_mfma_f32_32x32x16_bf16 v[160:175], v[12:15], v[112:115], v[160:175]
    v_exp_f32 v128, v128
    v_exp_f32 v129, v129
    v_exp_f32 v130, v130
    v_mfma_f32_32x32x16_bf16 v[160:175], v[12:15], v[116:119], v[160:175]
    v_exp_f32 v131, v131
    v_exp_f32 v132, v132
    v_exp_f32 v133, v133
    v_mfma_f32_32x32x16_bf16 v[16:31], v[216:219], v[112:115], v[16:31]
    v_exp_f32 v134, v134
    v_exp_f32 v135, v135
    v_exp_f32 v136, v136
    v_mfma_f32_32x32x16_bf16 v[16:31], v[220:223], v[116:119], v[16:31]
    v_exp_f32 v137, v137
    v_exp_f32 v138, v138
    v_exp_f32 v139, v139
    v_exp_f32 v140, v140
    v_exp_f32 v141, v141
    v_exp_f32 v142, v142
    v_exp_f32 v143, v143
    v_cvt_pk_bf16_f32 v128, v128, v129
    v_cvt_pk_bf16_f32 v129, v130, v131
    v_cvt_pk_bf16_f32 v130, v136, v137
    v_cvt_pk_bf16_f32 v131, v138, v139
    v_cvt_pk_bf16_f32 v132, v132, v133
    v_cvt_pk_bf16_f32 v133, v134, v135
    v_cvt_pk_bf16_f32 v134, v140, v141
    v_cvt_pk_bf16_f32 v135, v142, v143
    v_pk_fma_f32 v[144:145], v[144:145], v[8:9], v[10:11]
    v_pk_fma_f32 v[146:147], v[146:147], v[8:9], v[10:11]
    v_pk_fma_f32 v[148:149], v[148:149], v[8:9], v[10:11]
    v_pk_fma_f32 v[150:151], v[150:151], v[8:9], v[10:11]
    v_pk_fma_f32 v[152:153], v[152:153], v[8:9], v[10:11]
    v_pk_fma_f32 v[154:155], v[154:155], v[8:9], v[10:11]
    v_pk_fma_f32 v[156:157], v[156:157], v[8:9], v[10:11]
    v_pk_fma_f32 v[158:159], v[158:159], v[8:9], v[10:11]
    v_mfma_f32_32x32x16_bf16 v[160:175], v[12:15], v[128:131], v[160:175]
    v_exp_f32 v144, v144
    v_exp_f32 v145, v145
    v_exp_f32 v146, v146
    v_mfma_f32_32x32x16_bf16 v[160:175], v[12:15], v[132:135], v[160:175]
    v_exp_f32 v147, v147
    v_exp_f32 v148, v148
    v_exp_f32 v149, v149
    v_mfma_f32_32x32x16_bf16 v[16:31], v[224:227], v[128:131], v[16:31]
    v_exp_f32 v150, v150
    v_exp_f32 v151, v151
    v_exp_f32 v152, v152
    v_mfma_f32_32x32x16_bf16 v[16:31], v[228:231], v[132:135], v[16:31]
    v_exp_f32 v153, v153
    v_exp_f32 v154, v154
    v_exp_f32 v155, v155
    v_exp_f32 v156, v156
    v_exp_f32 v157, v157
    v_exp_f32 v158, v158
    v_exp_f32 v159, v159
    v_cvt_pk_bf16_f32 v144, v144, v145
    v_cvt_pk_bf16_f32 v145, v146, v147
    v_cvt_pk_bf16_f32 v146, v152, v153
    v_cvt_pk_bf16_f32 v147, v154, v155
    v_cvt_pk_bf16_f32 v148, v148, v149
    v_cvt_pk_bf16_f32 v149, v150, v151
    v_cvt_pk_bf16_f32 v150, v156, v157
    v_cvt_pk_bf16_f32 v151, v158, v159
    v_mfma_f32_32x32x16_bf16 v[160:175], v[12:15], v[144:147], v[160:175]
    s_nop 0
    v_mfma_f32_32x32x16_bf16 v[160:175], v[12:15], v[148:151], v[160:175]
    v_mfma_f32_32x32x16_bf16 v[16:31], v[232:235], v[144:147], v[16:31]
    v_mfma_f32_32x32x16_bf16 v[16:31], v[236:239], v[148:151], v[16:31]
    s_add_u32 s16, s4, 16777216
    s_addc_u32 s17, s5, 0
    s_mov_b32 s18, 4194304
    s_mov_b32 s19, 0x20000
    s_lshl_b32 s30, s24, 18
    s_lshl_b32 s31, s25, 14
    s_add_u32 s30, s30, s31
    s_lshl_b32 s31, s34, 13
    s_add_u32 s30, s30, s31
    s_lshl_b32 s31, s35, 11
    s_add_u32 s30, s30, s31
    v_rcp_f32 v248, v160
    v_rcp_f32 v249, v160
    s_nop 0
    v_pk_mul_f32 v[16:17], v[16:17], v[248:249]
    v_pk_mul_f32 v[18:19], v[18:19], v[248:249]
    v_pk_mul_f32 v[20:21], v[20:21], v[248:249]
    v_pk_mul_f32 v[22:23], v[22:23], v[248:249]
    v_pk_mul_f32 v[24:25], v[24:25], v[248:249]
    v_pk_mul_f32 v[26:27], v[26:27], v[248:249]
    v_pk_mul_f32 v[28:29], v[28:29], v[248:249]
    v_pk_mul_f32 v[30:31], v[30:31], v[248:249]
    v_cvt_pk_bf16_f32 v16, v16, v17
    v_cvt_pk_bf16_f32 v17, v18, v19
    v_cvt_pk_bf16_f32 v18, v24, v25
    v_cvt_pk_bf16_f32 v19, v26, v27
    v_cvt_pk_bf16_f32 v20, v20, v21
    v_cvt_pk_bf16_f32 v21, v22, v23
    v_cvt_pk_bf16_f32 v22, v28, v29
    v_cvt_pk_bf16_f32 v23, v30, v31
    buffer_store_dwordx4 v[16:19], v2, s[16:19], s30 offen sc0 sc1
    buffer_store_dwordx4 v[20:23], v2, s[16:19], s30 offen offset:512 sc0 sc1
    s_lshl_b32 s40, s24, 10
    s_lshl_b32 s41, s25, 6
    s_add_u32 s40, s40, s41
    s_lshl_b32 s41, s3, 3
    s_add_u32 s40, s40, s41
    s_add_u32 s40, s40, 16384
    v_mov_b32 v32, s72
    v_mov_b32 v33, s73
    v_mov_b32 v34, 0
    s_waitcnt vmcnt(0)
    s_mov_b64 exec, 1
    buffer_store_dwordx2 v[32:33], v34, s[76:79], s40 offen sc0 sc1
    s_mov_b64 exec, -1
    s_barrier
    s_cmp_ge_u32 s3, 4
    s_cbranch_scc1 L_prod2
    v_lshrrev_b32 v72, 4, v1
    v_bfe_u32 v73, v1, 2, 2
    v_mul_u32_u24 v74, 4, v72
    v_add_u32 v74, v74, v73
    v_mul_u32_u24 v74, 448, v74
    v_and_b32 v75, 3, v1
    v_lshl_add_u32 v74, v75, 3, v74
    v_and_b32 v72, 1, v72
    s_lshl_b32 s71, s3, 7
    s_add_u32 s71, s71, 81920
    v_add_u32 v74, s71, v74
    v_xor_b32 v75, 0, v72
    v_lshl_add_u32 v32, v75, 5, v74
    v_xor_b32 v75, 1, v72
    v_lshl_add_u32 v33, v75, 5, v74
    v_xor_b32 v75, 2, v72
    v_lshl_add_u32 v34, v75, 5, v74
    v_xor_b32 v75, 3, v72
    v_lshl_add_u32 v35, v75, 5, v74
    ds_read_b64_tr_b16 v[40:41], v32 offset:0
    ds_read_b64_tr_b16 v[42:43], v33 offset:0
    ds_read_b64_tr_b16 v[44:45], v34 offset:0
    ds_read_b64_tr_b16 v[46:47], v35 offset:0
    ds_read_b64_tr_b16 v[48:49], v32 offset:7168
    ds_read_b64_tr_b16 v[50:51], v33 offset:7168
    ds_read_b64_tr_b16 v[52:53], v34 offset:7168
    ds_read_b64_tr_b16 v[54:55], v35 offset:7168
    ds_read_b64_tr_b16 v[56:57], v32 offset:14336
    ds_read_b64_tr_b16 v[58:59], v33 offset:14336
    ds_read_b64_tr_b16 v[60:61], v34 offset:14336
    ds_read_b64_tr_b16 v[62:63], v35 offset:14336
    ds_read_b64_tr_b16 v[64:65], v32 offset:21504
    ds_read_b64_tr_b16 v[66:67], v33 offset:21504
    ds_read_b64_tr_b16 v[68:69], v34 offset:21504
    ds_read_b64_tr_b16 v[70:71], v35 offset:21504
    v_mov_b32 v36, 0
    v_mov_b32 v37, 0
    v_mov_b32 v38, 0
    v_mov_b32 v39, 0
    s_add_u32 s16, s4, 44564480
    s_addc_u32 s17, s5, 0
    s_mov_b32 s18, 524288
    s_mov_b32 s19, 0x20000
    s_mov_b32 s75, 0x3f803f80
    v_lshlrev_b32 v72, 3, v1
    s_lshl_b32 s71, s25, 15
    s_lshl_b32 s31, s24, 11
    s_add_u32 s71, s71, s31
    s_lshl_b32 s31, s3, 9
    s_add_u32 s71, s71, s31
    s_waitcnt lgkmcnt(12)
    v_dot2c_f32_bf16 v36, s75, v40
    v_dot2c_f32_bf16 v37, s75, v42
    v_dot2c_f32_bf16 v38, s75, v44
    v_dot2c_f32_bf16 v39, s75, v46
    v_dot2c_f32_bf16 v36, s75, v41
    v_dot2c_f32_bf16 v37, s75, v43
    v_dot2c_f32_bf16 v38, s75, v45
    v_dot2c_f32_bf16 v39, s75, v47
    s_waitcnt lgkmcnt(8)
    v_dot2c_f32_bf16 v36, s75, v48
    v_dot2c_f32_bf16 v37, s75, v50
    v_dot2c_f32_bf16 v38, s75, v52
    v_dot2c_f32_bf16 v39, s75, v54
    v_dot2c_f32_bf16 v36, s75, v49
    v_dot2c_f32_bf16 v37, s75, v51
    v_dot2c_f32_bf16 v38, s75, v53
    v_dot2c_f32_bf16 v39, s75, v55
    s_waitcnt lgkmcnt(4)
    v_dot2c_f32_bf16 v36, s75, v56
    v_dot2c_f32_bf16 v37, s75, v58
    v_dot2c_f32_bf16 v38, s75, v60
    v_dot2c_f32_bf16 v39, s75, v62
    v_dot2c_f32_bf16 v36, s75, v57
    v_dot2c_f32_bf16 v37, s75, v59
    v_dot2c_f32_bf16 v38, s75, v61
    v_dot2c_f32_bf16 v39, s75, v63
    s_waitcnt lgkmcnt(0)
    v_dot2c_f32_bf16 v36, s75, v64
    v_dot2c_f32_bf16 v37, s75, v66
    v_dot2c_f32_bf16 v38, s75, v68
    v_dot2c_f32_bf16 v39, s75, v70
    v_dot2c_f32_bf16 v36, s75, v65
    v_dot2c_f32_bf16 v37, s75, v67
    v_dot2c_f32_bf16 v38, s75, v69
    v_dot2c_f32_bf16 v39, s75, v71
    s_nop 1
    v_permlane32_swap_b32 v36, v38
    v_permlane32_swap_b32 v37, v39
    v_add_f32 v36, v36, v38
    v_add_f32 v37, v37, v39
    s_nop 1
    v_permlane16_swap_b32 v36, v37
    v_add_f32 v36, v36, v37
    v_mov_b32 v37, s72
    buffer_store_dwordx2 v[36:37], v72, s[16:19], s71 offen sc0 sc1
    s_and_b32 s30, s2, 7
    s_lshr_b32 s31, s2, 3
    s_lshr_b32 s24, s30, 2
    s_lshl_b32 s24, s24, 3
    s_and_b32 s25, s30, 3
    s_lshl_b32 s25, s25, 2
    s_lshr_b32 s30, s31, 2
    s_add_u32 s24, s24, s30
    s_and_b32 s30, s31, 3
    s_add_u32 s25, s25, s30
    s_lshr_b32 s34, s3, 1
    s_and_b32 s35, s3, 1
    v_lshlrev_b32 v13, 4, v1
    s_lshl_b32 s30, s34, 12
    v_add_u32 v13, s30, v13
    v_lshrrev_b32 v12, 4, v1
    v_bfe_u32 v48, v1, 2, 2
    v_and_b32 v49, 3, v1
    v_mov_b32 v2, v13
    v_mul_u32_u24 v14, 4, v12
    v_add_u32 v14, v14, v48
    v_lshlrev_b32 v14, 7, v14
    v_lshl_add_u32 v14, v49, 3, v14
    v_lshrrev_b32 v15, 1, v48
    v_and_b32 v50, 1, v12
    v_lshl_or_b32 v15, v50, 1, v15
    s_lshl_b32 s30, s35, 1
    v_xor_b32 v15, s30, v15
    v_lshl_add_u32 v4, v15, 5, v14
    v_xor_b32 v15, 1, v15
    v_lshl_add_u32 v5, v15, 5, v14
    s_add_u32 s20, s80, 0
    s_addc_u32 s21, s81, 0
    s_mov_b32 s22, 4194304
    s_mov_b32 s23, 0x20000
    v_and_b32 v14, 15, v1
    v_lshlrev_b32 v14, 11, v14
    v_lshl_add_u32 v14, v12, 3, v14
    s_lshl_b32 s30, s24, 18
    s_lshl_b32 s31, s34, 17
    s_add_u32 s30, s30, s31
    s_lshl_b32 s31, s25, 7
    s_add_u32 s30, s30, s31
    s_lshl_b32 s31, s35, 6
    s_add_u32 s30, s30, s31
    v_and_b32 v14, 15, v1
    v_lshrrev_b32 v15, 1, v14
    v_lshrrev_b32 v48, 1, v12
    s_lshl_b32 s30, s35, 2
    v_add_u32 v48, s30, v48
    v_xor_b32 v15, v15, v48
    v_lshlrev_b32 v15, 4, v15
    v_lshl_add_u32 v15, v14, 7, v15
    v_and_b32 v48, 1, v12
    v_lshl_add_u32 v15, v48, 3, v15
    s_lshl_b32 s30, s34, 13
    s_add_u32 s30, s30, 147456
    v_add_u32 v15, s30, v15
    v_xor_b32 v14, 32, v15
    ds_read_b64 v[144:145], v15 offset:0
    ds_read_b64 v[146:147], v14 offset:0
    ds_read_b64 v[148:149], v15 offset:2048
    ds_read_b64 v[150:151], v14 offset:2048
    ds_read_b64 v[152:153], v15 offset:4096
    ds_read_b64 v[154:155], v14 offset:4096
    ds_read_b64 v[156:157], v15 offset:6144
    ds_read_b64 v[158:159], v14 offset:6144
    v_mov_b32 v16, 0
    v_mov_b32 v17, 0
    v_mov_b32 v18, 0
    v_mov_b32 v19, 0
    v_mov_b32 v20, 0
    v_mov_b32 v21, 0
    v_mov_b32 v22, 0
    v_mov_b32 v23, 0
    v_mov_b32 v24, 0
    v_mov_b32 v25, 0
    v_mov_b32 v26, 0
    v_mov_b32 v27, 0
    v_mov_b32 v28, 0
    v_mov_b32 v29, 0
    v_mov_b32 v30, 0
    v_mov_b32 v31, 0
    v_mov_b32 v32, 0
    v_mov_b32 v33, 0
    v_mov_b32 v34, 0
    v_mov_b32 v35, 0
    v_mov_b32 v36, 0
    v_mov_b32 v37, 0
    v_mov_b32 v38, 0
    v_mov_b32 v39, 0
    v_mov_b32 v40, 0
    v_mov_b32 v41, 0
    v_mov_b32 v42, 0
    v_mov_b32 v43, 0
    v_mov_b32 v44, 0
    v_mov_b32 v45, 0
    v_mov_b32 v46, 0
    v_mov_b32 v47, 0
    s_mov_b32 s27, 0
    s_mov_b32 s32, 114688
    v_add_u32 v7, s27, v2
    v_add_u32 v9, s32, v4
    v_add_u32 v10, s32, v5
    s_mov_b32 s26, 16
    s_barrier
    s_mov_b32 s26, 8
    ds_read_b64_tr_b16 v[64:65], v9 offset:0
    ds_read_b64_tr_b16 v[66:67], v9 offset:2048
    ds_read_b128 v[48:51], v7 offset:0
    ds_read_b128 v[52:55], v7 offset:1024
    ds_read_b128 v[56:59], v7 offset:2048
    ds_read_b128 v[60:63], v7 offset:3072
    ds_read_b64_tr_b16 v[68:69], v10 offset:0
    ds_read_b64_tr_b16 v[70:71], v10 offset:2048
    ds_read_b64_tr_b16 v[88:89], v9 offset:4096
    ds_read_b64_tr_b16 v[90:91], v9 offset:6144
    ds_read_b128 v[72:75], v7 offset:8192
    ds_read_b128 v[76:79], v7 offset:9216
    ds_read_b128 v[80:83], v7 offset:10240
    ds_read_b128 v[84:87], v7 offset:11264
    ds_read_b64_tr_b16 v[92:93], v10 offset:4096
    ds_read_b64_tr_b16 v[94:95], v10 offset:6144
    s_add_u32 s27, s27, 16384
    s_add_u32 s32, s32, 8192
    s_cmp_eq_u32 s27, 65536
    s_cselect_b32 s27, 0, s27
    s_cselect_b32 s32, 114688, s32
    v_add_u32 v7, s27, v2
    v_add_u32 v9, s32, v4
    v_add_u32 v10, s32, v5
c_loop_15:
    s_waitcnt lgkmcnt(0)
    s_barrier
    v_mfma_f32_16x16x32_bf16 v[16:19], v[64:67], v[48:51], v[16:19]
    ds_read_b64_tr_b16 v[112:113], v9 offset:0
    ds_read_b64_tr_b16 v[114:115], v9 offset:2048
    v_mfma_f32_16x16x32_bf16 v[20:23], v[64:67], v[52:55], v[20:23]
    ds_read_b128 v[96:99], v7 offset:0
    ds_read_b128 v[100:103], v7 offset:1024
    v_mfma_f32_16x16x32_bf16 v[24:27], v[64:67], v[56:59], v[24:27]
    ds_read_b128 v[104:107], v7 offset:2048
    ds_read_b128 v[108:111], v7 offset:3072
    v_mfma_f32_16x16x32_bf16 v[28:31], v[64:67], v[60:63], v[28:31]
    ds_read_b64_tr_b16 v[116:117], v10 offset:0
    ds_read_b64_tr_b16 v[118:119], v10 offset:2048
    v_mfma_f32_16x16x32_bf16 v[44:47], v[68:71], v[60:63], v[44:47]
    ds_read_b64_tr_b16 v[136:137], v9 offset:4096
    ds_read_b64_tr_b16 v[138:139], v9 offset:6144
    v_mfma_f32_16x16x32_bf16 v[40:43], v[68:71], v[56:59], v[40:43]
    ds_read_b128 v[120:123], v7 offset:8192
    ds_read_b128 v[124:127], v7 offset:9216
    v_mfma_f32_16x16x32_bf16 v[36:39], v[68:71], v[52:55], v[36:39]
    ds_read_b128 v[128:131], v7 offset:10240
    ds_read_b128 v[132:135], v7 offset:11264
    v_mfma_f32_16x16x32_bf16 v[32:35], v[68:71], v[48:51], v[32:35]
    ds_read_b64_tr_b16 v[140:141], v10 offset:4096
    ds_read_b64_tr_b16 v[142:143], v10 offset:6144
    v_mfma_f32_16x16x32_bf16 v[16:19], v[88:91], v[72:75], v[16:19]
    s_add_u32 s27, s27, 16384
    s_add_u32 s32, s32, 8192
    v_mfma_f32_16x16x32_bf16 v[20:23], v[88:91], v[76:79], v[20:23]
    s_cmp_eq_u32 s27, 65536
    s_cselect_b32 s27, 0, s27
    v_mfma_f32_16x16x32_bf16 v[24:27], v[88:91], v[80:83], v[24:27]
    s_cselect_b32 s32, 114688, s32
    v_add_u32 v7, s27, v2
    v_mfma_f32_16x16x32_bf16 v[28:31], v[88:91], v[84:87], v[28:31]
    v_add_u32 v9, s32, v4
    v_add_u32 v10, s32, v5
    v_mfma_f32_16x16x32_bf16 v[44:47], v[92:95], v[84:87], v[44:47]
    v_mfma_f32_16x16x32_bf16 v[40:43], v[92:95], v[80:83], v[40:43]
    v_mfma_f32_16x16x32_bf16 v[36:39], v[92:95], v[76:79], v[36:39]
    v_mfma_f32_16x16x32_bf16 v[32:35], v[92:95], v[72:75], v[32:35]
    s_waitcnt lgkmcnt(0)
    s_barrier
    v_mfma_f32_16x16x32_bf16 v[16:19], v[112:115], v[96:99], v[16:19]
    ds_read_b64_tr_b16 v[64:65], v9 offset:0
    ds_read_b64_tr_b16 v[66:67], v9 offset:2048
    v_mfma_f32_16x16x32_bf16 v[20:23], v[112:115], v[100:103], v[20:23]
    ds_read_b128 v[48:51], v7 offset:0
    ds_read_b128 v[52:55], v7 offset:1024
    v_mfma_f32_16x16x32_bf16 v[24:27], v[112:115], v[104:107], v[24:27]
    ds_read_b128 v[56:59], v7 offset:2048
    ds_read_b128 v[60:63], v7 offset:3072
    v_mfma_f32_16x16x32_bf16 v[28:31], v[112:115], v[108:111], v[28:31]
    ds_read_b64_tr_b16 v[68:69], v10 offset:0
    ds_read_b64_tr_b16 v[70:71], v10 offset:2048
    v_mfma_f32_16x16x32_bf16 v[44:47], v[116:119], v[108:111], v[44:47]
    ds_read_b64_tr_b16 v[88:89], v9 offset:4096
    ds_read_b64_tr_b16 v[90:91], v9 offset:6144
    v_mfma_f32_16x16x32_bf16 v[40:43], v[116:119], v[104:107], v[40:43]
    ds_read_b128 v[72:75], v7 offset:8192
    ds_read_b128 v[76:79], v7 offset:9216
    v_mfma_f32_16x16x32_bf16 v[36:39], v[116:119], v[100:103], v[36:39]
    ds_read_b128 v[80:83], v7 offset:10240
    ds_read_b128 v[84:87], v7 offset:11264
    v_mfma_f32_16x16x32_bf16 v[32:35], v[116:119], v[96:99], v[32:35]
    ds_read_b64_tr_b16 v[92:93], v10 offset:4096
    ds_read_b64_tr_b16 v[94:95], v10 offset:6144
    v_mfma_f32_16x16x32_bf16 v[16:19], v[136:139], v[120:123], v[16:19]
    s_add_u32 s27, s27, 16384
    s_add_u32 s32, s32, 8192
    v_mfma_f32_16x16x32_bf16 v[20:23], v[136:139], v[124:127], v[20:23]
    s_cmp_eq_u32 s27, 65536
    s_cselect_b32 s27, 0, s27
    v_mfma_f32_16x16x32_bf16 v[24:27], v[136:139], v[128:131], v[24:27]
    s_cselect_b32 s32, 114688, s32
    v_add_u32 v7, s27, v2
    v_mfma_f32_16x16x32_bf16 v[28:31], v[136:139], v[132:135], v[28:31]
    v_add_u32 v9, s32, v4
    v_add_u32 v10, s32, v5
    v_mfma_f32_16x16x32_bf16 v[44:47], v[140:143], v[132:135], v[44:47]
    s_sub_u32 s26, s26, 1
    s_cmp_lg_u32 s26, 0
    v_mfma_f32_16x16x32_bf16 v[40:43], v[140:143], v[128:131], v[40:43]
    v_mfma_f32_16x16x32_bf16 v[36:39], v[140:143], v[124:127], v[36:39]
    v_mfma_f32_16x16x32_bf16 v[32:35], v[140:143], v[120:123], v[32:35]
    s_cbranch_scc1 c_loop_15
    s_waitcnt lgkmcnt(0)
    s_add_u32 s16, s4, 20971520
    s_addc_u32 s17, s5, 0
    s_mov_b32 s18, 4194304
    s_mov_b32 s19, 0x20000
    s_lshl_b32 s30, s24, 18
    s_lshl_b32 s31, s25, 14
    s_add_u32 s30, s30, s31
    s_lshl_b32 s31, s35, 13
    s_add_u32 s30, s30, s31
    s_mov_b32 s36, 0xffff0000
    s_waitcnt vmcnt(0) lgkmcnt(0)
    v_lshlrev_b32 v48, 16, v144
    v_and_b32 v49, s36, v144
    v_pk_add_f32 v[16:17], v[16:17], v[48:49]
    v_lshlrev_b32 v48, 16, v145
    v_and_b32 v49, s36, v145
    v_pk_add_f32 v[18:19], v[18:19], v[48:49]
    v_lshlrev_b32 v48, 16, v146
    v_and_b32 v49, s36, v146
    v_pk_add_f32 v[32:33], v[32:33], v[48:49]
    v_lshlrev_b32 v48, 16, v147
    v_and_b32 v49, s36, v147
    v_pk_add_f32 v[34:35], v[34:35], v[48:49]
    v_cvt_pk_bf16_f32 v232, v16, v17
    v_cvt_pk_bf16_f32 v233, v18, v19
    v_cvt_pk_bf16_f32 v234, v32, v33
    v_cvt_pk_bf16_f32 v235, v34, v35
    buffer_store_dwordx4 v[232:235], v13, s[16:19], s30 offen offset:0 sc0 sc1
    s_lshl_b32 s33, s35, 13
    v_add_u32 v7, s33, v13
    ds_write_b128 v7, v[232:235] offset:0
    v_lshlrev_b32 v48, 16, v148
    v_and_b32 v49, s36, v148
    v_pk_add_f32 v[20:21], v[20:21], v[48:49]
    v_lshlrev_b32 v48, 16, v149
    v_and_b32 v49, s36, v149
    v_pk_add_f32 v[22:23], v[22:23], v[48:49]
    v_lshlrev_b32 v48, 16, v150
    v_and_b32 v49, s36, v150
    v_pk_add_f32 v[36:37], v[36:37], v[48:49]
    v_lshlrev_b32 v48, 16, v151
    v_and_b32 v49, s36, v151
    v_pk_add_f32 v[38:39], v[38:39], v[48:49]
    v_cvt_pk_bf16_f32 v236, v20, v21
    v_cvt_pk_bf16_f32 v237, v22, v23
    v_cvt_pk_bf16_f32 v238, v36, v37
    v_cvt_pk_bf16_f32 v239, v38, v39
    buffer_store_dwordx4 v[236:239], v13, s[16:19], s30 offen offset:1024 sc0 sc1
    ds_write_b128 v7, v[236:239] offset:1024
    v_lshlrev_b32 v48, 16, v152
    v_and_b32 v49, s36, v152
    v_pk_add_f32 v[24:25], v[24:25], v[48:49]
    v_lshlrev_b32 v48, 16, v153
    v_and_b32 v49, s36, v153
    v_pk_add_f32 v[26:27], v[26:27], v[48:49]
    v_lshlrev_b32 v48, 16, v154
    v_and_b32 v49, s36, v154
    v_pk_add_f32 v[40:41], v[40:41], v[48:49]
    v_lshlrev_b32 v48, 16, v155
    v_and_b32 v49, s36, v155
    v_pk_add_f32 v[42:43], v[42:43], v[48:49]
    v_cvt_pk_bf16_f32 v240, v24, v25
    v_cvt_pk_bf16_f32 v241, v26, v27
    v_cvt_pk_bf16_f32 v242, v40, v41
    v_cvt_pk_bf16_f32 v243, v42, v43
    buffer_store_dwordx4 v[240:243], v13, s[16:19], s30 offen offset:2048 sc0 sc1
    ds_write_b128 v7, v[240:243] offset:2048
    v_lshlrev_b32 v48, 16, v156
    v_and_b32 v49, s36, v156
    v_pk_add_f32 v[28:29], v[28:29], v[48:49]
    v_lshlrev_b32 v48, 16, v157
    v_and_b32 v49, s36, v157
    v_pk_add_f32 v[30:31], v[30:31], v[48:49]
    v_lshlrev_b32 v48, 16, v158
    v_and_b32 v49, s36, v158
    v_pk_add_f32 v[44:45], v[44:45], v[48:49]
    v_lshlrev_b32 v48, 16, v159
    v_and_b32 v49, s36, v159
    v_pk_add_f32 v[46:47], v[46:47], v[48:49]
    v_cvt_pk_bf16_f32 v244, v28, v29
    v_cvt_pk_bf16_f32 v245, v30, v31
    v_cvt_pk_bf16_f32 v246, v44, v45
    v_cvt_pk_bf16_f32 v247, v46, v47
    buffer_store_dwordx4 v[244:247], v13, s[16:19], s30 offen offset:3072 sc0 sc1
    ds_write_b128 v7, v[244:247] offset:3072
    v_pk_add_f32 v[48:49], v[16:17], v[18:19]
    v_pk_mul_f32 v[50:51], v[16:17], v[16:17]
    v_pk_add_f32 v[48:49], v[48:49], v[32:33]
    v_pk_fma_f32 v[50:51], v[18:19], v[18:19], v[50:51]
    v_pk_add_f32 v[48:49], v[48:49], v[34:35]
    v_pk_fma_f32 v[50:51], v[32:33], v[32:33], v[50:51]
    v_pk_fma_f32 v[50:51], v[34:35], v[34:35], v[50:51]
    v_add_f32 v52, v48, v49
    v_add_f32 v53, v50, v51
    v_pk_add_f32 v[48:49], v[20:21], v[22:23]
    v_pk_mul_f32 v[50:51], v[20:21], v[20:21]
    v_pk_add_f32 v[48:49], v[48:49], v[36:37]
    v_pk_fma_f32 v[50:51], v[22:23], v[22:23], v[50:51]
    v_pk_add_f32 v[48:49], v[48:49], v[38:39]
    v_pk_fma_f32 v[50:51], v[36:37], v[36:37], v[50:51]
    v_pk_fma_f32 v[50:51], v[38:39], v[38:39], v[50:51]
    v_add_f32 v54, v48, v49
    v_add_f32 v55, v50, v51
    v_pk_add_f32 v[48:49], v[24:25], v[26:27]
    v_pk_mul_f32 v[50:51], v[24:25], v[24:25]
    v_pk_add_f32 v[48:49], v[48:49], v[40:41]
    v_pk_fma_f32 v[50:51], v[26:27], v[26:27], v[50:51]
    v_pk_add_f32 v[48:49], v[48:49], v[42:43]
    v_pk_fma_f32 v[50:51], v[40:41], v[40:41], v[50:51]
    v_pk_fma_f32 v[50:51], v[42:43], v[42:43], v[50:51]
    v_add_f32 v56, v48, v49
    v_add_f32 v57, v50, v51
    v_pk_add_f32 v[48:49], v[28:29], v[30:31]
    v_pk_mul_f32 v[50:51], v[28:29], v[28:29]
    v_pk_add_f32 v[48:49], v[48:49], v[44:45]
    v_pk_fma_f32 v[50:51], v[30:31], v[30:31], v[50:51]
    v_pk_add_f32 v[48:49], v[48:49], v[46:47]
    v_pk_fma_f32 v[50:51], v[44:45], v[44:45], v[50:51]
    v_pk_fma_f32 v[50:51], v[46:47], v[46:47], v[50:51]
    v_add_f32 v58, v48, v49
    v_add_f32 v59, v50, v51
    v_permlane32_swap_b32 v52, v53
    v_add_f32 v52, v52, v53
    v_permlane32_swap_b32 v54, v55
    v_add_f32 v54, v54, v55
    v_permlane32_swap_b32 v56, v57
    v_add_f32 v56, v56, v57
    v_permlane32_swap_b32 v58, v59
    v_add_f32 v58, v58, v59
    s_add_u32 s20, s4, 45088768
    s_addc_u32 s21, s5, 0
    s_mov_b32 s22, 524288
    s_mov_b32 s23, 0x20000
    v_and_b32 v14, 31, v1
    v_lshlrev_b32 v14, 2, v14
    v_lshrrev_b32 v15, 5, v1
    v_lshl_add_u32 v14, v15, 9, v14
    s_lshl_b32 s30, s24, 15
    s_lshl_b32 s31, s25, 11
    s_add_u32 s30, s30, s31
    s_lshl_b32 s31, s35, 10
    s_add_u32 s30, s30, s31
    s_lshl_b32 s31, s34, 8
    s_add_u32 s30, s30, s31
    v_permlane16_swap_b32 v52, v54
    v_add_f32 v52, v52, v54
    buffer_store_dword v52, v14, s[20:23], s30 offen offset:0 sc0 sc1
    v_permlane16_swap_b32 v56, v58
    v_add_f32 v56, v56, v58
    buffer_store_dword v56, v14, s[20:23], s30 offen offset:128 sc0 sc1
    s_lshl_b32 s40, s24, 10
    s_lshl_b32 s41, s25, 5
    s_add_u32 s40, s40, s41
    s_lshl_b32 s41, s3, 3
    s_add_u32 s40, s40, s41
    s_add_u32 s40, s40, 32768
    v_mov_b32 v48, s72
    v_mov_b32 v49, s73
    v_mov_b32 v50, 0
    s_waitcnt vmcnt(0)
    s_mov_b64 exec, 1
    buffer_store_dwordx2 v[48:49], v50, s[76:79], s40 offen sc0 sc1
    s_mov_b64 exec, -1
    s_waitcnt lgkmcnt(0)
    s_and_b32 s30, s2, 7
    s_lshr_b32 s31, s2, 3
    s_lshr_b32 s24, s30, 2
    s_lshl_b32 s24, s24, 3
    s_and_b32 s25, s30, 3
    s_lshl_b32 s25, s25, 2
    s_lshr_b32 s30, s31, 2
    s_add_u32 s24, s24, s30
    s_and_b32 s30, s31, 3
    s_add_u32 s25, s25, s30
    s_lshr_b32 s34, s3, 1
    s_and_b32 s35, s3, 1
    v_lshlrev_b32 v13, 4, v1
    s_lshl_b32 s30, s34, 12
    v_add_u32 v13, s30, v13
    v_lshrrev_b32 v12, 4, v1
    v_bfe_u32 v128, v1, 2, 2
    v_and_b32 v129, 3, v1
    v_mov_b32 v2, v13
    v_mul_u32_u24 v14, 4, v12
    v_add_u32 v14, v14, v128
    v_mul_u32_u24 v14, 448, v14
    v_lshl_add_u32 v14, v129, 3, v14
    v_and_b32 v15, 1, v12
    v_lshlrev_b32 v130, 5, v15
    s_lshl_b32 s30, s35, 8
    v_add_u32 v131, s30, v14
    v_add_u32 v4, v131, v130
    v_sub_u32 v5, v131, v130
    s_add_u32 s30, s35, 6
    v_xor_b32 v15, s30, v15
    v_lshl_add_u32 v6, v15, 5, v14
    v_mov_b32 v16, 0
    v_mov_b32 v17, 0
    v_mov_b32 v18, 0
    v_mov_b32 v19, 0
    v_mov_b32 v20, 0
    v_mov_b32 v21, 0
    v_mov_b32 v22, 0
    v_mov_b32 v23, 0
    v_mov_b32 v24, 0
    v_mov_b32 v25, 0
    v_mov_b32 v26, 0
    v_mov_b32 v27, 0
    v_mov_b32 v28, 0
    v_mov_b32 v29, 0
    v_mov_b32 v30, 0
    v_mov_b32 v31, 0
    v_mov_b32 v32, 0
    v_mov_b32 v33, 0
    v_mov_b32 v34, 0
    v_mov_b32 v35, 0
    v_mov_b32 v36, 0
    v_mov_b32 v37, 0
    v_mov_b32 v38, 0
    v_mov_b32 v39, 0
    v_mov_b32 v40, 0
    v_mov_b32 v41, 0
    v_mov_b32 v42, 0
    v_mov_b32 v43, 0
    v_mov_b32 v44, 0
    v_mov_b32 v45, 0
    v_mov_b32 v46, 0
    v_mov_b32 v47, 0
    v_mov_b32 v48, 0
    v_mov_b32 v49, 0
    v_mov_b32 v50, 0
    v_mov_b32 v51, 0
    v_mov_b32 v52, 0
    v_mov_b32 v53, 0
    v_mov_b32 v54, 0
    v_mov_b32 v55, 0
    v_mov_b32 v56, 0
    v_mov_b32 v57, 0
    v_mov_b32 v58, 0
    v_mov_b32 v59, 0
    v_mov_b32 v60, 0
    v_mov_b32 v61, 0
    v_mov_b32 v62, 0
    v_mov_b32 v63, 0
    v_mov_b32 v64, 0
    v_mov_b32 v65, 0
    v_mov_b32 v66, 0
    v_mov_b32 v67, 0
    v_mov_b32 v68, 0
    v_mov_b32 v69, 0
    v_mov_b32 v70, 0
    v_mov_b32 v71, 0
    v_mov_b32 v72, 0
    v_mov_b32 v73, 0
    v_mov_b32 v74, 0
    v_mov_b32 v75, 0
    v_mov_b32 v76, 0
    v_mov_b32 v77, 0
    v_mov_b32 v78, 0
    v_mov_b32 v79, 0
    v_mov_b32 v80, 0
    v_mov_b32 v81, 0
    v_mov_b32 v82, 0
    v_mov_b32 v83, 0
    v_mov_b32 v84, 0
    v_mov_b32 v85, 0
    v_mov_b32 v86, 0
    v_mov_b32 v87, 0
    v_mov_b32 v88, 0
    v_mov_b32 v89, 0
    v_mov_b32 v90, 0
    v_mov_b32 v91, 0
    v_mov_b32 v92, 0
    v_mov_b32 v93, 0
    v_mov_b32 v94, 0
    v_mov_b32 v95, 0
    v_mov_b32 v96, 0
    v_mov_b32 v97, 0
    v_mov_b32 v98, 0
    v_mov_b32 v99, 0
    v_mov_b32 v100, 0
    v_mov_b32 v101, 0
    v_mov_b32 v102, 0
    v_mov_b32 v103, 0
    v_mov_b32 v104, 0
    v_mov_b32 v105, 0
    v_mov_b32 v106, 0
    v_mov_b32 v107, 0
    v_mov_b32 v108, 0
    v_mov_b32 v109, 0
    v_mov_b32 v110, 0
    v_mov_b32 v111, 0
    v_mov_b32 v112, 0
    v_mov_b32 v113, 0
    v_mov_b32 v114, 0
    v_mov_b32 v115, 0
    v_mov_b32 v116, 0
    v_mov_b32 v117, 0
    v_mov_b32 v118, 0
    v_mov_b32 v119, 0
    v_mov_b32 v120, 0
    v_mov_b32 v121, 0
    v_mov_b32 v122, 0
    v_mov_b32 v123, 0
    v_mov_b32 v124, 0
    v_mov_b32 v125, 0
    v_mov_b32 v126, 0
    v_mov_b32 v127, 0
    s_mov_b32 s27, 0
    s_mov_b32 s32, 49152
    v_add_u32 v7, s27, v2
    v_add_u32 v9, s32, v4
    v_add_u32 v10, s32, v5
    v_add_u32 v11, s32, v6
    s_mov_b32 s26, 15
    s_barrier
    ds_read_b64_tr_b16 v[144:145], v9 offset:0
    ds_read_b64_tr_b16 v[146:147], v9 offset:7168
    ds_read_b128 v[128:131], v7 offset:0
    ds_read_b128 v[132:135], v7 offset:1024
    ds_read_b128 v[136:139], v7 offset:2048
    ds_read_b128 v[140:143], v7 offset:3072
    ds_read_b64_tr_b16 v[148:149], v10 offset:32
    ds_read_b64_tr_b16 v[150:151], v10 offset:7200
    ds_read_b64_tr_b16 v[152:153], v9 offset:64
    ds_read_b64_tr_b16 v[154:155], v9 offset:7232
    ds_read_b64_tr_b16 v[156:157], v10 offset:96
    ds_read_b64_tr_b16 v[158:159], v10 offset:7264
    ds_read_b64_tr_b16 v[160:161], v9 offset:128
    ds_read_b64_tr_b16 v[162:163], v9 offset:7296
    ds_read_b64_tr_b16 v[164:165], v10 offset:160
    ds_read_b64_tr_b16 v[166:167], v10 offset:7328
    ds_read_b64_tr_b16 v[168:169], v11 offset:0
    ds_read_b64_tr_b16 v[170:171], v11 offset:7168
    s_waitcnt lgkmcnt(0)
    v_mfma_f32_16x16x32_bf16 v[16:19], v[144:147], v[128:131], v[16:19]
    ds_read_b64_tr_b16 v[188:189], v9 offset:14336
    v_mfma_f32_16x16x32_bf16 v[20:23], v[144:147], v[132:135], v[20:23]
    ds_read_b64_tr_b16 v[190:191], v9 offset:21504
    v_mfma_f32_16x16x32_bf16 v[24:27], v[144:147], v[136:139], v[24:27]
    ds_read_b128 v[172:175], v7 offset:8192
    v_mfma_f32_16x16x32_bf16 v[28:31], v[144:147], v[140:143], v[28:31]
    ds_read_b128 v[176:179], v7 offset:9216
    v_mfma_f32_16x16x32_bf16 v[44:47], v[148:151], v[140:143], v[44:47]
    ds_read_b128 v[180:183], v7 offset:10240
    v_mfma_f32_16x16x32_bf16 v[40:43], v[148:151], v[136:139], v[40:43]
    ds_read_b128 v[184:187], v7 offset:11264
    v_mfma_f32_16x16x32_bf16 v[36:39], v[148:151], v[132:135], v[36:39]
    ds_read_b64_tr_b16 v[192:193], v10 offset:14368
    v_mfma_f32_16x16x32_bf16 v[32:35], v[148:151], v[128:131], v[32:35]
    ds_read_b64_tr_b16 v[194:195], v10 offset:21536
    v_mfma_f32_16x16x32_bf16 v[48:51], v[152:155], v[128:131], v[48:51]
    ds_read_b64_tr_b16 v[196:197], v9 offset:14400
    v_mfma_f32_16x16x32_bf16 v[52:55], v[152:155], v[132:135], v[52:55]
    ds_read_b64_tr_b16 v[198:199], v9 offset:21568
    v_mfma_f32_16x16x32_bf16 v[56:59], v[152:155], v[136:139], v[56:59]
    ds_read_b64_tr_b16 v[200:201], v10 offset:14432
    v_mfma_f32_16x16x32_bf16 v[60:63], v[152:155], v[140:143], v[60:63]
    ds_read_b64_tr_b16 v[202:203], v10 offset:21600
    v_mfma_f32_16x16x32_bf16 v[76:79], v[156:159], v[140:143], v[76:79]
    ds_read_b64_tr_b16 v[204:205], v9 offset:14464
    v_mfma_f32_16x16x32_bf16 v[72:75], v[156:159], v[136:139], v[72:75]
    ds_read_b64_tr_b16 v[206:207], v9 offset:21632
    v_mfma_f32_16x16x32_bf16 v[68:71], v[156:159], v[132:135], v[68:71]
    ds_read_b64_tr_b16 v[208:209], v10 offset:14496
    v_mfma_f32_16x16x32_bf16 v[64:67], v[156:159], v[128:131], v[64:67]
    ds_read_b64_tr_b16 v[210:211], v10 offset:21664
    v_mfma_f32_16x16x32_bf16 v[80:83], v[160:163], v[128:131], v[80:83]
    ds_read_b64_tr_b16 v[212:213], v11 offset:14336
    v_mfma_f32_16x16x32_bf16 v[84:87], v[160:163], v[132:135], v[84:87]
    ds_read_b64_tr_b16 v[214:215], v11 offset:21504
    v_mfma_f32_16x16x32_bf16 v[88:91], v[160:163], v[136:139], v[88:91]
    s_add_u32 s27, s27, 16384
    v_mfma_f32_16x16x32_bf16 v[92:95], v[160:163], v[140:143], v[92:95]
    s_add_u32 s32, s32, 28672
    v_mfma_f32_16x16x32_bf16 v[108:111], v[164:167], v[140:143], v[108:111]
    s_cmp_eq_u32 s27, 49152
    v_mfma_f32_16x16x32_bf16 v[104:107], v[164:167], v[136:139], v[104:107]
    s_cselect_b32 s27, 0, s27
    v_mfma_f32_16x16x32_bf16 v[100:103], v[164:167], v[132:135], v[100:103]
    s_cselect_b32 s32, 49152, s32
    v_mfma_f32_16x16x32_bf16 v[96:99], v[164:167], v[128:131], v[96:99]
    v_add_u32 v7, s27, v2
    v_mfma_f32_16x16x32_bf16 v[112:115], v[168:171], v[128:131], v[112:115]
    v_add_u32 v9, s32, v4
    v_mfma_f32_16x16x32_bf16 v[116:119], v[168:171], v[132:135], v[116:119]
    v_add_u32 v10, s32, v5
    v_mfma_f32_16x16x32_bf16 v[120:123], v[168:171], v[136:139], v[120:123]
    v_add_u32 v11, s32, v6
    v_mfma_f32_16x16x32_bf16 v[124:127], v[168:171], v[140:143], v[124:127]
    s_waitcnt lgkmcnt(0)
    v_mfma_f32_16x16x32_bf16 v[16:19], v[188:191], v[172:175], v[16:19]
    v_mfma_f32_16x16x32_bf16 v[20:23], v[188:191], v[176:179], v[20:23]
    v_mfma_f32_16x16x32_bf16 v[24:27], v[188:191], v[180:183], v[24:27]
    v_mfma_f32_16x16x32_bf16 v[28:31], v[188:191], v[184:187], v[28:31]
    v_mfma_f32_16x16x32_bf16 v[44:47], v[192:195], v[184:187], v[44:47]
    v_mfma_f32_16x16x32_bf16 v[40:43], v[192:195], v[180:183], v[40:43]
    v_mfma_f32_16x16x32_bf16 v[36:39], v[192:195], v[176:179], v[36:39]
    v_mfma_f32_16x16x32_bf16 v[32:35], v[192:195], v[172:175], v[32:35]
    v_mfma_f32_16x16x32_bf16 v[48:51], v[196:199], v[172:175], v[48:51]
    v_mfma_f32_16x16x32_bf16 v[52:55], v[196:199], v[176:179], v[52:55]
    v_mfma_f32_16x16x32_bf16 v[56:59], v[196:199], v[180:183], v[56:59]
    v_mfma_f32_16x16x32_bf16 v[60:63], v[196:199], v[184:187], v[60:63]
    v_mfma_f32_16x16x32_bf16 v[76:79], v[200:203], v[184:187], v[76:79]
    v_mfma_f32_16x16x32_bf16 v[72:75], v[200:203], v[180:183], v[72:75]
    v_mfma_f32_16x16x32_bf16 v[68:71], v[200:203], v[176:179], v[68:71]
    v_mfma_f32_16x16x32_bf16 v[64:67], v[200:203], v[172:175], v[64:67]
    v_mfma_f32_16x16x32_bf16 v[80:83], v[204:207], v[172:175], v[80:83]
    v_mfma_f32_16x16x32_bf16 v[84:87], v[204:207], v[176:179], v[84:87]
    v_mfma_f32_16x16x32_bf16 v[88:91], v[204:207], v[180:183], v[88:91]
    v_mfma_f32_16x16x32_bf16 v[92:95], v[204:207], v[184:187], v[92:95]
    v_mfma_f32_16x16x32_bf16 v[108:111], v[208:211], v[184:187], v[108:111]
    v_mfma_f32_16x16x32_bf16 v[104:107], v[208:211], v[180:183], v[104:107]
    v_mfma_f32_16x16x32_bf16 v[100:103], v[208:211], v[176:179], v[100:103]
    v_mfma_f32_16x16x32_bf16 v[96:99], v[208:211], v[172:175], v[96:99]
    s_barrier
    v_mfma_f32_16x16x32_bf16 v[112:115], v[212:215], v[172:175], v[112:115]
    ds_read_b64_tr_b16 v[144:145], v9 offset:0
    ds_read_b64_tr_b16 v[146:147], v9 offset:7168
    v_mfma_f32_16x16x32_bf16 v[116:119], v[212:215], v[176:179], v[116:119]
    ds_read_b128 v[128:131], v7 offset:0
    ds_read_b128 v[132:135], v7 offset:1024
    v_mfma_f32_16x16x32_bf16 v[120:123], v[212:215], v[180:183], v[120:123]
    ds_read_b128 v[136:139], v7 offset:2048
    ds_read_b128 v[140:143], v7 offset:3072
    v_mfma_f32_16x16x32_bf16 v[124:127], v[212:215], v[184:187], v[124:127]
    ds_read_b64_tr_b16 v[148:149], v10 offset:32
    ds_read_b64_tr_b16 v[150:151], v10 offset:7200
    ds_read_b64_tr_b16 v[152:153], v9 offset:64
    ds_read_b64_tr_b16 v[154:155], v9 offset:7232
    ds_read_b64_tr_b16 v[156:157], v10 offset:96
    ds_read_b64_tr_b16 v[158:159], v10 offset:7264
    ds_read_b64_tr_b16 v[160:161], v9 offset:128
    ds_read_b64_tr_b16 v[162:163], v9 offset:7296
    ds_read_b64_tr_b16 v[164:165], v10 offset:160
    ds_read_b64_tr_b16 v[166:167], v10 offset:7328
    ds_read_b64_tr_b16 v[168:169], v11 offset:0
    ds_read_b64_tr_b16 v[170:171], v11 offset:7168
    s_sub_u32 s26, s26, 1
c_loop_16:
    s_waitcnt lgkmcnt(0)
    v_mfma_f32_16x16x32_bf16 v[16:19], v[144:147], v[128:131], v[16:19]
    ds_read_b64_tr_b16 v[188:189], v9 offset:14336
    v_mfma_f32_16x16x32_bf16 v[20:23], v[144:147], v[132:135], v[20:23]
    ds_read_b64_tr_b16 v[190:191], v9 offset:21504
    v_mfma_f32_16x16x32_bf16 v[24:27], v[144:147], v[136:139], v[24:27]
    ds_read_b128 v[172:175], v7 offset:8192
    v_mfma_f32_16x16x32_bf16 v[28:31], v[144:147], v[140:143], v[28:31]
    ds_read_b128 v[176:179], v7 offset:9216
    v_mfma_f32_16x16x32_bf16 v[44:47], v[148:151], v[140:143], v[44:47]
    ds_read_b128 v[180:183], v7 offset:10240
    v_mfma_f32_16x16x32_bf16 v[40:43], v[148:151], v[136:139], v[40:43]
    ds_read_b128 v[184:187], v7 offset:11264
    v_mfma_f32_16x16x32_bf16 v[36:39], v[148:151], v[132:135], v[36:39]
    ds_read_b64_tr_b16 v[192:193], v10 offset:14368
    v_mfma_f32_16x16x32_bf16 v[32:35], v[148:151], v[128:131], v[32:35]
    ds_read_b64_tr_b16 v[194:195], v10 offset:21536
    v_mfma_f32_16x16x32_bf16 v[48:51], v[152:155], v[128:131], v[48:51]
    ds_read_b64_tr_b16 v[196:197], v9 offset:14400
    v_mfma_f32_16x16x32_bf16 v[52:55], v[152:155], v[132:135], v[52:55]
    ds_read_b64_tr_b16 v[198:199], v9 offset:21568
    v_mfma_f32_16x16x32_bf16 v[56:59], v[152:155], v[136:139], v[56:59]
    ds_read_b64_tr_b16 v[200:201], v10 offset:14432
    v_mfma_f32_16x16x32_bf16 v[60:63], v[152:155], v[140:143], v[60:63]
    ds_read_b64_tr_b16 v[202:203], v10 offset:21600
    v_mfma_f32_16x16x32_bf16 v[76:79], v[156:159], v[140:143], v[76:79]
    ds_read_b64_tr_b16 v[204:205], v9 offset:14464
    v_mfma_f32_16x16x32_bf16 v[72:75], v[156:159], v[136:139], v[72:75]
    ds_read_b64_tr_b16 v[206:207], v9 offset:21632
    v_mfma_f32_16x16x32_bf16 v[68:71], v[156:159], v[132:135], v[68:71]
    ds_read_b64_tr_b16 v[208:209], v10 offset:14496
    v_mfma_f32_16x16x32_bf16 v[64:67], v[156:159], v[128:131], v[64:67]
    ds_read_b64_tr_b16 v[210:211], v10 offset:21664
    v_mfma_f32_16x16x32_bf16 v[80:83], v[160:163], v[128:131], v[80:83]
    ds_read_b64_tr_b16 v[212:213], v11 offset:14336
    v_mfma_f32_16x16x32_bf16 v[84:87], v[160:163], v[132:135], v[84:87]
    ds_read_b64_tr_b16 v[214:215], v11 offset:21504
    v_mfma_f32_16x16x32_bf16 v[88:91], v[160:163], v[136:139], v[88:91]
    s_add_u32 s27, s27, 16384
    v_mfma_f32_16x16x32_bf16 v[92:95], v[160:163], v[140:143], v[92:95]
    s_add_u32 s32, s32, 28672
    v_mfma_f32_16x16x32_bf16 v[108:111], v[164:167], v[140:143], v[108:111]
    s_cmp_eq_u32 s27, 49152
    v_mfma_f32_16x16x32_bf16 v[104:107], v[164:167], v[136:139], v[104:107]
    s_cselect_b32 s27, 0, s27
    v_mfma_f32_16x16x32_bf16 v[100:103], v[164:167], v[132:135], v[100:103]
    s_cselect_b32 s32, 49152, s32
    v_mfma_f32_16x16x32_bf16 v[96:99], v[164:167], v[128:131], v[96:99]
    v_add_u32 v7, s27, v2
    v_mfma_f32_16x16x32_bf16 v[112:115], v[168:171], v[128:131], v[112:115]
    v_add_u32 v9, s32, v4
    v_mfma_f32_16x16x32_bf16 v[116:119], v[168:171], v[132:135], v[116:119]
    v_add_u32 v10, s32, v5
    v_mfma_f32_16x16x32_bf16 v[120:123], v[168:171], v[136:139], v[120:123]
    v_add_u32 v11, s32, v6
    v_mfma_f32_16x16x32_bf16 v[124:127], v[168:171], v[140:143], v[124:127]
    s_waitcnt lgkmcnt(0)
    s_barrier
    v_mfma_f32_16x16x32_bf16 v[16:19], v[188:191], v[172:175], v[16:19]
    ds_read_b64_tr_b16 v[144:145], v9 offset:0
    v_mfma_f32_16x16x32_bf16 v[20:23], v[188:191], v[176:179], v[20:23]
    ds_read_b64_tr_b16 v[146:147], v9 offset:7168
    v_mfma_f32_16x16x32_bf16 v[24:27], v[188:191], v[180:183], v[24:27]
    ds_read_b128 v[128:131], v7 offset:0
    v_mfma_f32_16x16x32_bf16 v[28:31], v[188:191], v[184:187], v[28:31]
    ds_read_b128 v[132:135], v7 offset:1024
    v_mfma_f32_16x16x32_bf16 v[44:47], v[192:195], v[184:187], v[44:47]
    ds_read_b128 v[136:139], v7 offset:2048
    v_mfma_f32_16x16x32_bf16 v[40:43], v[192:195], v[180:183], v[40:43]
    ds_read_b128 v[140:143], v7 offset:3072
    v_mfma_f32_16x16x32_bf16 v[36:39], v[192:195], v[176:179], v[36:39]
    ds_read_b64_tr_b16 v[148:149], v10 offset:32
    v_mfma_f32_16x16x32_bf16 v[32:35], v[192:195], v[172:175], v[32:35]
    ds_read_b64_tr_b16 v[150:151], v10 offset:7200
    v_mfma_f32_16x16x32_bf16 v[48:51], v[196:199], v[172:175], v[48:51]
    ds_read_b64_tr_b16 v[152:153], v9 offset:64
    v_mfma_f32_16x16x32_bf16 v[52:55], v[196:199], v[176:179], v[52:55]
    ds_read_b64_tr_b16 v[154:155], v9 offset:7232
    v_mfma_f32_16x16x32_bf16 v[56:59], v[196:199], v[180:183], v[56:59]
    ds_read_b64_tr_b16 v[156:157], v10 offset:96
    v_mfma_f32_16x16x32_bf16 v[60:63], v[196:199], v[184:187], v[60:63]
    ds_read_b64_tr_b16 v[158:159], v10 offset:7264
    v_mfma_f32_16x16x32_bf16 v[76:79], v[200:203], v[184:187], v[76:79]
    ds_read_b64_tr_b16 v[160:161], v9 offset:128
    v_mfma_f32_16x16x32_bf16 v[72:75], v[200:203], v[180:183], v[72:75]
    ds_read_b64_tr_b16 v[162:163], v9 offset:7296
    v_mfma_f32_16x16x32_bf16 v[68:71], v[200:203], v[176:179], v[68:71]
    ds_read_b64_tr_b16 v[164:165], v10 offset:160
    v_mfma_f32_16x16x32_bf16 v[64:67], v[200:203], v[172:175], v[64:67]
    ds_read_b64_tr_b16 v[166:167], v10 offset:7328
    v_mfma_f32_16x16x32_bf16 v[80:83], v[204:207], v[172:175], v[80:83]
    ds_read_b64_tr_b16 v[168:169], v11 offset:0
    v_mfma_f32_16x16x32_bf16 v[84:87], v[204:207], v[176:179], v[84:87]
    ds_read_b64_tr_b16 v[170:171], v11 offset:7168
    v_mfma_f32_16x16x32_bf16 v[88:91], v[204:207], v[180:183], v[88:91]
    s_sub_u32 s26, s26, 1
    v_mfma_f32_16x16x32_bf16 v[92:95], v[204:207], v[184:187], v[92:95]
    s_cmp_lg_u32 s26, 0
    v_mfma_f32_16x16x32_bf16 v[108:111], v[208:211], v[184:187], v[108:111]
    v_mfma_f32_16x16x32_bf16 v[104:107], v[208:211], v[180:183], v[104:107]
    v_mfma_f32_16x16x32_bf16 v[100:103], v[208:211], v[176:179], v[100:103]
    v_mfma_f32_16x16x32_bf16 v[96:99], v[208:211], v[172:175], v[96:99]
    v_mfma_f32_16x16x32_bf16 v[112:115], v[212:215], v[172:175], v[112:115]
    v_mfma_f32_16x16x32_bf16 v[116:119], v[212:215], v[176:179], v[116:119]
    v_mfma_f32_16x16x32_bf16 v[120:123], v[212:215], v[180:183], v[120:123]
    v_mfma_f32_16x16x32_bf16 v[124:127], v[212:215], v[184:187], v[124:127]
    s_cbranch_scc1 c_loop_16
    s_waitcnt lgkmcnt(0)
    v_mfma_f32_16x16x32_bf16 v[16:19], v[144:147], v[128:131], v[16:19]
    ds_read_b64_tr_b16 v[188:189], v9 offset:14336
    v_mfma_f32_16x16x32_bf16 v[20:23], v[144:147], v[132:135], v[20:23]
    ds_read_b64_tr_b16 v[190:191], v9 offset:21504
    v_mfma_f32_16x16x32_bf16 v[24:27], v[144:147], v[136:139], v[24:27]
    ds_read_b128 v[172:175], v7 offset:8192
    v_mfma_f32_16x16x32_bf16 v[28:31], v[144:147], v[140:143], v[28:31]
    ds_read_b128 v[176:179], v7 offset:9216
    v_mfma_f32_16x16x32_bf16 v[44:47], v[148:151], v[140:143], v[44:47]
    ds_read_b128 v[180:183], v7 offset:10240
    v_mfma_f32_16x16x32_bf16 v[40:43], v[148:151], v[136:139], v[40:43]
    ds_read_b128 v[184:187], v7 offset:11264
    v_mfma_f32_16x16x32_bf16 v[36:39], v[148:151], v[132:135], v[36:39]
    ds_read_b64_tr_b16 v[192:193], v10 offset:14368
    v_mfma_f32_16x16x32_bf16 v[32:35], v[148:151], v[128:131], v[32:35]
    ds_read_b64_tr_b16 v[194:195], v10 offset:21536
    v_mfma_f32_16x16x32_bf16 v[48:51], v[152:155], v[128:131], v[48:51]
    ds_read_b64_tr_b16 v[196:197], v9 offset:14400
    v_mfma_f32_16x16x32_bf16 v[52:55], v[152:155], v[132:135], v[52:55]
    ds_read_b64_tr_b16 v[198:199], v9 offset:21568
    v_mfma_f32_16x16x32_bf16 v[56:59], v[152:155], v[136:139], v[56:59]
    ds_read_b64_tr_b16 v[200:201], v10 offset:14432
    v_mfma_f32_16x16x32_bf16 v[60:63], v[152:155], v[140:143], v[60:63]
    ds_read_b64_tr_b16 v[202:203], v10 offset:21600
    v_mfma_f32_16x16x32_bf16 v[76:79], v[156:159], v[140:143], v[76:79]
    ds_read_b64_tr_b16 v[204:205], v9 offset:14464
    v_mfma_f32_16x16x32_bf16 v[72:75], v[156:159], v[136:139], v[72:75]
    ds_read_b64_tr_b16 v[206:207], v9 offset:21632
    v_mfma_f32_16x16x32_bf16 v[68:71], v[156:159], v[132:135], v[68:71]
    ds_read_b64_tr_b16 v[208:209], v10 offset:14496
    v_mfma_f32_16x16x32_bf16 v[64:67], v[156:159], v[128:131], v[64:67]
    ds_read_b64_tr_b16 v[210:211], v10 offset:21664
    v_mfma_f32_16x16x32_bf16 v[80:83], v[160:163], v[128:131], v[80:83]
    ds_read_b64_tr_b16 v[212:213], v11 offset:14336
    v_mfma_f32_16x16x32_bf16 v[84:87], v[160:163], v[132:135], v[84:87]
    ds_read_b64_tr_b16 v[214:215], v11 offset:21504
    v_mfma_f32_16x16x32_bf16 v[88:91], v[160:163], v[136:139], v[88:91]
    v_mfma_f32_16x16x32_bf16 v[92:95], v[160:163], v[140:143], v[92:95]
    v_mfma_f32_16x16x32_bf16 v[108:111], v[164:167], v[140:143], v[108:111]
    v_mfma_f32_16x16x32_bf16 v[104:107], v[164:167], v[136:139], v[104:107]
    v_mfma_f32_16x16x32_bf16 v[100:103], v[164:167], v[132:135], v[100:103]
    v_mfma_f32_16x16x32_bf16 v[96:99], v[164:167], v[128:131], v[96:99]
    v_mfma_f32_16x16x32_bf16 v[112:115], v[168:171], v[128:131], v[112:115]
    v_mfma_f32_16x16x32_bf16 v[116:119], v[168:171], v[132:135], v[116:119]
    v_mfma_f32_16x16x32_bf16 v[120:123], v[168:171], v[136:139], v[120:123]
    v_mfma_f32_16x16x32_bf16 v[124:127], v[168:171], v[140:143], v[124:127]
    s_waitcnt lgkmcnt(0)
    v_mfma_f32_16x16x32_bf16 v[16:19], v[188:191], v[172:175], v[16:19]
    s_add_u32 s16, s4, 25165824
    s_addc_u32 s17, s5, 0
    v_mfma_f32_16x16x32_bf16 v[20:23], v[188:191], v[176:179], v[20:23]
    s_mov_b32 s18, 14680064
    s_mov_b32 s19, 0x20000
    v_mfma_f32_16x16x32_bf16 v[24:27], v[188:191], v[180:183], v[24:27]
    v_and_b32 v14, 15, v1
    v_lshlrev_b32 v7, 4, v14
    v_mfma_f32_16x16x32_bf16 v[28:31], v[188:191], v[184:187], v[28:31]
    s_lshl_b32 s30, s34, 10
    s_add_u32 s30, s30, 155648
    v_mfma_f32_16x16x32_bf16 v[44:47], v[192:195], v[184:187], v[44:47]
    v_add_u32 v7, s30, v7
    v_lshlrev_b32 v15, 4, v12
    v_mfma_f32_16x16x32_bf16 v[40:43], v[192:195], v[180:183], v[40:43]
    s_lshl_b32 s30, s35, 9
    s_add_u32 s30, s30, 158720
    v_mfma_f32_16x16x32_bf16 v[36:39], v[192:195], v[176:179], v[36:39]
    v_add_u32 v9, s30, v15
    s_lshl_b32 s30, s35, 6
    v_mfma_f32_16x16x32_bf16 v[32:35], v[192:195], v[172:175], v[32:35]
    s_add_u32 s30, s30, 158720
    v_add_u32 v10, s30, v15
    v_mfma_f32_16x16x32_bf16 v[48:51], v[196:199], v[172:175], v[48:51]
    s_mul_i32 s30, s24, 917504
    s_mul_i32 s31, s25, 57344
    v_mfma_f32_16x16x32_bf16 v[52:55], v[196:199], v[176:179], v[52:55]
    s_add_u32 s30, s30, s31
    s_add_u32 s36, s30, 24576
    v_mfma_f32_16x16x32_bf16 v[56:59], v[196:199], v[180:183], v[56:59]
    s_lshl_b32 s31, s35, 15
    s_add_u32 s30, s30, s31
    v_mfma_f32_16x16x32_bf16 v[60:63], v[196:199], v[184:187], v[60:63]
    s_add_u32 s31, s30, 8192
    s_add_u32 s37, s30, 16384
    v_mfma_f32_16x16x32_bf16 v[76:79], v[200:203], v[184:187], v[76:79]
    s_lshl_b32 s33, s35, 3
    s_add_u32 s33, s33, 147456
    v_mfma_f32_16x16x32_bf16 v[72:75], v[200:203], v[180:183], v[72:75]
    v_add_u32 v11, s33, v13
    v_mfma_f32_16x16x32_bf16 v[68:71], v[200:203], v[176:179], v[68:71]
    v_mfma_f32_16x16x32_bf16 v[64:67], v[200:203], v[172:175], v[64:67]
    v_mfma_f32_16x16x32_bf16 v[80:83], v[204:207], v[172:175], v[80:83]
    v_mfma_f32_16x16x32_bf16 v[84:87], v[204:207], v[176:179], v[84:87]
    v_mfma_f32_16x16x32_bf16 v[88:91], v[204:207], v[180:183], v[88:91]
    v_mfma_f32_16x16x32_bf16 v[92:95], v[204:207], v[184:187], v[92:95]
    s_barrier
    v_mfma_f32_16x16x32_bf16 v[108:111], v[208:211], v[184:187], v[108:111]
    ds_read_b128 v[156:159], v7 offset:0
    ds_read_b128 v[160:163], v7 offset:256
    v_mfma_f32_16x16x32_bf16 v[104:107], v[208:211], v[180:183], v[104:107]
    ds_read_b128 v[164:167], v7 offset:512
    ds_read_b128 v[168:171], v7 offset:768
    v_mfma_f32_16x16x32_bf16 v[100:103], v[208:211], v[176:179], v[100:103]
    ds_read_b128 v[152:155], v10 offset:384
    ds_read_b128 v[128:131], v9 offset:0
    v_mfma_f32_16x16x32_bf16 v[96:99], v[208:211], v[172:175], v[96:99]
    ds_read_b128 v[132:135], v9 offset:64
    ds_read_b128 v[136:139], v9 offset:128
    v_mfma_f32_16x16x32_bf16 v[112:115], v[212:215], v[172:175], v[112:115]
    ds_read_b128 v[140:143], v9 offset:192
    ds_read_b128 v[144:147], v9 offset:256
    v_mfma_f32_16x16x32_bf16 v[116:119], v[212:215], v[176:179], v[116:119]
    ds_read_b128 v[148:151], v9 offset:320
    v_mfma_f32_16x16x32_bf16 v[120:123], v[212:215], v[180:183], v[120:123]
    v_mfma_f32_16x16x32_bf16 v[124:127], v[212:215], v[184:187], v[124:127]
    s_waitcnt lgkmcnt(0)
    s_lshl_b32 s33, s35, 13
    v_add_u32 v7, s33, v13
    v_pk_fma_f32 v[16:17], v[156:157], v[128:129], v[16:17] op_sel_hi:[0,1,1] neg_lo:[1,0,0] neg_hi:[1,0,0]
    v_pk_fma_f32 v[18:19], v[156:157], v[130:131], v[18:19] op_sel_hi:[0,1,1] neg_lo:[1,0,0] neg_hi:[1,0,0]
    v_pk_mul_f32 v[172:173], v[156:157], v[16:17] op_sel:[1,0] op_sel_hi:[1,1]
    v_pk_mul_f32 v[174:175], v[156:157], v[18:19] op_sel:[1,0] op_sel_hi:[1,1]
    v_exp_f32 v172, v172
    v_exp_f32 v173, v173
    v_exp_f32 v174, v174
    v_exp_f32 v175, v175
    v_pk_fma_f32 v[172:173], v[172:173], v[158:159], v[158:159]
    v_pk_fma_f32 v[174:175], v[174:175], v[158:159], v[158:159]
    v_rcp_f32 v172, v172
    v_rcp_f32 v173, v173
    v_rcp_f32 v174, v174
    v_rcp_f32 v175, v175
    v_pk_mul_f32 v[16:17], v[16:17], v[172:173]
    v_pk_mul_f32 v[18:19], v[18:19], v[174:175]
    v_pk_fma_f32 v[32:33], v[156:157], v[132:133], v[32:33] op_sel_hi:[0,1,1] neg_lo:[1,0,0] neg_hi:[1,0,0]
    v_pk_fma_f32 v[34:35], v[156:157], v[134:135], v[34:35] op_sel_hi:[0,1,1] neg_lo:[1,0,0] neg_hi:[1,0,0]
    v_pk_mul_f32 v[176:177], v[156:157], v[32:33] op_sel:[1,0] op_sel_hi:[1,1]
    v_pk_mul_f32 v[178:179], v[156:157], v[34:35] op_sel:[1,0] op_sel_hi:[1,1]
    v_exp_f32 v176, v176
    v_exp_f32 v177, v177
    v_exp_f32 v178, v178
    v_exp_f32 v179, v179
    v_pk_fma_f32 v[176:177], v[176:177], v[158:159], v[158:159]
    v_pk_fma_f32 v[178:179], v[178:179], v[158:159], v[158:159]
    v_rcp_f32 v176, v176
    v_rcp_f32 v177, v177
    v_rcp_f32 v178, v178
    v_rcp_f32 v179, v179
    v_pk_mul_f32 v[32:33], v[32:33], v[176:177]
    v_pk_mul_f32 v[34:35], v[34:35], v[178:179]
    v_cvt_pk_bf16_f32 v16, v16, v17
    v_cvt_pk_bf16_f32 v17, v18, v19
    v_cvt_pk_bf16_f32 v18, v32, v33
    v_cvt_pk_bf16_f32 v19, v34, v35
    buffer_store_dwordx4 v[16:19], v13, s[16:19], s30 offen offset:0 sc0 sc1
    ds_write_b128 v7, v[16:19] offset:0
    v_pk_fma_f32 v[20:21], v[160:161], v[128:129], v[20:21] op_sel_hi:[0,1,1] neg_lo:[1,0,0] neg_hi:[1,0,0]
    v_pk_fma_f32 v[22:23], v[160:161], v[130:131], v[22:23] op_sel_hi:[0,1,1] neg_lo:[1,0,0] neg_hi:[1,0,0]
    v_pk_mul_f32 v[172:173], v[160:161], v[20:21] op_sel:[1,0] op_sel_hi:[1,1]
    v_pk_mul_f32 v[174:175], v[160:161], v[22:23] op_sel:[1,0] op_sel_hi:[1,1]
    v_exp_f32 v172, v172
    v_exp_f32 v173, v173
    v_exp_f32 v174, v174
    v_exp_f32 v175, v175
    v_pk_fma_f32 v[172:173], v[172:173], v[162:163], v[162:163]
    v_pk_fma_f32 v[174:175], v[174:175], v[162:163], v[162:163]
    v_rcp_f32 v172, v172
    v_rcp_f32 v173, v173
    v_rcp_f32 v174, v174
    v_rcp_f32 v175, v175
    v_pk_mul_f32 v[20:21], v[20:21], v[172:173]
    v_pk_mul_f32 v[22:23], v[22:23], v[174:175]
    v_pk_fma_f32 v[36:37], v[160:161], v[132:133], v[36:37] op_sel_hi:[0,1,1] neg_lo:[1,0,0] neg_hi:[1,0,0]
    v_pk_fma_f32 v[38:39], v[160:161], v[134:135], v[38:39] op_sel_hi:[0,1,1] neg_lo:[1,0,0] neg_hi:[1,0,0]
    v_pk_mul_f32 v[176:177], v[160:161], v[36:37] op_sel:[1,0] op_sel_hi:[1,1]
    v_pk_mul_f32 v[178:179], v[160:161], v[38:39] op_sel:[1,0] op_sel_hi:[1,1]
    v_exp_f32 v176, v176
    v_exp_f32 v177, v177
    v_exp_f32 v178, v178
    v_exp_f32 v179, v179
    v_pk_fma_f32 v[176:177], v[176:177], v[162:163], v[162:163]
    v_pk_fma_f32 v[178:179], v[178:179], v[162:163], v[162:163]
    v_rcp_f32 v176, v176
    v_rcp_f32 v177, v177
    v_rcp_f32 v178, v178
    v_rcp_f32 v179, v179
    v_pk_mul_f32 v[36:37], v[36:37], v[176:177]
    v_pk_mul_f32 v[38:39], v[38:39], v[178:179]
    v_cvt_pk_bf16_f32 v20, v20, v21
    v_cvt_pk_bf16_f32 v21, v22, v23
    v_cvt_pk_bf16_f32 v22, v36, v37
    v_cvt_pk_bf16_f32 v23, v38, v39
    buffer_store_dwordx4 v[20:23], v13, s[16:19], s30 offen offset:1024 sc0 sc1
    ds_write_b128 v7, v[20:23] offset:1024
    v_pk_fma_f32 v[24:25], v[164:165], v[128:129], v[24:25] op_sel_hi:[0,1,1] neg_lo:[1,0,0] neg_hi:[1,0,0]
    v_pk_fma_f32 v[26:27], v[164:165], v[130:131], v[26:27] op_sel_hi:[0,1,1] neg_lo:[1,0,0] neg_hi:[1,0,0]
    v_pk_mul_f32 v[172:173], v[164:165], v[24:25] op_sel:[1,0] op_sel_hi:[1,1]
    v_pk_mul_f32 v[174:175], v[164:165], v[26:27] op_sel:[1,0] op_sel_hi:[1,1]
    v_exp_f32 v172, v172
    v_exp_f32 v173, v173
    v_exp_f32 v174, v174
    v_exp_f32 v175, v175
    v_pk_fma_f32 v[172:173], v[172:173], v[166:167], v[166:167]
    v_pk_fma_f32 v[174:175], v[174:175], v[166:167], v[166:167]
    v_rcp_f32 v172, v172
    v_rcp_f32 v173, v173
    v_rcp_f32 v174, v174
    v_rcp_f32 v175, v175
    v_pk_mul_f32 v[24:25], v[24:25], v[172:173]
    v_pk_mul_f32 v[26:27], v[26:27], v[174:175]
    v_pk_fma_f32 v[40:41], v[164:165], v[132:133], v[40:41] op_sel_hi:[0,1,1] neg_lo:[1,0,0] neg_hi:[1,0,0]
    v_pk_fma_f32 v[42:43], v[164:165], v[134:135], v[42:43] op_sel_hi:[0,1,1] neg_lo:[1,0,0] neg_hi:[1,0,0]
    v_pk_mul_f32 v[176:177], v[164:165], v[40:41] op_sel:[1,0] op_sel_hi:[1,1]
    v_pk_mul_f32 v[178:179], v[164:165], v[42:43] op_sel:[1,0] op_sel_hi:[1,1]
    v_exp_f32 v176, v176
    v_exp_f32 v177, v177
    v_exp_f32 v178, v178
    v_exp_f32 v179, v179
    v_pk_fma_f32 v[176:177], v[176:177], v[166:167], v[166:167]
    v_pk_fma_f32 v[178:179], v[178:179], v[166:167], v[166:167]
    v_rcp_f32 v176, v176
    v_rcp_f32 v177, v177
    v_rcp_f32 v178, v178
    v_rcp_f32 v179, v179
    v_pk_mul_f32 v[40:41], v[40:41], v[176:177]
    v_pk_mul_f32 v[42:43], v[42:43], v[178:179]
    v_cvt_pk_bf16_f32 v24, v24, v25
    v_cvt_pk_bf16_f32 v25, v26, v27
    v_cvt_pk_bf16_f32 v26, v40, v41
    v_cvt_pk_bf16_f32 v27, v42, v43
    buffer_store_dwordx4 v[24:27], v13, s[16:19], s30 offen offset:2048 sc0 sc1
    ds_write_b128 v7, v[24:27] offset:2048
    v_pk_fma_f32 v[28:29], v[168:169], v[128:129], v[28:29] op_sel_hi:[0,1,1] neg_lo:[1,0,0] neg_hi:[1,0,0]
    v_pk_fma_f32 v[30:31], v[168:169], v[130:131], v[30:31] op_sel_hi:[0,1,1] neg_lo:[1,0,0] neg_hi:[1,0,0]
    v_pk_mul_f32 v[172:173], v[168:169], v[28:29] op_sel:[1,0] op_sel_hi:[1,1]
    v_pk_mul_f32 v[174:175], v[168:169], v[30:31] op_sel:[1,0] op_sel_hi:[1,1]
    v_exp_f32 v172, v172
    v_exp_f32 v173, v173
    v_exp_f32 v174, v174
    v_exp_f32 v175, v175
    v_pk_fma_f32 v[172:173], v[172:173], v[170:171], v[170:171]
    v_pk_fma_f32 v[174:175], v[174:175], v[170:171], v[170:171]
    v_rcp_f32 v172, v172
    v_rcp_f32 v173, v173
    v_rcp_f32 v174, v174
    v_rcp_f32 v175, v175
    v_pk_mul_f32 v[28:29], v[28:29], v[172:173]
    v_pk_mul_f32 v[30:31], v[30:31], v[174:175]
    v_pk_fma_f32 v[44:45], v[168:169], v[132:133], v[44:45] op_sel_hi:[0,1,1] neg_lo:[1,0,0] neg_hi:[1,0,0]
    v_pk_fma_f32 v[46:47], v[168:169], v[134:135], v[46:47] op_sel_hi:[0,1,1] neg_lo:[1,0,0] neg_hi:[1,0,0]
    v_pk_mul_f32 v[176:177], v[168:169], v[44:45] op_sel:[1,0] op_sel_hi:[1,1]
    v_pk_mul_f32 v[178:179], v[168:169], v[46:47] op_sel:[1,0] op_sel_hi:[1,1]
    v_exp_f32 v176, v176
    v_exp_f32 v177, v177
    v_exp_f32 v178, v178
    v_exp_f32 v179, v179
    v_pk_fma_f32 v[176:177], v[176:177], v[170:171], v[170:171]
    v_pk_fma_f32 v[178:179], v[178:179], v[170:171], v[170:171]
    v_rcp_f32 v176, v176
    v_rcp_f32 v177, v177
    v_rcp_f32 v178, v178
    v_rcp_f32 v179, v179
    v_pk_mul_f32 v[44:45], v[44:45], v[176:177]
    v_pk_mul_f32 v[46:47], v[46:47], v[178:179]
    v_cvt_pk_bf16_f32 v28, v28, v29
    v_cvt_pk_bf16_f32 v29, v30, v31
    v_cvt_pk_bf16_f32 v30, v44, v45
    v_cvt_pk_bf16_f32 v31, v46, v47
    buffer_store_dwordx4 v[28:31], v13, s[16:19], s30 offen offset:3072 sc0 sc1
    ds_write_b128 v7, v[28:31] offset:3072
    v_pk_fma_f32 v[112:113], v[156:157], v[152:153], v[112:113] op_sel_hi:[0,1,1] neg_lo:[1,0,0] neg_hi:[1,0,0]
    v_pk_fma_f32 v[114:115], v[156:157], v[154:155], v[114:115] op_sel_hi:[0,1,1] neg_lo:[1,0,0] neg_hi:[1,0,0]
    v_pk_mul_f32 v[172:173], v[156:157], v[112:113] op_sel:[1,0] op_sel_hi:[1,1]
    v_pk_mul_f32 v[174:175], v[156:157], v[114:115] op_sel:[1,0] op_sel_hi:[1,1]
    v_exp_f32 v172, v172
    v_exp_f32 v173, v173
    v_exp_f32 v174, v174
    v_exp_f32 v175, v175
    v_pk_fma_f32 v[172:173], v[172:173], v[158:159], v[158:159]
    v_pk_fma_f32 v[174:175], v[174:175], v[158:159], v[158:159]
    v_rcp_f32 v172, v172
    v_rcp_f32 v173, v173
    v_rcp_f32 v174, v174
    v_rcp_f32 v175, v175
    v_pk_mul_f32 v[112:113], v[112:113], v[172:173]
    v_pk_mul_f32 v[114:115], v[114:115], v[174:175]
    v_cvt_pk_bf16_f32 v112, v112, v113
    v_cvt_pk_bf16_f32 v113, v114, v115
    ds_write_b64 v11, v[112:113] offset:0
    v_pk_fma_f32 v[116:117], v[160:161], v[152:153], v[116:117] op_sel_hi:[0,1,1] neg_lo:[1,0,0] neg_hi:[1,0,0]
    v_pk_fma_f32 v[118:119], v[160:161], v[154:155], v[118:119] op_sel_hi:[0,1,1] neg_lo:[1,0,0] neg_hi:[1,0,0]
    v_pk_mul_f32 v[176:177], v[160:161], v[116:117] op_sel:[1,0] op_sel_hi:[1,1]
    v_pk_mul_f32 v[178:179], v[160:161], v[118:119] op_sel:[1,0] op_sel_hi:[1,1]
    v_exp_f32 v176, v176
    v_exp_f32 v177, v177
    v_exp_f32 v178, v178
    v_exp_f32 v179, v179
    v_pk_fma_f32 v[176:177], v[176:177], v[162:163], v[162:163]
    v_pk_fma_f32 v[178:179], v[178:179], v[162:163], v[162:163]
    v_rcp_f32 v176, v176
    v_rcp_f32 v177, v177
    v_rcp_f32 v178, v178
    v_rcp_f32 v179, v179
    v_pk_mul_f32 v[116:117], v[116:117], v[176:177]
    v_pk_mul_f32 v[118:119], v[118:119], v[178:179]
    v_cvt_pk_bf16_f32 v116, v116, v117
    v_cvt_pk_bf16_f32 v117, v118, v119
    ds_write_b64 v11, v[116:117] offset:1024
    v_pk_fma_f32 v[120:121], v[164:165], v[152:153], v[120:121] op_sel_hi:[0,1,1] neg_lo:[1,0,0] neg_hi:[1,0,0]
    v_pk_fma_f32 v[122:123], v[164:165], v[154:155], v[122:123] op_sel_hi:[0,1,1] neg_lo:[1,0,0] neg_hi:[1,0,0]
    v_pk_mul_f32 v[172:173], v[164:165], v[120:121] op_sel:[1,0] op_sel_hi:[1,1]
    v_pk_mul_f32 v[174:175], v[164:165], v[122:123] op_sel:[1,0] op_sel_hi:[1,1]
    v_exp_f32 v172, v172
    v_exp_f32 v173, v173
    v_exp_f32 v174, v174
    v_exp_f32 v175, v175
    v_pk_fma_f32 v[172:173], v[172:173], v[166:167], v[166:167]
    v_pk_fma_f32 v[174:175], v[174:175], v[166:167], v[166:167]
    v_rcp_f32 v172, v172
    v_rcp_f32 v173, v173
    v_rcp_f32 v174, v174
    v_rcp_f32 v175, v175
    v_pk_mul_f32 v[120:121], v[120:121], v[172:173]
    v_pk_mul_f32 v[122:123], v[122:123], v[174:175]
    v_cvt_pk_bf16_f32 v120, v120, v121
    v_cvt_pk_bf16_f32 v121, v122, v123
    ds_write_b64 v11, v[120:121] offset:2048
    v_pk_fma_f32 v[124:125], v[168:169], v[152:153], v[124:125] op_sel_hi:[0,1,1] neg_lo:[1,0,0] neg_hi:[1,0,0]
    v_pk_fma_f32 v[126:127], v[168:169], v[154:155], v[126:127] op_sel_hi:[0,1,1] neg_lo:[1,0,0] neg_hi:[1,0,0]
    v_pk_mul_f32 v[176:177], v[168:169], v[124:125] op_sel:[1,0] op_sel_hi:[1,1]
    v_pk_mul_f32 v[178:179], v[168:169], v[126:127] op_sel:[1,0] op_sel_hi:[1,1]
    v_exp_f32 v176, v176
    v_exp_f32 v177, v177
    v_exp_f32 v178, v178
    v_exp_f32 v179, v179
    v_pk_fma_f32 v[176:177], v[176:177], v[170:171], v[170:171]
    v_pk_fma_f32 v[178:179], v[178:179], v[170:171], v[170:171]
    v_rcp_f32 v176, v176
    v_rcp_f32 v177, v177
    v_rcp_f32 v178, v178
    v_rcp_f32 v179, v179
    v_pk_mul_f32 v[124:125], v[124:125], v[176:177]
    v_pk_mul_f32 v[126:127], v[126:127], v[178:179]
    v_cvt_pk_bf16_f32 v124, v124, v125
    v_cvt_pk_bf16_f32 v125, v126, v127
    ds_write_b64 v11, v[124:125] offset:3072
    s_waitcnt lgkmcnt(0)
    s_barrier
    s_lshl_b32 s33, s35, 11
    v_add_u32 v11, s33, v13
    v_add_u32 v10, 147456, v11
    ds_read_b128 v[112:115], v10
    ds_read_b128 v[116:119], v10 offset:1024
    v_pk_fma_f32 v[48:49], v[156:157], v[136:137], v[48:49] op_sel_hi:[0,1,1] neg_lo:[1,0,0] neg_hi:[1,0,0]
    v_pk_fma_f32 v[50:51], v[156:157], v[138:139], v[50:51] op_sel_hi:[0,1,1] neg_lo:[1,0,0] neg_hi:[1,0,0]
    v_pk_mul_f32 v[172:173], v[156:157], v[48:49] op_sel:[1,0] op_sel_hi:[1,1]
    v_pk_mul_f32 v[174:175], v[156:157], v[50:51] op_sel:[1,0] op_sel_hi:[1,1]
    v_exp_f32 v172, v172
    v_exp_f32 v173, v173
    v_exp_f32 v174, v174
    v_exp_f32 v175, v175
    v_pk_fma_f32 v[172:173], v[172:173], v[158:159], v[158:159]
    v_pk_fma_f32 v[174:175], v[174:175], v[158:159], v[158:159]
    v_rcp_f32 v172, v172
    v_rcp_f32 v173, v173
    v_rcp_f32 v174, v174
    v_rcp_f32 v175, v175
    v_pk_mul_f32 v[48:49], v[48:49], v[172:173]
    v_pk_mul_f32 v[50:51], v[50:51], v[174:175]
    v_pk_fma_f32 v[64:65], v[156:157], v[140:141], v[64:65] op_sel_hi:[0,1,1] neg_lo:[1,0,0] neg_hi:[1,0,0]
    v_pk_fma_f32 v[66:67], v[156:157], v[142:143], v[66:67] op_sel_hi:[0,1,1] neg_lo:[1,0,0] neg_hi:[1,0,0]
    v_pk_mul_f32 v[176:177], v[156:157], v[64:65] op_sel:[1,0] op_sel_hi:[1,1]
    v_pk_mul_f32 v[178:179], v[156:157], v[66:67] op_sel:[1,0] op_sel_hi:[1,1]
    v_exp_f32 v176, v176
    v_exp_f32 v177, v177
    v_exp_f32 v178, v178
    v_exp_f32 v179, v179
    v_pk_fma_f32 v[176:177], v[176:177], v[158:159], v[158:159]
    v_pk_fma_f32 v[178:179], v[178:179], v[158:159], v[158:159]
    v_rcp_f32 v176, v176
    v_rcp_f32 v177, v177
    v_rcp_f32 v178, v178
    v_rcp_f32 v179, v179
    v_pk_mul_f32 v[64:65], v[64:65], v[176:177]
    v_pk_mul_f32 v[66:67], v[66:67], v[178:179]
    v_cvt_pk_bf16_f32 v48, v48, v49
    v_cvt_pk_bf16_f32 v49, v50, v51
    v_cvt_pk_bf16_f32 v50, v64, v65
    v_cvt_pk_bf16_f32 v51, v66, v67
    buffer_store_dwordx4 v[48:51], v13, s[16:19], s31 offen offset:0 sc0 sc1
    ds_write_b128 v7, v[48:51] offset:16384
    s_waitcnt lgkmcnt(0)
    buffer_store_dwordx4 v[112:115], v11, s[16:19], s36 offen sc0 sc1
    buffer_store_dwordx4 v[116:119], v11, s[16:19], s36 offen offset:1024 sc0 sc1
    v_pk_fma_f32 v[52:53], v[160:161], v[136:137], v[52:53] op_sel_hi:[0,1,1] neg_lo:[1,0,0] neg_hi:[1,0,0]
    v_pk_fma_f32 v[54:55], v[160:161], v[138:139], v[54:55] op_sel_hi:[0,1,1] neg_lo:[1,0,0] neg_hi:[1,0,0]
    v_pk_mul_f32 v[172:173], v[160:161], v[52:53] op_sel:[1,0] op_sel_hi:[1,1]
    v_pk_mul_f32 v[174:175], v[160:161], v[54:55] op_sel:[1,0] op_sel_hi:[1,1]
    v_exp_f32 v172, v172
    v_exp_f32 v173, v173
    v_exp_f32 v174, v174
    v_exp_f32 v175, v175
    v_pk_fma_f32 v[172:173], v[172:173], v[162:163], v[162:163]
    v_pk_fma_f32 v[174:175], v[174:175], v[162:163], v[162:163]
    v_rcp_f32 v172, v172
    v_rcp_f32 v173, v173
    v_rcp_f32 v174, v174
    v_rcp_f32 v175, v175
    v_pk_mul_f32 v[52:53], v[52:53], v[172:173]
    v_pk_mul_f32 v[54:55], v[54:55], v[174:175]
    v_pk_fma_f32 v[68:69], v[160:161], v[140:141], v[68:69] op_sel_hi:[0,1,1] neg_lo:[1,0,0] neg_hi:[1,0,0]
    v_pk_fma_f32 v[70:71], v[160:161], v[142:143], v[70:71] op_sel_hi:[0,1,1] neg_lo:[1,0,0] neg_hi:[1,0,0]
    v_pk_mul_f32 v[176:177], v[160:161], v[68:69] op_sel:[1,0] op_sel_hi:[1,1]
    v_pk_mul_f32 v[178:179], v[160:161], v[70:71] op_sel:[1,0] op_sel_hi:[1,1]
    v_exp_f32 v176, v176
    v_exp_f32 v177, v177
    v_exp_f32 v178, v178
    v_exp_f32 v179, v179
    v_pk_fma_f32 v[176:177], v[176:177], v[162:163], v[162:163]
    v_pk_fma_f32 v[178:179], v[178:179], v[162:163], v[162:163]
    v_rcp_f32 v176, v176
    v_rcp_f32 v177, v177
    v_rcp_f32 v178, v178
    v_rcp_f32 v179, v179
    v_pk_mul_f32 v[68:69], v[68:69], v[176:177]
    v_pk_mul_f32 v[70:71], v[70:71], v[178:179]
    v_cvt_pk_bf16_f32 v52, v52, v53
    v_cvt_pk_bf16_f32 v53, v54, v55
    v_cvt_pk_bf16_f32 v54, v68, v69
    v_cvt_pk_bf16_f32 v55, v70, v71
    buffer_store_dwordx4 v[52:55], v13, s[16:19], s31 offen offset:1024 sc0 sc1
    ds_write_b128 v7, v[52:55] offset:17408
    v_pk_fma_f32 v[56:57], v[164:165], v[136:137], v[56:57] op_sel_hi:[0,1,1] neg_lo:[1,0,0] neg_hi:[1,0,0]
    v_pk_fma_f32 v[58:59], v[164:165], v[138:139], v[58:59] op_sel_hi:[0,1,1] neg_lo:[1,0,0] neg_hi:[1,0,0]
    v_pk_mul_f32 v[172:173], v[164:165], v[56:57] op_sel:[1,0] op_sel_hi:[1,1]
    v_pk_mul_f32 v[174:175], v[164:165], v[58:59] op_sel:[1,0] op_sel_hi:[1,1]
    v_exp_f32 v172, v172
    v_exp_f32 v173, v173
    v_exp_f32 v174, v174
    v_exp_f32 v175, v175
    v_pk_fma_f32 v[172:173], v[172:173], v[166:167], v[166:167]
    v_pk_fma_f32 v[174:175], v[174:175], v[166:167], v[166:167]
    v_rcp_f32 v172, v172
    v_rcp_f32 v173, v173
    v_rcp_f32 v174, v174
    v_rcp_f32 v175, v175
    v_pk_mul_f32 v[56:57], v[56:57], v[172:173]
    v_pk_mul_f32 v[58:59], v[58:59], v[174:175]
    v_pk_fma_f32 v[72:73], v[164:165], v[140:141], v[72:73] op_sel_hi:[0,1,1] neg_lo:[1,0,0] neg_hi:[1,0,0]
    v_pk_fma_f32 v[74:75], v[164:165], v[142:143], v[74:75] op_sel_hi:[0,1,1] neg_lo:[1,0,0] neg_hi:[1,0,0]
    v_pk_mul_f32 v[176:177], v[164:165], v[72:73] op_sel:[1,0] op_sel_hi:[1,1]
    v_pk_mul_f32 v[178:179], v[164:165], v[74:75] op_sel:[1,0] op_sel_hi:[1,1]
    v_exp_f32 v176, v176
    v_exp_f32 v177, v177
    v_exp_f32 v178, v178
    v_exp_f32 v179, v179
    v_pk_fma_f32 v[176:177], v[176:177], v[166:167], v[166:167]
    v_pk_fma_f32 v[178:179], v[178:179], v[166:167], v[166:167]
    v_rcp_f32 v176, v176
    v_rcp_f32 v177, v177
    v_rcp_f32 v178, v178
    v_rcp_f32 v179, v179
    v_pk_mul_f32 v[72:73], v[72:73], v[176:177]
    v_pk_mul_f32 v[74:75], v[74:75], v[178:179]
    v_cvt_pk_bf16_f32 v56, v56, v57
    v_cvt_pk_bf16_f32 v57, v58, v59
    v_cvt_pk_bf16_f32 v58, v72, v73
    v_cvt_pk_bf16_f32 v59, v74, v75
    buffer_store_dwordx4 v[56:59], v13, s[16:19], s31 offen offset:2048 sc0 sc1
    ds_write_b128 v7, v[56:59] offset:18432
    v_pk_fma_f32 v[60:61], v[168:169], v[136:137], v[60:61] op_sel_hi:[0,1,1] neg_lo:[1,0,0] neg_hi:[1,0,0]
    v_pk_fma_f32 v[62:63], v[168:169], v[138:139], v[62:63] op_sel_hi:[0,1,1] neg_lo:[1,0,0] neg_hi:[1,0,0]
    v_pk_mul_f32 v[172:173], v[168:169], v[60:61] op_sel:[1,0] op_sel_hi:[1,1]
    v_pk_mul_f32 v[174:175], v[168:169], v[62:63] op_sel:[1,0] op_sel_hi:[1,1]
    v_exp_f32 v172, v172
    v_exp_f32 v173, v173
    v_exp_f32 v174, v174
    v_exp_f32 v175, v175
    v_pk_fma_f32 v[172:173], v[172:173], v[170:171], v[170:171]
    v_pk_fma_f32 v[174:175], v[174:175], v[170:171], v[170:171]
    v_rcp_f32 v172, v172
    v_rcp_f32 v173, v173
    v_rcp_f32 v174, v174
    v_rcp_f32 v175, v175
    v_pk_mul_f32 v[60:61], v[60:61], v[172:173]
    v_pk_mul_f32 v[62:63], v[62:63], v[174:175]
    v_pk_fma_f32 v[76:77], v[168:169], v[140:141], v[76:77] op_sel_hi:[0,1,1] neg_lo:[1,0,0] neg_hi:[1,0,0]
    v_pk_fma_f32 v[78:79], v[168:169], v[142:143], v[78:79] op_sel_hi:[0,1,1] neg_lo:[1,0,0] neg_hi:[1,0,0]
    v_pk_mul_f32 v[176:177], v[168:169], v[76:77] op_sel:[1,0] op_sel_hi:[1,1]
    v_pk_mul_f32 v[178:179], v[168:169], v[78:79] op_sel:[1,0] op_sel_hi:[1,1]
    v_exp_f32 v176, v176
    v_exp_f32 v177, v177
    v_exp_f32 v178, v178
    v_exp_f32 v179, v179
    v_pk_fma_f32 v[176:177], v[176:177], v[170:171], v[170:171]
    v_pk_fma_f32 v[178:179], v[178:179], v[170:171], v[170:171]
    v_rcp_f32 v176, v176
    v_rcp_f32 v177, v177
    v_rcp_f32 v178, v178
    v_rcp_f32 v179, v179
    v_pk_mul_f32 v[76:77], v[76:77], v[176:177]
    v_pk_mul_f32 v[78:79], v[78:79], v[178:179]
    v_cvt_pk_bf16_f32 v60, v60, v61
    v_cvt_pk_bf16_f32 v61, v62, v63
    v_cvt_pk_bf16_f32 v62, v76, v77
    v_cvt_pk_bf16_f32 v63, v78, v79
    buffer_store_dwordx4 v[60:63], v13, s[16:19], s31 offen offset:3072 sc0 sc1
    ds_write_b128 v7, v[60:63] offset:19456
    v_pk_fma_f32 v[80:81], v[156:157], v[144:145], v[80:81] op_sel_hi:[0,1,1] neg_lo:[1,0,0] neg_hi:[1,0,0]
    v_pk_fma_f32 v[82:83], v[156:157], v[146:147], v[82:83] op_sel_hi:[0,1,1] neg_lo:[1,0,0] neg_hi:[1,0,0]
    v_pk_mul_f32 v[172:173], v[156:157], v[80:81] op_sel:[1,0] op_sel_hi:[1,1]
    v_pk_mul_f32 v[174:175], v[156:157], v[82:83] op_sel:[1,0] op_sel_hi:[1,1]
    v_exp_f32 v172, v172
    v_exp_f32 v173, v173
    v_exp_f32 v174, v174
    v_exp_f32 v175, v175
    v_pk_fma_f32 v[172:173], v[172:173], v[158:159], v[158:159]
    v_pk_fma_f32 v[174:175], v[174:175], v[158:159], v[158:159]
    v_rcp_f32 v172, v172
    v_rcp_f32 v173, v173
    v_rcp_f32 v174, v174
    v_rcp_f32 v175, v175
    v_pk_mul_f32 v[80:81], v[80:81], v[172:173]
    v_pk_mul_f32 v[82:83], v[82:83], v[174:175]
    v_pk_fma_f32 v[96:97], v[156:157], v[148:149], v[96:97] op_sel_hi:[0,1,1] neg_lo:[1,0,0] neg_hi:[1,0,0]
    v_pk_fma_f32 v[98:99], v[156:157], v[150:151], v[98:99] op_sel_hi:[0,1,1] neg_lo:[1,0,0] neg_hi:[1,0,0]
    v_pk_mul_f32 v[176:177], v[156:157], v[96:97] op_sel:[1,0] op_sel_hi:[1,1]
    v_pk_mul_f32 v[178:179], v[156:157], v[98:99] op_sel:[1,0] op_sel_hi:[1,1]
    v_exp_f32 v176, v176
    v_exp_f32 v177, v177
    v_exp_f32 v178, v178
    v_exp_f32 v179, v179
    v_pk_fma_f32 v[176:177], v[176:177], v[158:159], v[158:159]
    v_pk_fma_f32 v[178:179], v[178:179], v[158:159], v[158:159]
    v_rcp_f32 v176, v176
    v_rcp_f32 v177, v177
    v_rcp_f32 v178, v178
    v_rcp_f32 v179, v179
    v_pk_mul_f32 v[96:97], v[96:97], v[176:177]
    v_pk_mul_f32 v[98:99], v[98:99], v[178:179]
    v_cvt_pk_bf16_f32 v80, v80, v81
    v_cvt_pk_bf16_f32 v81, v82, v83
    v_cvt_pk_bf16_f32 v82, v96, v97
    v_cvt_pk_bf16_f32 v83, v98, v99
    buffer_store_dwordx4 v[80:83], v13, s[16:19], s37 offen offset:0 sc0 sc1
    ds_write_b128 v7, v[80:83] offset:32768
    v_pk_fma_f32 v[84:85], v[160:161], v[144:145], v[84:85] op_sel_hi:[0,1,1] neg_lo:[1,0,0] neg_hi:[1,0,0]
    v_pk_fma_f32 v[86:87], v[160:161], v[146:147], v[86:87] op_sel_hi:[0,1,1] neg_lo:[1,0,0] neg_hi:[1,0,0]
    v_pk_mul_f32 v[172:173], v[160:161], v[84:85] op_sel:[1,0] op_sel_hi:[1,1]
    v_pk_mul_f32 v[174:175], v[160:161], v[86:87] op_sel:[1,0] op_sel_hi:[1,1]
    v_exp_f32 v172, v172
    v_exp_f32 v173, v173
    v_exp_f32 v174, v174
    v_exp_f32 v175, v175
    v_pk_fma_f32 v[172:173], v[172:173], v[162:163], v[162:163]
    v_pk_fma_f32 v[174:175], v[174:175], v[162:163], v[162:163]
    v_rcp_f32 v172, v172
    v_rcp_f32 v173, v173
    v_rcp_f32 v174, v174
    v_rcp_f32 v175, v175
    v_pk_mul_f32 v[84:85], v[84:85], v[172:173]
    v_pk_mul_f32 v[86:87], v[86:87], v[174:175]
    v_pk_fma_f32 v[100:101], v[160:161], v[148:149], v[100:101] op_sel_hi:[0,1,1] neg_lo:[1,0,0] neg_hi:[1,0,0]
    v_pk_fma_f32 v[102:103], v[160:161], v[150:151], v[102:103] op_sel_hi:[0,1,1] neg_lo:[1,0,0] neg_hi:[1,0,0]
    v_pk_mul_f32 v[176:177], v[160:161], v[100:101] op_sel:[1,0] op_sel_hi:[1,1]
    v_pk_mul_f32 v[178:179], v[160:161], v[102:103] op_sel:[1,0] op_sel_hi:[1,1]
    v_exp_f32 v176, v176
    v_exp_f32 v177, v177
    v_exp_f32 v178, v178
    v_exp_f32 v179, v179
    v_pk_fma_f32 v[176:177], v[176:177], v[162:163], v[162:163]
    v_pk_fma_f32 v[178:179], v[178:179], v[162:163], v[162:163]
    v_rcp_f32 v176, v176
    v_rcp_f32 v177, v177
    v_rcp_f32 v178, v178
    v_rcp_f32 v179, v179
    v_pk_mul_f32 v[100:101], v[100:101], v[176:177]
    v_pk_mul_f32 v[102:103], v[102:103], v[178:179]
    v_cvt_pk_bf16_f32 v84, v84, v85
    v_cvt_pk_bf16_f32 v85, v86, v87
    v_cvt_pk_bf16_f32 v86, v100, v101
    v_cvt_pk_bf16_f32 v87, v102, v103
    buffer_store_dwordx4 v[84:87], v13, s[16:19], s37 offen offset:1024 sc0 sc1
    ds_write_b128 v7, v[84:87] offset:33792
    s_lshl_b32 s40, s24, 10
    s_lshl_b32 s41, s25, 5
    s_add_u32 s40, s40, s41
    s_lshl_b32 s41, s3, 3
    s_add_u32 s40, s40, s41
    s_add_u32 s40, s40, 0
    v_mov_b32 v120, s72
    v_mov_b32 v121, s73
    v_mov_b32 v122, 0
    s_waitcnt vmcnt(5)
    s_mov_b64 exec, 1
    buffer_store_dwordx2 v[120:121], v122, s[76:79], s40 offen sc0 sc1
    s_mov_b64 exec, -1
    s_barrier
    v_pk_fma_f32 v[88:89], v[164:165], v[144:145], v[88:89] op_sel_hi:[0,1,1] neg_lo:[1,0,0] neg_hi:[1,0,0]
    v_pk_fma_f32 v[90:91], v[164:165], v[146:147], v[90:91] op_sel_hi:[0,1,1] neg_lo:[1,0,0] neg_hi:[1,0,0]
    v_pk_mul_f32 v[172:173], v[164:165], v[88:89] op_sel:[1,0] op_sel_hi:[1,1]
    v_pk_mul_f32 v[174:175], v[164:165], v[90:91] op_sel:[1,0] op_sel_hi:[1,1]
    v_exp_f32 v172, v172
    v_exp_f32 v173, v173
    v_exp_f32 v174, v174
    v_exp_f32 v175, v175
    v_pk_fma_f32 v[172:173], v[172:173], v[166:167], v[166:167]
    v_pk_fma_f32 v[174:175], v[174:175], v[166:167], v[166:167]
    v_rcp_f32 v172, v172
    v_rcp_f32 v173, v173
    v_rcp_f32 v174, v174
    v_rcp_f32 v175, v175
    v_pk_mul_f32 v[88:89], v[88:89], v[172:173]
    v_pk_mul_f32 v[90:91], v[90:91], v[174:175]
    v_pk_fma_f32 v[104:105], v[164:165], v[148:149], v[104:105] op_sel_hi:[0,1,1] neg_lo:[1,0,0] neg_hi:[1,0,0]
    v_pk_fma_f32 v[106:107], v[164:165], v[150:151], v[106:107] op_sel_hi:[0,1,1] neg_lo:[1,0,0] neg_hi:[1,0,0]
    v_pk_mul_f32 v[176:177], v[164:165], v[104:105] op_sel:[1,0] op_sel_hi:[1,1]
    v_pk_mul_f32 v[178:179], v[164:165], v[106:107] op_sel:[1,0] op_sel_hi:[1,1]
    v_exp_f32 v176, v176
    v_exp_f32 v177, v177
    v_exp_f32 v178, v178
    v_exp_f32 v179, v179
    v_pk_fma_f32 v[176:177], v[176:177], v[166:167], v[166:167]
    v_pk_fma_f32 v[178:179], v[178:179], v[166:167], v[166:167]
    v_rcp_f32 v176, v176
    v_rcp_f32 v177, v177
    v_rcp_f32 v178, v178
    v_rcp_f32 v179, v179
    v_pk_mul_f32 v[104:105], v[104:105], v[176:177]
    v_pk_mul_f32 v[106:107], v[106:107], v[178:179]
    v_cvt_pk_bf16_f32 v88, v88, v89
    v_cvt_pk_bf16_f32 v89, v90, v91
    v_cvt_pk_bf16_f32 v90, v104, v105
    v_cvt_pk_bf16_f32 v91, v106, v107
    buffer_store_dwordx4 v[88:91], v13, s[16:19], s37 offen offset:2048 sc0 sc1
    ds_write_b128 v7, v[88:91] offset:34816
    v_pk_fma_f32 v[92:93], v[168:169], v[144:145], v[92:93] op_sel_hi:[0,1,1] neg_lo:[1,0,0] neg_hi:[1,0,0]
    v_pk_fma_f32 v[94:95], v[168:169], v[146:147], v[94:95] op_sel_hi:[0,1,1] neg_lo:[1,0,0] neg_hi:[1,0,0]
    v_pk_mul_f32 v[172:173], v[168:169], v[92:93] op_sel:[1,0] op_sel_hi:[1,1]
    v_pk_mul_f32 v[174:175], v[168:169], v[94:95] op_sel:[1,0] op_sel_hi:[1,1]
    v_exp_f32 v172, v172
    v_exp_f32 v173, v173
    v_exp_f32 v174, v174
    v_exp_f32 v175, v175
    v_pk_fma_f32 v[172:173], v[172:173], v[170:171], v[170:171]
    v_pk_fma_f32 v[174:175], v[174:175], v[170:171], v[170:171]
    v_rcp_f32 v172, v172
    v_rcp_f32 v173, v173
    v_rcp_f32 v174, v174
    v_rcp_f32 v175, v175
    v_pk_mul_f32 v[92:93], v[92:93], v[172:173]
    v_pk_mul_f32 v[94:95], v[94:95], v[174:175]
    v_pk_fma_f32 v[108:109], v[168:169], v[148:149], v[108:109] op_sel_hi:[0,1,1] neg_lo:[1,0,0] neg_hi:[1,0,0]
    v_pk_fma_f32 v[110:111], v[168:169], v[150:151], v[110:111] op_sel_hi:[0,1,1] neg_lo:[1,0,0] neg_hi:[1,0,0]
    v_pk_mul_f32 v[176:177], v[168:169], v[108:109] op_sel:[1,0] op_sel_hi:[1,1]
    v_pk_mul_f32 v[178:179], v[168:169], v[110:111] op_sel:[1,0] op_sel_hi:[1,1]
    v_exp_f32 v176, v176
    v_exp_f32 v177, v177
    v_exp_f32 v178, v178
    v_exp_f32 v179, v179
    v_pk_fma_f32 v[176:177], v[176:177], v[170:171], v[170:171]
    v_pk_fma_f32 v[178:179], v[178:179], v[170:171], v[170:171]
    v_rcp_f32 v176, v176
    v_rcp_f32 v177, v177
    v_rcp_f32 v178, v178
    v_rcp_f32 v179, v179
    v_pk_mul_f32 v[108:109], v[108:109], v[176:177]
    v_pk_mul_f32 v[110:111], v[110:111], v[178:179]
    v_cvt_pk_bf16_f32 v92, v92, v93
    v_cvt_pk_bf16_f32 v93, v94, v95
    v_cvt_pk_bf16_f32 v94, v108, v109
    v_cvt_pk_bf16_f32 v95, v110, v111
    buffer_store_dwordx4 v[92:95], v13, s[16:19], s37 offen offset:3072 sc0 sc1
    ds_write_b128 v7, v[92:95] offset:35840
    s_waitcnt lgkmcnt(0)
    s_mov_b32 s42, s24
    s_mov_b32 s43, s25
    s_mov_b32 s44, s31
    s_mov_b32 s45, s37
    s_and_b32 s30, s2, 7
    s_lshr_b32 s31, s2, 3
    s_lshr_b32 s24, s30, 2
    s_lshl_b32 s24, s24, 3
    s_and_b32 s25, s30, 3
    s_lshl_b32 s25, s25, 2
    s_lshr_b32 s30, s31, 2
    s_add_u32 s24, s24, s30
    s_and_b32 s30, s31, 3
    s_add_u32 s25, s25, s30
    s_lshr_b32 s34, s3, 1
    s_and_b32 s35, s3, 1
    v_lshlrev_b32 v13, 4, v1
    s_lshl_b32 s30, s34, 12
    v_add_u32 v13, s30, v13
    v_lshrrev_b32 v12, 4, v1
    v_bfe_u32 v80, v1, 2, 2
    v_and_b32 v81, 3, v1
    v_mov_b32 v2, v13
    v_mul_u32_u24 v14, 4, v12
    v_add_u32 v14, v14, v80
    v_lshlrev_b32 v14, 7, v14
    v_lshl_add_u32 v14, v81, 3, v14
    v_lshrrev_b32 v15, 1, v80
    v_and_b32 v82, 1, v12
    v_lshl_or_b32 v15, v82, 1, v15
    s_lshl_b32 s30, s35, 1
    v_xor_b32 v15, s30, v15
    v_lshl_add_u32 v4, v15, 5, v14
    v_xor_b32 v15, 1, v15
    v_lshl_add_u32 v5, v15, 5, v14
    v_mov_b32 v16, 0
    v_mov_b32 v17, 0
    v_mov_b32 v18, 0
    v_mov_b32 v19, 0
    v_mov_b32 v20, 0
    v_mov_b32 v21, 0
    v_mov_b32 v22, 0
    v_mov_b32 v23, 0
    v_mov_b32 v24, 0
    v_mov_b32 v25, 0
    v_mov_b32 v26, 0
    v_mov_b32 v27, 0
    v_mov_b32 v28, 0
    v_mov_b32 v29, 0
    v_mov_b32 v30, 0
    v_mov_b32 v31, 0
    v_mov_b32 v32, 0
    v_mov_b32 v33, 0
    v_mov_b32 v34, 0
    v_mov_b32 v35, 0
    v_mov_b32 v36, 0
    v_mov_b32 v37, 0
    v_mov_b32 v38, 0
    v_mov_b32 v39, 0
    v_mov_b32 v40, 0
    v_mov_b32 v41, 0
    v_mov_b32 v42, 0
    v_mov_b32 v43, 0
    v_mov_b32 v44, 0
    v_mov_b32 v45, 0
    v_mov_b32 v46, 0
    v_mov_b32 v47, 0
    v_mov_b32 v48, 0
    v_mov_b32 v49, 0
    v_mov_b32 v50, 0
    v_mov_b32 v51, 0
    v_mov_b32 v52, 0
    v_mov_b32 v53, 0
    v_mov_b32 v54, 0
    v_mov_b32 v55, 0
    v_mov_b32 v56, 0
    v_mov_b32 v57, 0
    v_mov_b32 v58, 0
    v_mov_b32 v59, 0
    v_mov_b32 v60, 0
    v_mov_b32 v61, 0
    v_mov_b32 v62, 0
    v_mov_b32 v63, 0
    v_mov_b32 v64, 0
    v_mov_b32 v65, 0
    v_mov_b32 v66, 0
    v_mov_b32 v67, 0
    v_mov_b32 v68, 0
    v_mov_b32 v69, 0
    v_mov_b32 v70, 0
    v_mov_b32 v71, 0
    v_mov_b32 v72, 0
    v_mov_b32 v73, 0
    v_mov_b32 v74, 0
    v_mov_b32 v75, 0
    v_mov_b32 v76, 0
    v_mov_b32 v77, 0
    v_mov_b32 v78, 0
    v_mov_b32 v79, 0
    s_mov_b32 s27, 0
    s_mov_b32 s32, 77824
    v_add_u32 v7, s27, v2
    v_add_u32 v9, s32, v4
    v_add_u32 v10, s32, v5
    s_mov_b32 s26, 25
    s_barrier
    ds_read_b64_tr_b16 v[96:97], v9 offset:0
    ds_read_b64_tr_b16 v[98:99], v9 offset:2048
    ds_read_b128 v[80:83], v7 offset:0
    ds_read_b128 v[84:87], v7 offset:1024
    ds_read_b128 v[88:91], v7 offset:2048
    ds_read_b128 v[92:95], v7 offset:3072
    ds_read_b64_tr_b16 v[100:101], v10 offset:0
    ds_read_b64_tr_b16 v[102:103], v10 offset:2048
    ds_read_b64_tr_b16 v[104:105], v9 offset:8192
    ds_read_b64_tr_b16 v[106:107], v9 offset:10240
    ds_read_b64_tr_b16 v[108:109], v10 offset:8192
    ds_read_b64_tr_b16 v[110:111], v10 offset:10240
c_loop_17:
    s_cmp_ge_u32 s26, 22
    s_cbranch_scc1 w2early_19
w2back_18:
    s_waitcnt lgkmcnt(0)
    v_mfma_f32_16x16x32_bf16 v[16:19], v[96:99], v[80:83], v[16:19]
    ds_read_b64_tr_b16 v[128:129], v9 offset:4096
    v_mfma_f32_16x16x32_bf16 v[20:23], v[96:99], v[84:87], v[20:23]
    ds_read_b64_tr_b16 v[130:131], v9 offset:6144
    v_mfma_f32_16x16x32_bf16 v[24:27], v[96:99], v[88:91], v[24:27]
    ds_read_b128 v[112:115], v7 offset:8192
    v_mfma_f32_16x16x32_bf16 v[28:31], v[96:99], v[92:95], v[28:31]
    ds_read_b128 v[116:119], v7 offset:9216
    v_mfma_f32_16x16x32_bf16 v[44:47], v[100:103], v[92:95], v[44:47]
    ds_read_b128 v[120:123], v7 offset:10240
    v_mfma_f32_16x16x32_bf16 v[40:43], v[100:103], v[88:91], v[40:43]
    ds_read_b128 v[124:127], v7 offset:11264
    v_mfma_f32_16x16x32_bf16 v[36:39], v[100:103], v[84:87], v[36:39]
    ds_read_b64_tr_b16 v[132:133], v10 offset:4096
    v_mfma_f32_16x16x32_bf16 v[32:35], v[100:103], v[80:83], v[32:35]
    ds_read_b64_tr_b16 v[134:135], v10 offset:6144
    v_mfma_f32_16x16x32_bf16 v[48:51], v[104:107], v[80:83], v[48:51]
    ds_read_b64_tr_b16 v[136:137], v9 offset:12288
    v_mfma_f32_16x16x32_bf16 v[52:55], v[104:107], v[84:87], v[52:55]
    ds_read_b64_tr_b16 v[138:139], v9 offset:14336
    v_mfma_f32_16x16x32_bf16 v[56:59], v[104:107], v[88:91], v[56:59]
    ds_read_b64_tr_b16 v[140:141], v10 offset:12288
    v_mfma_f32_16x16x32_bf16 v[60:63], v[104:107], v[92:95], v[60:63]
    ds_read_b64_tr_b16 v[142:143], v10 offset:14336
    v_mfma_f32_16x16x32_bf16 v[76:79], v[108:111], v[92:95], v[76:79]
    s_add_u32 s27, s27, 16384
    v_mfma_f32_16x16x32_bf16 v[72:75], v[108:111], v[88:91], v[72:75]
    s_add_u32 s32, s32, 16384
    v_mfma_f32_16x16x32_bf16 v[68:71], v[108:111], v[84:87], v[68:71]
    s_cmp_eq_u32 s27, 65536
    v_mfma_f32_16x16x32_bf16 v[64:67], v[108:111], v[80:83], v[64:67]
    s_cselect_b32 s27, 0, s27
    s_cselect_b32 s32, 77824, s32
    v_add_u32 v7, s27, v2
    v_add_u32 v9, s32, v4
    v_add_u32 v10, s32, v5
    s_waitcnt lgkmcnt(0)
    s_barrier
    v_mfma_f32_16x16x32_bf16 v[16:19], v[128:131], v[112:115], v[16:19]
    ds_read_b64_tr_b16 v[96:97], v9 offset:0
    v_mfma_f32_16x16x32_bf16 v[20:23], v[128:131], v[116:119], v[20:23]
    ds_read_b64_tr_b16 v[98:99], v9 offset:2048
    v_mfma_f32_16x16x32_bf16 v[24:27], v[128:131], v[120:123], v[24:27]
    ds_read_b128 v[80:83], v7 offset:0
    v_mfma_f32_16x16x32_bf16 v[28:31], v[128:131], v[124:127], v[28:31]
    ds_read_b128 v[84:87], v7 offset:1024
    v_mfma_f32_16x16x32_bf16 v[44:47], v[132:135], v[124:127], v[44:47]
    ds_read_b128 v[88:91], v7 offset:2048
    v_mfma_f32_16x16x32_bf16 v[40:43], v[132:135], v[120:123], v[40:43]
    ds_read_b128 v[92:95], v7 offset:3072
    v_mfma_f32_16x16x32_bf16 v[36:39], v[132:135], v[116:119], v[36:39]
    ds_read_b64_tr_b16 v[100:101], v10 offset:0
    v_mfma_f32_16x16x32_bf16 v[32:35], v[132:135], v[112:115], v[32:35]
    ds_read_b64_tr_b16 v[102:103], v10 offset:2048
    v_mfma_f32_16x16x32_bf16 v[48:51], v[136:139], v[112:115], v[48:51]
    ds_read_b64_tr_b16 v[104:105], v9 offset:8192
    v_mfma_f32_16x16x32_bf16 v[52:55], v[136:139], v[116:119], v[52:55]
    ds_read_b64_tr_b16 v[106:107], v9 offset:10240
    v_mfma_f32_16x16x32_bf16 v[56:59], v[136:139], v[120:123], v[56:59]
    ds_read_b64_tr_b16 v[108:109], v10 offset:8192
    v_mfma_f32_16x16x32_bf16 v[60:63], v[136:139], v[124:127], v[60:63]
    ds_read_b64_tr_b16 v[110:111], v10 offset:10240
    v_mfma_f32_16x16x32_bf16 v[76:79], v[140:143], v[124:127], v[76:79]
    s_sub_u32 s26, s26, 1
    v_mfma_f32_16x16x32_bf16 v[72:75], v[140:143], v[120:123], v[72:75]
    s_cmp_lg_u32 s26, 0
    v_mfma_f32_16x16x32_bf16 v[68:71], v[140:143], v[116:119], v[68:71]
    v_mfma_f32_16x16x32_bf16 v[64:67], v[140:143], v[112:115], v[64:67]
    s_cbranch_scc1 c_loop_17
    s_waitcnt lgkmcnt(0)
    v_mfma_f32_16x16x32_bf16 v[48:51], v[104:107], v[80:83], v[48:51]
    ds_read_b64_tr_b16 v[136:137], v9 offset:12288
    v_mfma_f32_16x16x32_bf16 v[52:55], v[104:107], v[84:87], v[52:55]
    ds_read_b64_tr_b16 v[138:139], v9 offset:14336
    v_mfma_f32_16x16x32_bf16 v[56:59], v[104:107], v[88:91], v[56:59]
    ds_read_b128 v[112:115], v7 offset:8192
    v_mfma_f32_16x16x32_bf16 v[60:63], v[104:107], v[92:95], v[60:63]
    ds_read_b128 v[116:119], v7 offset:9216
    v_mfma_f32_16x16x32_bf16 v[76:79], v[108:111], v[92:95], v[76:79]
    ds_read_b128 v[120:123], v7 offset:10240
    v_mfma_f32_16x16x32_bf16 v[72:75], v[108:111], v[88:91], v[72:75]
    ds_read_b128 v[124:127], v7 offset:11264
    v_mfma_f32_16x16x32_bf16 v[68:71], v[108:111], v[84:87], v[68:71]
    ds_read_b64_tr_b16 v[140:141], v10 offset:12288
    v_mfma_f32_16x16x32_bf16 v[64:67], v[108:111], v[80:83], v[64:67]
    ds_read_b64_tr_b16 v[142:143], v10 offset:14336
    s_waitcnt lgkmcnt(0)
    v_add_u32 v7, 32768, v2
    v_add_u32 v9, 110592, v4
    v_add_u32 v10, 110592, v5
    s_barrier
    v_mfma_f32_16x16x32_bf16 v[48:51], v[136:139], v[112:115], v[48:51]
    ds_read_b64_tr_b16 v[104:105], v9 offset:8192
    v_mfma_f32_16x16x32_bf16 v[52:55], v[136:139], v[116:119], v[52:55]
    ds_read_b64_tr_b16 v[106:107], v9 offset:10240
    v_mfma_f32_16x16x32_bf16 v[56:59], v[136:139], v[120:123], v[56:59]
    ds_read_b128 v[80:83], v7 offset:0
    v_mfma_f32_16x16x32_bf16 v[60:63], v[136:139], v[124:127], v[60:63]
    ds_read_b128 v[84:87], v7 offset:1024
    v_mfma_f32_16x16x32_bf16 v[76:79], v[140:143], v[124:127], v[76:79]
    ds_read_b128 v[88:91], v7 offset:2048
    v_mfma_f32_16x16x32_bf16 v[72:75], v[140:143], v[120:123], v[72:75]
    ds_read_b128 v[92:95], v7 offset:3072
    v_mfma_f32_16x16x32_bf16 v[68:71], v[140:143], v[116:119], v[68:71]
    ds_read_b64_tr_b16 v[108:109], v10 offset:8192
    v_mfma_f32_16x16x32_bf16 v[64:67], v[140:143], v[112:115], v[64:67]
    ds_read_b64_tr_b16 v[110:111], v10 offset:10240
    s_waitcnt lgkmcnt(0)
    v_mfma_f32_16x16x32_bf16 v[48:51], v[104:107], v[80:83], v[48:51]
    ds_read_b64_tr_b16 v[136:137], v9 offset:12288
    v_mfma_f32_16x16x32_bf16 v[52:55], v[104:107], v[84:87], v[52:55]
    ds_read_b64_tr_b16 v[138:139], v9 offset:14336
    v_mfma_f32_16x16x32_bf16 v[56:59], v[104:107], v[88:91], v[56:59]
    ds_read_b128 v[112:115], v7 offset:8192
    v_mfma_f32_16x16x32_bf16 v[60:63], v[104:107], v[92:95], v[60:63]
    ds_read_b128 v[116:119], v7 offset:9216
    v_mfma_f32_16x16x32_bf16 v[76:79], v[108:111], v[92:95], v[76:79]
    ds_read_b128 v[120:123], v7 offset:10240
    v_mfma_f32_16x16x32_bf16 v[72:75], v[108:111], v[88:91], v[72:75]
    ds_read_b128 v[124:127], v7 offset:11264
    v_mfma_f32_16x16x32_bf16 v[68:71], v[108:111], v[84:87], v[68:71]
    ds_read_b64_tr_b16 v[140:141], v10 offset:12288
    v_mfma_f32_16x16x32_bf16 v[64:67], v[108:111], v[80:83], v[64:67]
    ds_read_b64_tr_b16 v[142:143], v10 offset:14336
    s_waitcnt lgkmcnt(0)
    v_add_u32 v7, 49152, v2
    v_add_u32 v9, 126976, v4
    v_add_u32 v10, 126976, v5
    s_barrier
    v_mfma_f32_16x16x32_bf16 v[48:51], v[136:139], v[112:115], v[48:51]
    ds_read_b64_tr_b16 v[104:105], v9 offset:8192
    v_mfma_f32_16x16x32_bf16 v[52:55], v[136:139], v[116:119], v[52:55]
    ds_read_b64_tr_b16 v[106:107], v9 offset:10240
    v_mfma_f32_16x16x32_bf16 v[56:59], v[136:139], v[120:123], v[56:59]
    ds_read_b128 v[80:83], v7 offset:0
    v_mfma_f32_16x16x32_bf16 v[60:63], v[136:139], v[124:127], v[60:63]
    ds_read_b128 v[84:87], v7 offset:1024
    v_mfma_f32_16x16x32_bf16 v[76:79], v[140:143], v[124:127], v[76:79]
    ds_read_b128 v[88:91], v7 offset:2048
    v_mfma_f32_16x16x32_bf16 v[72:75], v[140:143], v[120:123], v[72:75]
    ds_read_b128 v[92:95], v7 offset:3072
    v_mfma_f32_16x16x32_bf16 v[68:71], v[140:143], v[116:119], v[68:71]
    ds_read_b64_tr_b16 v[108:109], v10 offset:8192
    v_mfma_f32_16x16x32_bf16 v[64:67], v[140:143], v[112:115], v[64:67]
    ds_read_b64_tr_b16 v[110:111], v10 offset:10240
    s_waitcnt lgkmcnt(0)
    v_mfma_f32_16x16x32_bf16 v[48:51], v[104:107], v[80:83], v[48:51]
    ds_read_b64_tr_b16 v[136:137], v9 offset:12288
    v_mfma_f32_16x16x32_bf16 v[52:55], v[104:107], v[84:87], v[52:55]
    ds_read_b64_tr_b16 v[138:139], v9 offset:14336
    v_mfma_f32_16x16x32_bf16 v[56:59], v[104:107], v[88:91], v[56:59]
    ds_read_b128 v[112:115], v7 offset:8192
    v_mfma_f32_16x16x32_bf16 v[60:63], v[104:107], v[92:95], v[60:63]
    ds_read_b128 v[116:119], v7 offset:9216
    v_mfma_f32_16x16x32_bf16 v[76:79], v[108:111], v[92:95], v[76:79]
    ds_read_b128 v[120:123], v7 offset:10240
    v_mfma_f32_16x16x32_bf16 v[72:75], v[108:111], v[88:91], v[72:75]
    ds_read_b128 v[124:127], v7 offset:11264
    v_mfma_f32_16x16x32_bf16 v[68:71], v[108:111], v[84:87], v[68:71]
    ds_read_b64_tr_b16 v[140:141], v10 offset:12288
    v_mfma_f32_16x16x32_bf16 v[64:67], v[108:111], v[80:83], v[64:67]
    ds_read_b64_tr_b16 v[142:143], v10 offset:14336
    s_waitcnt lgkmcnt(0)
    v_add_u32 v7, 16384, v2
    v_add_u32 v9, 94208, v4
    v_add_u32 v10, 94208, v5
    v_mfma_f32_16x16x32_bf16 v[48:51], v[136:139], v[112:115], v[48:51]
    ds_read_b64_tr_b16 v[96:97], v9 offset:0
    v_mfma_f32_16x16x32_bf16 v[52:55], v[136:139], v[116:119], v[52:55]
    ds_read_b64_tr_b16 v[98:99], v9 offset:2048
    v_mfma_f32_16x16x32_bf16 v[56:59], v[136:139], v[120:123], v[56:59]
    ds_read_b128 v[80:83], v7 offset:0
    v_mfma_f32_16x16x32_bf16 v[60:63], v[136:139], v[124:127], v[60:63]
    ds_read_b128 v[84:87], v7 offset:1024
    v_mfma_f32_16x16x32_bf16 v[76:79], v[140:143], v[124:127], v[76:79]
    ds_read_b128 v[88:91], v7 offset:2048
    v_mfma_f32_16x16x32_bf16 v[72:75], v[140:143], v[120:123], v[72:75]
    ds_read_b128 v[92:95], v7 offset:3072
    v_mfma_f32_16x16x32_bf16 v[68:71], v[140:143], v[116:119], v[68:71]
    ds_read_b64_tr_b16 v[100:101], v10 offset:0
    v_mfma_f32_16x16x32_bf16 v[64:67], v[140:143], v[112:115], v[64:67]
    ds_read_b64_tr_b16 v[102:103], v10 offset:2048
    s_barrier
    s_add_u32 s20, s4, 46137344
    s_addc_u32 s21, s5, 0
    s_mov_b32 s22, 8388608
    s_mov_b32 s23, 0x20000
    s_lshl_b32 s30, s24, 18
    s_lshl_b32 s31, s3, 12
    s_add_u32 s30, s30, s31
    s_lshl_b32 s31, s25, 14
    s_add_u32 s33, s30, s31
    s_xor_b32 s31, s31, 65536
    s_add_u32 s37, s30, s31
    v_lshlrev_b32 v148, 4, v1
    v_cvt_pk_bf16_f32 v48, v48, v49
    v_cvt_pk_bf16_f32 v49, v50, v51
    v_cvt_pk_bf16_f32 v50, v64, v65
    v_cvt_pk_bf16_f32 v51, v66, v67
    buffer_store_dwordx4 v[48:51], v148, s[20:23], s33 offen offset:0 sc0 sc1
    v_cvt_pk_bf16_f32 v52, v52, v53
    v_cvt_pk_bf16_f32 v53, v54, v55
    v_cvt_pk_bf16_f32 v54, v68, v69
    v_cvt_pk_bf16_f32 v55, v70, v71
    buffer_store_dwordx4 v[52:55], v148, s[20:23], s33 offen offset:1024 sc0 sc1
    v_cvt_pk_bf16_f32 v56, v56, v57
    v_cvt_pk_bf16_f32 v57, v58, v59
    v_cvt_pk_bf16_f32 v58, v72, v73
    v_cvt_pk_bf16_f32 v59, v74, v75
    buffer_store_dwordx4 v[56:59], v148, s[20:23], s33 offen offset:2048 sc0 sc1
    v_cvt_pk_bf16_f32 v60, v60, v61
    v_cvt_pk_bf16_f32 v61, v62, v63
    v_cvt_pk_bf16_f32 v62, v76, v77
    v_cvt_pk_bf16_f32 v63, v78, v79
    buffer_store_dwordx4 v[60:63], v148, s[20:23], s33 offen offset:3072 sc0 sc1
    s_waitcnt lgkmcnt(0)
    v_mfma_f32_16x16x32_bf16 v[16:19], v[96:99], v[80:83], v[16:19]
    ds_read_b64_tr_b16 v[128:129], v9 offset:4096
    v_mfma_f32_16x16x32_bf16 v[20:23], v[96:99], v[84:87], v[20:23]
    ds_read_b64_tr_b16 v[130:131], v9 offset:6144
    v_mfma_f32_16x16x32_bf16 v[24:27], v[96:99], v[88:91], v[24:27]
    ds_read_b128 v[112:115], v7 offset:8192
    v_mfma_f32_16x16x32_bf16 v[28:31], v[96:99], v[92:95], v[28:31]
    ds_read_b128 v[116:119], v7 offset:9216
    v_mfma_f32_16x16x32_bf16 v[44:47], v[100:103], v[92:95], v[44:47]
    ds_read_b128 v[120:123], v7 offset:10240
    v_mfma_f32_16x16x32_bf16 v[40:43], v[100:103], v[88:91], v[40:43]
    ds_read_b128 v[124:127], v7 offset:11264
    v_mfma_f32_16x16x32_bf16 v[36:39], v[100:103], v[84:87], v[36:39]
    ds_read_b64_tr_b16 v[132:133], v10 offset:4096
    v_mfma_f32_16x16x32_bf16 v[32:35], v[100:103], v[80:83], v[32:35]
    ds_read_b64_tr_b16 v[134:135], v10 offset:6144
    s_waitcnt lgkmcnt(0)
    v_add_u32 v7, 32768, v2
    v_add_u32 v9, 110592, v4
    v_add_u32 v10, 110592, v5
    v_mfma_f32_16x16x32_bf16 v[16:19], v[128:131], v[112:115], v[16:19]
    ds_read_b64_tr_b16 v[96:97], v9 offset:0
    v_mfma_f32_16x16x32_bf16 v[20:23], v[128:131], v[116:119], v[20:23]
    ds_read_b64_tr_b16 v[98:99], v9 offset:2048
    v_mfma_f32_16x16x32_bf16 v[24:27], v[128:131], v[120:123], v[24:27]
    ds_read_b128 v[80:83], v7 offset:0
    v_mfma_f32_16x16x32_bf16 v[28:31], v[128:131], v[124:127], v[28:31]
    ds_read_b128 v[84:87], v7 offset:1024
    v_mfma_f32_16x16x32_bf16 v[44:47], v[132:135], v[124:127], v[44:47]
    ds_read_b128 v[88:91], v7 offset:2048
    v_mfma_f32_16x16x32_bf16 v[40:43], v[132:135], v[120:123], v[40:43]
    ds_read_b128 v[92:95], v7 offset:3072
    v_mfma_f32_16x16x32_bf16 v[36:39], v[132:135], v[116:119], v[36:39]
    ds_read_b64_tr_b16 v[100:101], v10 offset:0
    v_mfma_f32_16x16x32_bf16 v[32:35], v[132:135], v[112:115], v[32:35]
    ds_read_b64_tr_b16 v[102:103], v10 offset:2048
    s_waitcnt lgkmcnt(0)
    v_mfma_f32_16x16x32_bf16 v[16:19], v[96:99], v[80:83], v[16:19]
    ds_read_b64_tr_b16 v[128:129], v9 offset:4096
    v_mfma_f32_16x16x32_bf16 v[20:23], v[96:99], v[84:87], v[20:23]
    ds_read_b64_tr_b16 v[130:131], v9 offset:6144
    v_mfma_f32_16x16x32_bf16 v[24:27], v[96:99], v[88:91], v[24:27]
    ds_read_b128 v[112:115], v7 offset:8192
    v_mfma_f32_16x16x32_bf16 v[28:31], v[96:99], v[92:95], v[28:31]
    ds_read_b128 v[116:119], v7 offset:9216
    v_mfma_f32_16x16x32_bf16 v[44:47], v[100:103], v[92:95], v[44:47]
    ds_read_b128 v[120:123], v7 offset:10240
    v_mfma_f32_16x16x32_bf16 v[40:43], v[100:103], v[88:91], v[40:43]
    ds_read_b128 v[124:127], v7 offset:11264
    v_mfma_f32_16x16x32_bf16 v[36:39], v[100:103], v[84:87], v[36:39]
    ds_read_b64_tr_b16 v[132:133], v10 offset:4096
    v_mfma_f32_16x16x32_bf16 v[32:35], v[100:103], v[80:83], v[32:35]
    ds_read_b64_tr_b16 v[134:135], v10 offset:6144
    s_waitcnt lgkmcnt(0)
    v_add_u32 v7, 49152, v2
    v_add_u32 v9, 126976, v4
    v_add_u32 v10, 126976, v5
    v_mfma_f32_16x16x32_bf16 v[16:19], v[128:131], v[112:115], v[16:19]
    ds_read_b64_tr_b16 v[96:97], v9 offset:0
    v_mfma_f32_16x16x32_bf16 v[20:23], v[128:131], v[116:119], v[20:23]
    ds_read_b64_tr_b16 v[98:99], v9 offset:2048
    v_mfma_f32_16x16x32_bf16 v[24:27], v[128:131], v[120:123], v[24:27]
    ds_read_b128 v[80:83], v7 offset:0
    v_mfma_f32_16x16x32_bf16 v[28:31], v[128:131], v[124:127], v[28:31]
    ds_read_b128 v[84:87], v7 offset:1024
    v_mfma_f32_16x16x32_bf16 v[44:47], v[132:135], v[124:127], v[44:47]
    ds_read_b128 v[88:91], v7 offset:2048
    v_mfma_f32_16x16x32_bf16 v[40:43], v[132:135], v[120:123], v[40:43]
    ds_read_b128 v[92:95], v7 offset:3072
    v_mfma_f32_16x16x32_bf16 v[36:39], v[132:135], v[116:119], v[36:39]
    ds_read_b64_tr_b16 v[100:101], v10 offset:0
    v_mfma_f32_16x16x32_bf16 v[32:35], v[132:135], v[112:115], v[32:35]
    ds_read_b64_tr_b16 v[102:103], v10 offset:2048
    s_waitcnt lgkmcnt(0)
    v_mfma_f32_16x16x32_bf16 v[16:19], v[96:99], v[80:83], v[16:19]
    ds_read_b64_tr_b16 v[128:129], v9 offset:4096
    v_mfma_f32_16x16x32_bf16 v[20:23], v[96:99], v[84:87], v[20:23]
    ds_read_b64_tr_b16 v[130:131], v9 offset:6144
    v_mfma_f32_16x16x32_bf16 v[24:27], v[96:99], v[88:91], v[24:27]
    ds_read_b128 v[112:115], v7 offset:8192
    v_mfma_f32_16x16x32_bf16 v[28:31], v[96:99], v[92:95], v[28:31]
    ds_read_b128 v[116:119], v7 offset:9216
    v_mfma_f32_16x16x32_bf16 v[44:47], v[100:103], v[92:95], v[44:47]
    ds_read_b128 v[120:123], v7 offset:10240
    v_mfma_f32_16x16x32_bf16 v[40:43], v[100:103], v[88:91], v[40:43]
    ds_read_b128 v[124:127], v7 offset:11264
    v_mfma_f32_16x16x32_bf16 v[36:39], v[100:103], v[84:87], v[36:39]
    ds_read_b64_tr_b16 v[132:133], v10 offset:4096
    v_mfma_f32_16x16x32_bf16 v[32:35], v[100:103], v[80:83], v[32:35]
    ds_read_b64_tr_b16 v[134:135], v10 offset:6144
    s_lshl_b32 s40, s24, 10
    s_lshl_b32 s41, s25, 5
    s_add_u32 s40, s40, s41
    s_lshl_b32 s41, s3, 3
    s_add_u32 s40, s40, s41
    s_add_u32 s40, s40, 98304
    v_mov_b32 v144, s72
    v_mov_b32 v145, s73
    v_mov_b32 v146, 0
    s_waitcnt vmcnt(0)
    s_mov_b64 exec, 1
    buffer_store_dwordx2 v[144:145], v146, s[76:79], s40 offen sc0 sc1
    s_mov_b64 exec, -1
    s_waitcnt lgkmcnt(0)
    v_mfma_f32_16x16x32_bf16 v[16:19], v[128:131], v[112:115], v[16:19]
    v_mfma_f32_16x16x32_bf16 v[20:23], v[128:131], v[116:119], v[20:23]
    v_mfma_f32_16x16x32_bf16 v[24:27], v[128:131], v[120:123], v[24:27]
    v_mfma_f32_16x16x32_bf16 v[28:31], v[128:131], v[124:127], v[28:31]
    v_mfma_f32_16x16x32_bf16 v[44:47], v[132:135], v[124:127], v[44:47]
    v_mfma_f32_16x16x32_bf16 v[40:43], v[132:135], v[120:123], v[40:43]
    v_mfma_f32_16x16x32_bf16 v[36:39], v[132:135], v[116:119], v[36:39]
    v_mfma_f32_16x16x32_bf16 v[32:35], v[132:135], v[112:115], v[32:35]
    s_waitcnt lgkmcnt(0)
    s_add_u32 s16, s92, 0
    s_addc_u32 s17, s93, 0
    s_mov_b32 s18, 4194304
    s_mov_b32 s19, 0x20000
    v_and_b32 v14, 15, v1
    v_lshlrev_b32 v14, 11, v14
    v_and_b32 v15, 1, v12
    v_lshl_add_u32 v14, v15, 5, v14
    v_lshrrev_b32 v15, 1, v12
    v_lshl_add_u32 v14, v15, 4, v14
    s_lshl_b32 s30, s24, 18
    s_lshl_b32 s31, s34, 17
    s_add_u32 s30, s30, s31
    s_lshl_b32 s31, s25, 7
    s_add_u32 s30, s30, s31
    s_lshl_b32 s31, s35, 6
    s_add_u32 s30, s30, s31
    s_mov_b32 s36, 0xffff0000
    v_lshlrev_b32 v96, 16, v232
    v_and_b32 v97, s36, v232
    v_pk_add_f32 v[16:17], v[16:17], v[96:97]
    v_lshlrev_b32 v96, 16, v233
    v_and_b32 v97, s36, v233
    v_pk_add_f32 v[18:19], v[18:19], v[96:97]
    v_lshlrev_b32 v96, 16, v234
    v_and_b32 v97, s36, v234
    v_pk_add_f32 v[32:33], v[32:33], v[96:97]
    v_lshlrev_b32 v96, 16, v235
    v_and_b32 v97, s36, v235
    v_pk_add_f32 v[34:35], v[34:35], v[96:97]
    v_lshlrev_b32 v96, 16, v236
    v_and_b32 v97, s36, v236
    v_pk_add_f32 v[20:21], v[20:21], v[96:97]
    v_lshlrev_b32 v96, 16, v237
    v_and_b32 v97, s36, v237
    v_pk_add_f32 v[22:23], v[22:23], v[96:97]
    v_lshlrev_b32 v96, 16, v238
    v_and_b32 v97, s36, v238
    v_pk_add_f32 v[36:37], v[36:37], v[96:97]
    v_lshlrev_b32 v96, 16, v239
    v_and_b32 v97, s36, v239
    v_pk_add_f32 v[38:39], v[38:39], v[96:97]
    v_lshlrev_b32 v96, 16, v240
    v_and_b32 v97, s36, v240
    v_pk_add_f32 v[24:25], v[24:25], v[96:97]
    v_lshlrev_b32 v96, 16, v241
    v_and_b32 v97, s36, v241
    v_pk_add_f32 v[26:27], v[26:27], v[96:97]
    v_lshlrev_b32 v96, 16, v242
    v_and_b32 v97, s36, v242
    v_pk_add_f32 v[40:41], v[40:41], v[96:97]
    v_lshlrev_b32 v96, 16, v243
    v_and_b32 v97, s36, v243
    v_pk_add_f32 v[42:43], v[42:43], v[96:97]
    v_lshlrev_b32 v96, 16, v244
    v_and_b32 v97, s36, v244
    v_pk_add_f32 v[28:29], v[28:29], v[96:97]
    v_lshlrev_b32 v96, 16, v245
    v_and_b32 v97, s36, v245
    v_pk_add_f32 v[30:31], v[30:31], v[96:97]
    v_lshlrev_b32 v96, 16, v246
    v_and_b32 v97, s36, v246
    v_pk_add_f32 v[44:45], v[44:45], v[96:97]
    v_lshlrev_b32 v96, 16, v247
    v_and_b32 v97, s36, v247
    v_pk_add_f32 v[46:47], v[46:47], v[96:97]
    s_xor_b32 s40, s40, 128
    s_mov_b32 s39, 0x200000
xpoll_20:
    buffer_load_dwordx2 v[84:85], v146, s[76:79], s40 offen sc0 sc1
    s_waitcnt vmcnt(0)
    v_cmp_eq_u64 vcc, s[72:73], v[84:85]
    s_nop 3
    s_cmp_eq_u64 vcc, -1
    s_cbranch_scc1 skip_xp_21
    s_sub_u32 s39, s39, 1
    s_cbranch_scc0 xpoll_20
skip_xp_21:
    buffer_load_dwordx4 v[112:115], v148, s[20:23], s37 offen offset:0 sc0 sc1
    buffer_load_dwordx4 v[116:119], v148, s[20:23], s37 offen offset:1024 sc0 sc1
    buffer_load_dwordx4 v[120:123], v148, s[20:23], s37 offen offset:2048 sc0 sc1
    buffer_load_dwordx4 v[124:127], v148, s[20:23], s37 offen offset:3072 sc0 sc1
    s_waitcnt vmcnt(3)
    v_lshlrev_b32 v96, 16, v112
    v_and_b32 v97, s36, v112
    v_pk_add_f32 v[16:17], v[16:17], v[96:97]
    v_lshlrev_b32 v96, 16, v113
    v_and_b32 v97, s36, v113
    v_pk_add_f32 v[18:19], v[18:19], v[96:97]
    v_lshlrev_b32 v96, 16, v114
    v_and_b32 v97, s36, v114
    v_pk_add_f32 v[32:33], v[32:33], v[96:97]
    v_lshlrev_b32 v96, 16, v115
    v_and_b32 v97, s36, v115
    v_pk_add_f32 v[34:35], v[34:35], v[96:97]
    v_cvt_pk_bf16_f32 v80, v16, v17
    v_cvt_pk_bf16_f32 v81, v18, v19
    v_cvt_pk_bf16_f32 v82, v32, v33
    v_cvt_pk_bf16_f32 v83, v34, v35
    s_nop 0
    v_permlane16_swap_b32 v80, v82
    v_permlane16_swap_b32 v81, v83
    buffer_store_dwordx4 v[80:83], v14, s[16:19], s30 offen sc0 sc1
    s_add_u32 s30, s30, 32768
    s_waitcnt vmcnt(3)
    v_lshlrev_b32 v96, 16, v116
    v_and_b32 v97, s36, v116
    v_pk_add_f32 v[20:21], v[20:21], v[96:97]
    v_lshlrev_b32 v96, 16, v117
    v_and_b32 v97, s36, v117
    v_pk_add_f32 v[22:23], v[22:23], v[96:97]
    v_lshlrev_b32 v96, 16, v118
    v_and_b32 v97, s36, v118
    v_pk_add_f32 v[36:37], v[36:37], v[96:97]
    v_lshlrev_b32 v96, 16, v119
    v_and_b32 v97, s36, v119
    v_pk_add_f32 v[38:39], v[38:39], v[96:97]
    v_cvt_pk_bf16_f32 v84, v20, v21
    v_cvt_pk_bf16_f32 v85, v22, v23
    v_cvt_pk_bf16_f32 v86, v36, v37
    v_cvt_pk_bf16_f32 v87, v38, v39
    s_nop 0
    v_permlane16_swap_b32 v84, v86
    v_permlane16_swap_b32 v85, v87
    buffer_store_dwordx4 v[84:87], v14, s[16:19], s30 offen sc0 sc1
    s_add_u32 s30, s30, 32768
    s_waitcnt vmcnt(3)
    v_lshlrev_b32 v96, 16, v120
    v_and_b32 v97, s36, v120
    v_pk_add_f32 v[24:25], v[24:25], v[96:97]
    v_lshlrev_b32 v96, 16, v121
    v_and_b32 v97, s36, v121
    v_pk_add_f32 v[26:27], v[26:27], v[96:97]
    v_lshlrev_b32 v96, 16, v122
    v_and_b32 v97, s36, v122
    v_pk_add_f32 v[40:41], v[40:41], v[96:97]
    v_lshlrev_b32 v96, 16, v123
    v_and_b32 v97, s36, v123
    v_pk_add_f32 v[42:43], v[42:43], v[96:97]
    v_cvt_pk_bf16_f32 v88, v24, v25
    v_cvt_pk_bf16_f32 v89, v26, v27
    v_cvt_pk_bf16_f32 v90, v40, v41
    v_cvt_pk_bf16_f32 v91, v42, v43
    s_nop 0
    v_permlane16_swap_b32 v88, v90
    v_permlane16_swap_b32 v89, v91
    buffer_store_dwordx4 v[88:91], v14, s[16:19], s30 offen sc0 sc1
    s_add_u32 s30, s30, 32768
    s_waitcnt vmcnt(3)
    v_lshlrev_b32 v96, 16, v124
    v_and_b32 v97, s36, v124
    v_pk_add_f32 v[28:29], v[28:29], v[96:97]
    v_lshlrev_b32 v96, 16, v125
    v_and_b32 v97, s36, v125
    v_pk_add_f32 v[30:31], v[30:31], v[96:97]
    v_lshlrev_b32 v96, 16, v126
    v_and_b32 v97, s36, v126
    v_pk_add_f32 v[44:45], v[44:45], v[96:97]
    v_lshlrev_b32 v96, 16, v127
    v_and_b32 v97, s36, v127
    v_pk_add_f32 v[46:47], v[46:47], v[96:97]
    v_cvt_pk_bf16_f32 v92, v28, v29
    v_cvt_pk_bf16_f32 v93, v30, v31
    v_cvt_pk_bf16_f32 v94, v44, v45
    v_cvt_pk_bf16_f32 v95, v46, v47
    s_nop 0
    v_permlane16_swap_b32 v92, v94
    v_permlane16_swap_b32 v93, v95
    buffer_store_dwordx4 v[92:95], v14, s[16:19], s30 offen sc0 sc1
    s_add_u32 s30, s30, 32768
    s_endpgm
w2early_19:
    s_cmp_lg_u32 s26, 22
    s_cbranch_scc1 w2back_18
    s_lshl_b32 s40, s42, 10
    s_lshl_b32 s41, s43, 5
    s_add_u32 s40, s40, s41
    s_lshl_b32 s41, s3, 3
    s_add_u32 s40, s40, s41
    s_add_u32 s40, s40, 49152
    v_mov_b32 v144, s72
    v_mov_b32 v145, s73
    v_mov_b32 v146, 0
    s_waitcnt vmcnt(0)
    s_mov_b64 exec, 1
    buffer_store_dwordx2 v[144:145], v146, s[76:79], s40 offen sc0 sc1
    s_mov_b64 exec, -1
    s_branch w2back_18
L_prod2:
    s_and_b32 s30, s2, 7
    s_lshr_b32 s31, s2, 3
    s_lshr_b32 s24, s30, 2
    s_lshl_b32 s24, s24, 3
    s_and_b32 s25, s30, 3
    s_lshl_b32 s25, s25, 2
    s_lshr_b32 s30, s31, 2
    s_add_u32 s24, s24, s30
    s_and_b32 s30, s31, 3
    s_add_u32 s25, s25, s30
    s_mul_i32 s30, s24, 262144
    s_add_u32 s30, s30, 16777216
    s_add_u32 s8, s4, s30
    s_addc_u32 s9, s5, 0
    s_mov_b32 s10, 262144
    s_mov_b32 s11, 0x20000
    s_and_b32 s30, s38, 3
    s_lshl_b32 s30, s30, 12
    v_lshlrev_b32 v4, 4, v1
    v_add_u32 v4, s30, v4
    s_and_b32 s65, s25, 3
    s_mul_i32 s65, s65, 4
    s_mov_b32 s65, 4
    s_lshl_b32 s34, s38, 12
    s_mul_i32 s35, s38, 2048
    s_mul_i32 s30, s25, 128
    s_sub_u32 s31, 2097152, s30
    s_add_u32 s12, s84, s30
    s_addc_u32 s13, s85, 0
    s_mov_b32 s14, s31
    s_mov_b32 s15, 0x20000
    v_lshrrev_b32 v2, 3, v1
    v_mul_u32_u24 v2, 2048, v2
    v_bfe_u32 v3, v1, 4, 2
    v_lshlrev_b32 v3, 1, v3
    v_and_b32 v15, 7, v1
    v_xor_b32 v3, v3, v15
    v_lshl_add_u32 v2, v3, 4, v2
    s_mul_i32 s36, s38, 2
    s_add_u32 s30, s36, 0
    s_and_b32 s31, s30, 7
    s_mul_i32 s31, s31, 16384
    v_add_u32 v8, s31, v2
    s_add_u32 s30, s36, 1
    s_and_b32 s31, s30, 7
    s_mul_i32 s31, s31, 16384
    s_sub_u32 s31, s31, 1024
    v_add_u32 v9, s31, v2
    s_mov_b32 s27, 0
    s_mov_b32 s32, 114688
    s_mul_i32 s28, s65, 16384
    s_mul_i32 s29, s65, 131072
    s_add_u32 s29, s29, 524288
    s_and_b32 s29, s29, 2097151
    s_lshl_b32 s30, s65, 2
    v_add_u32 v26, s30, v1
    v_and_b32 v26, 63, v26
    v_lshlrev_b32 v26, 4, v26
    s_lshl_b32 s33, s24, 10
    s_add_u32 s33, s33, 16384
    s_mov_b64 s[56:57], 0
    s_mov_b32 s39, 0x200000
gate_39:
    s_bfe_u32 s30, s56, 0x40000
    s_cmp_eq_u32 s30, 15
    s_cbranch_scc1 skip_gate_40
    buffer_load_dwordx4 v[28:31], v26, s[76:79], s33 offen sc0 sc1
    s_waitcnt vmcnt(0)
    v_cmp_eq_u64 s[56:57], s[72:73], v[28:29]
    v_cmp_eq_u64 s[58:59], s[72:73], v[30:31]
    s_nop 3
    s_and_b64 s[56:57], s[56:57], s[58:59]
    s_sub_u32 s39, s39, 1
    s_cselect_b64 s[58:59], -1, 0
    s_cselect_b32 s39, 0, s39
    s_or_b64 s[56:57], s[56:57], s[58:59]
    s_branch gate_39
skip_gate_40:
    s_add_u32 m0, s34, 0
    s_nop 0
    buffer_load_dwordx4 v4, s[8:11], s28 offen offset:0 sc1 lds
    buffer_load_dwordx4 v4, s[8:11], s28 offen offset:1024 sc1 lds
    buffer_load_dwordx4 v4, s[8:11], s28 offen offset:2048 sc1 lds
    buffer_load_dwordx4 v4, s[8:11], s28 offen offset:3072 sc1 lds
    s_add_u32 s28, s28, 16384
    s_and_b32 s28, s28, 262143
gate_41:
    s_bfe_u32 s30, s56, 0x40004
    s_cmp_eq_u32 s30, 15
    s_cbranch_scc1 skip_gate_42
    buffer_load_dwordx4 v[28:31], v26, s[76:79], s33 offen sc0 sc1
    s_waitcnt vmcnt(0)
    v_cmp_eq_u64 s[56:57], s[72:73], v[28:29]
    v_cmp_eq_u64 s[58:59], s[72:73], v[30:31]
    s_nop 3
    s_and_b64 s[56:57], s[56:57], s[58:59]
    s_sub_u32 s39, s39, 1
    s_cselect_b64 s[58:59], -1, 0
    s_cselect_b32 s39, 0, s39
    s_or_b64 s[56:57], s[56:57], s[58:59]
    s_branch gate_41
skip_gate_42:
    s_add_u32 m0, s34, 16384
    s_nop 0
    buffer_load_dwordx4 v4, s[8:11], s28 offen offset:0 sc1 lds
    buffer_load_dwordx4 v4, s[8:11], s28 offen offset:1024 sc1 lds
    buffer_load_dwordx4 v4, s[8:11], s28 offen offset:2048 sc1 lds
    buffer_load_dwordx4 v4, s[8:11], s28 offen offset:3072 sc1 lds
    s_add_u32 s28, s28, 16384
    s_and_b32 s28, s28, 262143
    s_waitcnt vmcnt(4)
    s_barrier
gate_43:
    s_bfe_u32 s30, s56, 0x40008
    s_cmp_eq_u32 s30, 15
    s_cbranch_scc1 skip_gate_44
    buffer_load_dwordx4 v[28:31], v26, s[76:79], s33 offen sc0 sc1
    s_waitcnt vmcnt(0)
    v_cmp_eq_u64 s[56:57], s[72:73], v[28:29]
    v_cmp_eq_u64 s[58:59], s[72:73], v[30:31]
    s_nop 3
    s_and_b64 s[56:57], s[56:57], s[58:59]
    s_sub_u32 s39, s39, 1
    s_cselect_b64 s[58:59], -1, 0
    s_cselect_b32 s39, 0, s39
    s_or_b64 s[56:57], s[56:57], s[58:59]
    s_branch gate_43
skip_gate_44:
    s_add_u32 m0, s34, 32768
    s_nop 0
    buffer_load_dwordx4 v4, s[8:11], s28 offen offset:0 sc1 lds
    buffer_load_dwordx4 v4, s[8:11], s28 offen offset:1024 sc1 lds
    buffer_load_dwordx4 v4, s[8:11], s28 offen offset:2048 sc1 lds
    buffer_load_dwordx4 v4, s[8:11], s28 offen offset:3072 sc1 lds
    s_add_u32 s28, s28, 16384
    s_and_b32 s28, s28, 262143
gate_45:
    s_bfe_u32 s30, s56, 0x4000c
    s_cmp_eq_u32 s30, 15
    s_cbranch_scc1 skip_gate_46
    buffer_load_dwordx4 v[28:31], v26, s[76:79], s33 offen sc0 sc1
    s_waitcnt vmcnt(0)
    v_cmp_eq_u64 s[56:57], s[72:73], v[28:29]
    v_cmp_eq_u64 s[58:59], s[72:73], v[30:31]
    s_nop 3
    s_and_b64 s[56:57], s[56:57], s[58:59]
    s_sub_u32 s39, s39, 1
    s_cselect_b64 s[58:59], -1, 0
    s_cselect_b32 s39, 0, s39
    s_or_b64 s[56:57], s[56:57], s[58:59]
    s_branch gate_45
skip_gate_46:
    s_add_u32 m0, s34, 49152
    s_nop 0
    buffer_load_dwordx4 v4, s[8:11], s28 offen offset:0 sc1 lds
    buffer_load_dwordx4 v4, s[8:11], s28 offen offset:1024 sc1 lds
    buffer_load_dwordx4 v4, s[8:11], s28 offen offset:2048 sc1 lds
    buffer_load_dwordx4 v4, s[8:11], s28 offen offset:3072 sc1 lds
    s_add_u32 s28, s28, 16384
    s_and_b32 s28, s28, 262143
    s_waitcnt vmcnt(8)
    s_barrier
gate_47:
    s_bfe_u32 s30, s56, 0x40010
    s_cmp_eq_u32 s30, 15
    s_cbranch_scc1 skip_gate_48
    buffer_load_dwordx4 v[28:31], v26, s[76:79], s33 offen sc0 sc1
    s_waitcnt vmcnt(0)
    v_cmp_eq_u64 s[56:57], s[72:73], v[28:29]
    v_cmp_eq_u64 s[58:59], s[72:73], v[30:31]
    s_nop 3
    s_and_b64 s[56:57], s[56:57], s[58:59]
    s_sub_u32 s39, s39, 1
    s_cselect_b64 s[58:59], -1, 0
    s_cselect_b32 s39, 0, s39
    s_or_b64 s[56:57], s[56:57], s[58:59]
    s_branch gate_47
skip_gate_48:
    s_add_u32 m0, s34, 0
    s_nop 0
    buffer_load_dwordx4 v4, s[8:11], s28 offen offset:0 sc1 lds
    buffer_load_dwordx4 v4, s[8:11], s28 offen offset:1024 sc1 lds
    buffer_load_dwordx4 v4, s[8:11], s28 offen offset:2048 sc1 lds
    buffer_load_dwordx4 v4, s[8:11], s28 offen offset:3072 sc1 lds
    s_add_u32 s28, s28, 16384
    s_and_b32 s28, s28, 262143
    s_add_u32 m0, s35, 114688
    s_nop 0
    buffer_load_dwordx4 v8, s[12:15], s29 offen offset:0 lds
    buffer_load_dwordx4 v9, s[12:15], s29 offen offset:1024 lds
    s_add_u32 s29, s29, 131072
    s_cmp_eq_u32 s29, 2097152
    s_cselect_b32 s29, 0, s29
    s_waitcnt vmcnt(10)
    s_barrier
gate_49:
    s_bfe_u32 s30, s56, 0x40014
    s_cmp_eq_u32 s30, 15
    s_cbranch_scc1 skip_gate_50
    buffer_load_dwordx4 v[28:31], v26, s[76:79], s33 offen sc0 sc1
    s_waitcnt vmcnt(0)
    v_cmp_eq_u64 s[56:57], s[72:73], v[28:29]
    v_cmp_eq_u64 s[58:59], s[72:73], v[30:31]
    s_nop 3
    s_and_b64 s[56:57], s[56:57], s[58:59]
    s_sub_u32 s39, s39, 1
    s_cselect_b64 s[58:59], -1, 0
    s_cselect_b32 s39, 0, s39
    s_or_b64 s[56:57], s[56:57], s[58:59]
    s_branch gate_49
skip_gate_50:
    s_add_u32 m0, s34, 16384
    s_nop 0
    buffer_load_dwordx4 v4, s[8:11], s28 offen offset:0 sc1 lds
    buffer_load_dwordx4 v4, s[8:11], s28 offen offset:1024 sc1 lds
    buffer_load_dwordx4 v4, s[8:11], s28 offen offset:2048 sc1 lds
    buffer_load_dwordx4 v4, s[8:11], s28 offen offset:3072 sc1 lds
    s_add_u32 s28, s28, 16384
    s_and_b32 s28, s28, 262143
    s_add_u32 m0, s35, 122880
    s_nop 0
    buffer_load_dwordx4 v8, s[12:15], s29 offen offset:0 lds
    buffer_load_dwordx4 v9, s[12:15], s29 offen offset:1024 lds
    s_add_u32 s29, s29, 131072
    s_cmp_eq_u32 s29, 2097152
    s_cselect_b32 s29, 0, s29
    s_waitcnt vmcnt(12)
    s_barrier
gate_51:
    s_bfe_u32 s30, s56, 0x40018
    s_cmp_eq_u32 s30, 15
    s_cbranch_scc1 skip_gate_52
    buffer_load_dwordx4 v[28:31], v26, s[76:79], s33 offen sc0 sc1
    s_waitcnt vmcnt(0)
    v_cmp_eq_u64 s[56:57], s[72:73], v[28:29]
    v_cmp_eq_u64 s[58:59], s[72:73], v[30:31]
    s_nop 3
    s_and_b64 s[56:57], s[56:57], s[58:59]
    s_sub_u32 s39, s39, 1
    s_cselect_b64 s[58:59], -1, 0
    s_cselect_b32 s39, 0, s39
    s_or_b64 s[56:57], s[56:57], s[58:59]
    s_branch gate_51
skip_gate_52:
    s_add_u32 m0, s34, 32768
    s_nop 0
    buffer_load_dwordx4 v4, s[8:11], s28 offen offset:0 sc1 lds
    buffer_load_dwordx4 v4, s[8:11], s28 offen offset:1024 sc1 lds
    buffer_load_dwordx4 v4, s[8:11], s28 offen offset:2048 sc1 lds
    buffer_load_dwordx4 v4, s[8:11], s28 offen offset:3072 sc1 lds
    s_add_u32 s28, s28, 16384
    s_and_b32 s28, s28, 262143
    s_add_u32 m0, s35, 131072
    s_nop 0
    buffer_load_dwordx4 v8, s[12:15], s29 offen offset:0 lds
    buffer_load_dwordx4 v9, s[12:15], s29 offen offset:1024 lds
    s_add_u32 s29, s29, 131072
    s_cmp_eq_u32 s29, 2097152
    s_cselect_b32 s29, 0, s29
    s_waitcnt vmcnt(12)
    s_barrier
gate_53:
    s_bfe_u32 s30, s56, 0x4001c
    s_cmp_eq_u32 s30, 15
    s_cbranch_scc1 skip_gate_54
    buffer_load_dwordx4 v[28:31], v26, s[76:79], s33 offen sc0 sc1
    s_waitcnt vmcnt(0)
    v_cmp_eq_u64 s[56:57], s[72:73], v[28:29]
    v_cmp_eq_u64 s[58:59], s[72:73], v[30:31]
    s_nop 3
    s_and_b64 s[56:57], s[56:57], s[58:59]
    s_sub_u32 s39, s39, 1
    s_cselect_b64 s[58:59], -1, 0
    s_cselect_b32 s39, 0, s39
    s_or_b64 s[56:57], s[56:57], s[58:59]
    s_branch gate_53
skip_gate_54:
    s_add_u32 m0, s34, 49152
    s_nop 0
    buffer_load_dwordx4 v4, s[8:11], s28 offen offset:0 sc1 lds
    buffer_load_dwordx4 v4, s[8:11], s28 offen offset:1024 sc1 lds
    buffer_load_dwordx4 v4, s[8:11], s28 offen offset:2048 sc1 lds
    buffer_load_dwordx4 v4, s[8:11], s28 offen offset:3072 sc1 lds
    s_add_u32 s28, s28, 16384
    s_and_b32 s28, s28, 262143
    s_add_u32 m0, s35, 139264
    s_nop 0
    buffer_load_dwordx4 v8, s[12:15], s29 offen offset:0 lds
    buffer_load_dwordx4 v9, s[12:15], s29 offen offset:1024 lds
    s_add_u32 s29, s29, 131072
    s_cmp_eq_u32 s29, 2097152
    s_cselect_b32 s29, 0, s29
    s_waitcnt vmcnt(12)
    s_barrier
gate_55:
    s_bfe_u32 s30, s57, 0x40000
    s_cmp_eq_u32 s30, 15
    s_cbranch_scc1 skip_gate_56
    buffer_load_dwordx4 v[28:31], v26, s[76:79], s33 offen sc0 sc1
    s_waitcnt vmcnt(0)
    v_cmp_eq_u64 s[56:57], s[72:73], v[28:29]
    v_cmp_eq_u64 s[58:59], s[72:73], v[30:31]
    s_nop 3
    s_and_b64 s[56:57], s[56:57], s[58:59]
    s_sub_u32 s39, s39, 1
    s_cselect_b64 s[58:59], -1, 0
    s_cselect_b32 s39, 0, s39
    s_or_b64 s[56:57], s[56:57], s[58:59]
    s_branch gate_55
skip_gate_56:
    s_add_u32 m0, s34, 0
    s_nop 0
    buffer_load_dwordx4 v4, s[8:11], s28 offen offset:0 sc1 lds
    buffer_load_dwordx4 v4, s[8:11], s28 offen offset:1024 sc1 lds
    buffer_load_dwordx4 v4, s[8:11], s28 offen offset:2048 sc1 lds
    buffer_load_dwordx4 v4, s[8:11], s28 offen offset:3072 sc1 lds
    s_add_u32 s28, s28, 16384
    s_and_b32 s28, s28, 262143
    s_add_u32 m0, s35, 114688
    s_nop 0
    buffer_load_dwordx4 v8, s[12:15], s29 offen offset:0 lds
    buffer_load_dwordx4 v9, s[12:15], s29 offen offset:1024 lds
    s_add_u32 s29, s29, 131072
    s_cmp_eq_u32 s29, 2097152
    s_cselect_b32 s29, 0, s29
    s_waitcnt vmcnt(12)
    s_barrier
gate_57:
    s_bfe_u32 s30, s57, 0x40004
    s_cmp_eq_u32 s30, 15
    s_cbranch_scc1 skip_gate_58
    buffer_load_dwordx4 v[28:31], v26, s[76:79], s33 offen sc0 sc1
    s_waitcnt vmcnt(0)
    v_cmp_eq_u64 s[56:57], s[72:73], v[28:29]
    v_cmp_eq_u64 s[58:59], s[72:73], v[30:31]
    s_nop 3
    s_and_b64 s[56:57], s[56:57], s[58:59]
    s_sub_u32 s39, s39, 1
    s_cselect_b64 s[58:59], -1, 0
    s_cselect_b32 s39, 0, s39
    s_or_b64 s[56:57], s[56:57], s[58:59]
    s_branch gate_57
skip_gate_58:
    s_add_u32 m0, s34, 16384
    s_nop 0
    buffer_load_dwordx4 v4, s[8:11], s28 offen offset:0 sc1 lds
    buffer_load_dwordx4 v4, s[8:11], s28 offen offset:1024 sc1 lds
    buffer_load_dwordx4 v4, s[8:11], s28 offen offset:2048 sc1 lds
    buffer_load_dwordx4 v4, s[8:11], s28 offen offset:3072 sc1 lds
    s_add_u32 s28, s28, 16384
    s_and_b32 s28, s28, 262143
    s_add_u32 m0, s35, 122880
    s_nop 0
    buffer_load_dwordx4 v8, s[12:15], s29 offen offset:0 lds
    buffer_load_dwordx4 v9, s[12:15], s29 offen offset:1024 lds
    s_add_u32 s29, s29, 131072
    s_cmp_eq_u32 s29, 2097152
    s_cselect_b32 s29, 0, s29
    s_waitcnt vmcnt(12)
    s_barrier
gate_59:
    s_bfe_u32 s30, s57, 0x40008
    s_cmp_eq_u32 s30, 15
    s_cbranch_scc1 skip_gate_60
    buffer_load_dwordx4 v[28:31], v26, s[76:79], s33 offen sc0 sc1
    s_waitcnt vmcnt(0)
    v_cmp_eq_u64 s[56:57], s[72:73], v[28:29]
    v_cmp_eq_u64 s[58:59], s[72:73], v[30:31]
    s_nop 3
    s_and_b64 s[56:57], s[56:57], s[58:59]
    s_sub_u32 s39, s39, 1
    s_cselect_b64 s[58:59], -1, 0
    s_cselect_b32 s39, 0, s39
    s_or_b64 s[56:57], s[56:57], s[58:59]
    s_branch gate_59
skip_gate_60:
    s_add_u32 m0, s34, 32768
    s_nop 0
    buffer_load_dwordx4 v4, s[8:11], s28 offen offset:0 sc1 lds
    buffer_load_dwordx4 v4, s[8:11], s28 offen offset:1024 sc1 lds
    buffer_load_dwordx4 v4, s[8:11], s28 offen offset:2048 sc1 lds
    buffer_load_dwordx4 v4, s[8:11], s28 offen offset:3072 sc1 lds
    s_add_u32 s28, s28, 16384
    s_and_b32 s28, s28, 262143
    s_add_u32 m0, s35, 131072
    s_nop 0
    buffer_load_dwordx4 v8, s[12:15], s29 offen offset:0 lds
    buffer_load_dwordx4 v9, s[12:15], s29 offen offset:1024 lds
    s_add_u32 s29, s29, 131072
    s_cmp_eq_u32 s29, 2097152
    s_cselect_b32 s29, 0, s29
    s_waitcnt vmcnt(12)
    s_barrier
gate_61:
    s_bfe_u32 s30, s57, 0x4000c
    s_cmp_eq_u32 s30, 15
    s_cbranch_scc1 skip_gate_62
    buffer_load_dwordx4 v[28:31], v26, s[76:79], s33 offen sc0 sc1
    s_waitcnt vmcnt(0)
    v_cmp_eq_u64 s[56:57], s[72:73], v[28:29]
    v_cmp_eq_u64 s[58:59], s[72:73], v[30:31]
    s_nop 3
    s_and_b64 s[56:57], s[56:57], s[58:59]
    s_sub_u32 s39, s39, 1
    s_cselect_b64 s[58:59], -1, 0
    s_cselect_b32 s39, 0, s39
    s_or_b64 s[56:57], s[56:57], s[58:59]
    s_branch gate_61
skip_gate_62:
    s_add_u32 m0, s34, 49152
    s_nop 0
    buffer_load_dwordx4 v4, s[8:11], s28 offen offset:0 sc1 lds
    buffer_load_dwordx4 v4, s[8:11], s28 offen offset:1024 sc1 lds
    buffer_load_dwordx4 v4, s[8:11], s28 offen offset:2048 sc1 lds
    buffer_load_dwordx4 v4, s[8:11], s28 offen offset:3072 sc1 lds
    s_add_u32 s28, s28, 16384
    s_and_b32 s28, s28, 262143
    s_add_u32 m0, s35, 139264
    s_nop 0
    buffer_load_dwordx4 v8, s[12:15], s29 offen offset:0 lds
    buffer_load_dwordx4 v9, s[12:15], s29 offen offset:1024 lds
    s_add_u32 s29, s29, 131072
    s_cmp_eq_u32 s29, 2097152
    s_cselect_b32 s29, 0, s29
    s_waitcnt vmcnt(12)
    s_barrier
gate_63:
    s_bfe_u32 s30, s57, 0x40010
    s_cmp_eq_u32 s30, 15
    s_cbranch_scc1 skip_gate_64
    buffer_load_dwordx4 v[28:31], v26, s[76:79], s33 offen sc0 sc1
    s_waitcnt vmcnt(0)
    v_cmp_eq_u64 s[56:57], s[72:73], v[28:29]
    v_cmp_eq_u64 s[58:59], s[72:73], v[30:31]
    s_nop 3
    s_and_b64 s[56:57], s[56:57], s[58:59]
    s_sub_u32 s39, s39, 1
    s_cselect_b64 s[58:59], -1, 0
    s_cselect_b32 s39, 0, s39
    s_or_b64 s[56:57], s[56:57], s[58:59]
    s_branch gate_63
skip_gate_64:
    s_add_u32 m0, s34, 0
    s_nop 0
    buffer_load_dwordx4 v4, s[8:11], s28 offen offset:0 sc1 lds
    buffer_load_dwordx4 v4, s[8:11], s28 offen offset:1024 sc1 lds
    buffer_load_dwordx4 v4, s[8:11], s28 offen offset:2048 sc1 lds
    buffer_load_dwordx4 v4, s[8:11], s28 offen offset:3072 sc1 lds
    s_add_u32 s28, s28, 16384
    s_and_b32 s28, s28, 262143
    s_add_u32 m0, s35, 114688
    s_nop 0
    buffer_load_dwordx4 v8, s[12:15], s29 offen offset:0 lds
    buffer_load_dwordx4 v9, s[12:15], s29 offen offset:1024 lds
    s_add_u32 s29, s29, 131072
    s_cmp_eq_u32 s29, 2097152
    s_cselect_b32 s29, 0, s29
    s_waitcnt vmcnt(12)
    s_barrier
gate_65:
    s_bfe_u32 s30, s57, 0x40014
    s_cmp_eq_u32 s30, 15
    s_cbranch_scc1 skip_gate_66
    buffer_load_dwordx4 v[28:31], v26, s[76:79], s33 offen sc0 sc1
    s_waitcnt vmcnt(0)
    v_cmp_eq_u64 s[56:57], s[72:73], v[28:29]
    v_cmp_eq_u64 s[58:59], s[72:73], v[30:31]
    s_nop 3
    s_and_b64 s[56:57], s[56:57], s[58:59]
    s_sub_u32 s39, s39, 1
    s_cselect_b64 s[58:59], -1, 0
    s_cselect_b32 s39, 0, s39
    s_or_b64 s[56:57], s[56:57], s[58:59]
    s_branch gate_65
skip_gate_66:
    s_add_u32 m0, s34, 16384
    s_nop 0
    buffer_load_dwordx4 v4, s[8:11], s28 offen offset:0 sc1 lds
    buffer_load_dwordx4 v4, s[8:11], s28 offen offset:1024 sc1 lds
    buffer_load_dwordx4 v4, s[8:11], s28 offen offset:2048 sc1 lds
    buffer_load_dwordx4 v4, s[8:11], s28 offen offset:3072 sc1 lds
    s_add_u32 s28, s28, 16384
    s_and_b32 s28, s28, 262143
    s_add_u32 m0, s35, 122880
    s_nop 0
    buffer_load_dwordx4 v8, s[12:15], s29 offen offset:0 lds
    buffer_load_dwordx4 v9, s[12:15], s29 offen offset:1024 lds
    s_add_u32 s29, s29, 131072
    s_cmp_eq_u32 s29, 2097152
    s_cselect_b32 s29, 0, s29
    s_waitcnt vmcnt(12)
    s_barrier
gate_67:
    s_bfe_u32 s30, s57, 0x40018
    s_cmp_eq_u32 s30, 15
    s_cbranch_scc1 skip_gate_68
    buffer_load_dwordx4 v[28:31], v26, s[76:79], s33 offen sc0 sc1
    s_waitcnt vmcnt(0)
    v_cmp_eq_u64 s[56:57], s[72:73], v[28:29]
    v_cmp_eq_u64 s[58:59], s[72:73], v[30:31]
    s_nop 3
    s_and_b64 s[56:57], s[56:57], s[58:59]
    s_sub_u32 s39, s39, 1
    s_cselect_b64 s[58:59], -1, 0
    s_cselect_b32 s39, 0, s39
    s_or_b64 s[56:57], s[56:57], s[58:59]
    s_branch gate_67
skip_gate_68:
    s_add_u32 m0, s34, 32768
    s_nop 0
    buffer_load_dwordx4 v4, s[8:11], s28 offen offset:0 sc1 lds
    buffer_load_dwordx4 v4, s[8:11], s28 offen offset:1024 sc1 lds
    buffer_load_dwordx4 v4, s[8:11], s28 offen offset:2048 sc1 lds
    buffer_load_dwordx4 v4, s[8:11], s28 offen offset:3072 sc1 lds
    s_add_u32 s28, s28, 16384
    s_and_b32 s28, s28, 262143
    s_add_u32 m0, s35, 131072
    s_nop 0
    buffer_load_dwordx4 v8, s[12:15], s29 offen offset:0 lds
    buffer_load_dwordx4 v9, s[12:15], s29 offen offset:1024 lds
    s_add_u32 s29, s29, 131072
    s_cmp_eq_u32 s29, 2097152
    s_cselect_b32 s29, 0, s29
    s_waitcnt vmcnt(12)
    s_barrier
gate_69:
    s_bfe_u32 s30, s57, 0x4001c
    s_cmp_eq_u32 s30, 15
    s_cbranch_scc1 skip_gate_70
    buffer_load_dwordx4 v[28:31], v26, s[76:79], s33 offen sc0 sc1
    s_waitcnt vmcnt(0)
    v_cmp_eq_u64 s[56:57], s[72:73], v[28:29]
    v_cmp_eq_u64 s[58:59], s[72:73], v[30:31]
    s_nop 3
    s_and_b64 s[56:57], s[56:57], s[58:59]
    s_sub_u32 s39, s39, 1
    s_cselect_b64 s[58:59], -1, 0
    s_cselect_b32 s39, 0, s39
    s_or_b64 s[56:57], s[56:57], s[58:59]
    s_branch gate_69
skip_gate_70:
    s_add_u32 m0, s34, 49152
    s_nop 0
    buffer_load_dwordx4 v4, s[8:11], s28 offen offset:0 sc1 lds
    buffer_load_dwordx4 v4, s[8:11], s28 offen offset:1024 sc1 lds
    buffer_load_dwordx4 v4, s[8:11], s28 offen offset:2048 sc1 lds
    buffer_load_dwordx4 v4, s[8:11], s28 offen offset:3072 sc1 lds
    s_add_u32 s28, s28, 16384
    s_and_b32 s28, s28, 262143
    s_add_u32 m0, s35, 139264
    s_nop 0
    buffer_load_dwordx4 v8, s[12:15], s29 offen offset:0 lds
    buffer_load_dwordx4 v9, s[12:15], s29 offen offset:1024 lds
    s_add_u32 s29, s29, 131072
    s_cmp_eq_u32 s29, 2097152
    s_cselect_b32 s29, 0, s29
    s_waitcnt vmcnt(12)
    s_barrier
    s_waitcnt vmcnt(6)
    s_barrier
    s_waitcnt vmcnt(0)
    s_barrier
    s_barrier
    s_and_b32 s30, s2, 7
    s_lshr_b32 s31, s2, 3
    s_lshr_b32 s24, s30, 2
    s_lshl_b32 s24, s24, 3
    s_and_b32 s25, s30, 3
    s_lshl_b32 s25, s25, 2
    s_lshr_b32 s30, s31, 2
    s_add_u32 s24, s24, s30
    s_and_b32 s30, s31, 3
    s_add_u32 s25, s25, s30
    s_mul_i32 s30, s24, 262144
    s_add_u32 s30, s30, 20971520
    s_add_u32 s8, s4, s30
    s_addc_u32 s9, s5, 0
    s_mov_b32 s10, 262144
    s_mov_b32 s11, 0x20000
    s_and_b32 s30, s38, 3
    s_lshl_b32 s30, s30, 12
    v_lshlrev_b32 v4, 4, v1
    v_add_u32 v4, s30, v4
    s_and_b32 s65, s25, 3
    s_mul_i32 s65, s65, 4
    s_mov_b32 s65, 4
    s_mov_b32 s65, s25
    s_lshl_b32 s34, s38, 12
    s_mul_i32 s35, s38, 7168
    s_mul_i32 s30, s25, 448
    s_sub_u32 s31, 7340032, s30
    s_add_u32 s12, s88, s30
    s_addc_u32 s13, s89, 0
    s_mov_b32 s14, s31
    s_mov_b32 s15, 0x20000
    s_mul_i32 s30, s38, 448
    s_mov_b32 s36, 7168
    s_add_u32 s31, s30, 0
    v_add_u32 v3, s31, v1
    v_mul_u32_u24 v2, 2341, v3
    v_lshrrev_b32 v2, 16, v2
    v_mul_u32_u24 v15, 28, v2
    v_sub_u32 v3, v3, v15
    v_bfe_u32 v15, v2, 2, 1
    v_lshlrev_b32 v15, 1, v15
    v_xor_b32 v3, v3, v15
    v_mul_lo_u32 v2, v2, s36
    v_lshl_add_u32 v8, v3, 4, v2
    s_add_u32 s31, s30, 64
    v_add_u32 v3, s31, v1
    v_mul_u32_u24 v2, 2341, v3
    v_lshrrev_b32 v2, 16, v2
    v_mul_u32_u24 v15, 28, v2
    v_sub_u32 v3, v3, v15
    v_bfe_u32 v15, v2, 2, 1
    v_lshlrev_b32 v15, 1, v15
    v_xor_b32 v3, v3, v15
    v_mul_lo_u32 v2, v2, s36
    v_lshl_add_u32 v9, v3, 4, v2
    v_subrev_u32 v9, 1024, v9
    s_add_u32 s31, s30, 128
    v_add_u32 v3, s31, v1
    v_mul_u32_u24 v2, 2341, v3
    v_lshrrev_b32 v2, 16, v2
    v_mul_u32_u24 v15, 28, v2
    v_sub_u32 v3, v3, v15
    v_bfe_u32 v15, v2, 2, 1
    v_lshlrev_b32 v15, 1, v15
    v_xor_b32 v3, v3, v15
    v_mul_lo_u32 v2, v2, s36
    v_lshl_add_u32 v10, v3, 4, v2
    v_subrev_u32 v10, 2048, v10
    s_add_u32 s31, s30, 192
    v_add_u32 v3, s31, v1
    v_mul_u32_u24 v2, 2341, v3
    v_lshrrev_b32 v2, 16, v2
    v_mul_u32_u24 v15, 28, v2
    v_sub_u32 v3, v3, v15
    v_bfe_u32 v15, v2, 2, 1
    v_lshlrev_b32 v15, 1, v15
    v_xor_b32 v3, v3, v15
    v_mul_lo_u32 v2, v2, s36
    v_lshl_add_u32 v11, v3, 4, v2
    v_subrev_u32 v11, 3072, v11
    s_add_u32 s31, s30, 256
    v_add_u32 v3, s31, v1
    v_mul_u32_u24 v2, 2341, v3
    v_lshrrev_b32 v2, 16, v2
    v_mul_u32_u24 v15, 28, v2
    v_sub_u32 v3, v3, v15
    v_bfe_u32 v15, v2, 2, 1
    v_lshlrev_b32 v15, 1, v15
    v_xor_b32 v3, v3, v15
    v_mul_lo_u32 v2, v2, s36
    v_lshl_add_u32 v12, v3, 4, v2
    s_add_u32 s31, s30, 320
    v_add_u32 v3, s31, v1
    v_mul_u32_u24 v2, 2341, v3
    v_lshrrev_b32 v2, 16, v2
    v_mul_u32_u24 v15, 28, v2
    v_sub_u32 v3, v3, v15
    v_bfe_u32 v15, v2, 2, 1
    v_lshlrev_b32 v15, 1, v15
    v_xor_b32 v3, v3, v15
    v_mul_lo_u32 v2, v2, s36
    v_lshl_add_u32 v13, v3, 4, v2
    v_subrev_u32 v13, 1024, v13
    s_add_u32 s31, s30, 384
    v_add_u32 v3, s31, v1
    v_mul_u32_u24 v2, 2341, v3
    v_lshrrev_b32 v2, 16, v2
    v_mul_u32_u24 v15, 28, v2
    v_sub_u32 v3, v3, v15
    v_bfe_u32 v15, v2, 2, 1
    v_lshlrev_b32 v15, 1, v15
    v_xor_b32 v3, v3, v15
    v_mul_lo_u32 v2, v2, s36
    v_lshl_add_u32 v14, v3, 4, v2
    v_subrev_u32 v14, 2048, v14
    s_mov_b32 s27, 0
    s_mov_b32 s32, 49152
    s_mul_i32 s28, s65, 16384
    s_mul_i32 s29, s65, 458752
    s_add_u32 m0, s35, 49152
    s_nop 0
    buffer_load_dwordx4 v8, s[12:15], s29 offen offset:0 lds
    buffer_load_dwordx4 v9, s[12:15], s29 offen offset:1024 lds
    buffer_load_dwordx4 v10, s[12:15], s29 offen offset:2048 lds
    buffer_load_dwordx4 v11, s[12:15], s29 offen offset:3072 lds
    s_add_u32 m0, s35, 53248
    s_nop 0
    buffer_load_dwordx4 v12, s[12:15], s29 offen offset:0 lds
    buffer_load_dwordx4 v13, s[12:15], s29 offen offset:1024 lds
    buffer_load_dwordx4 v14, s[12:15], s29 offen offset:2048 lds
    s_add_u32 s29, s29, 458752
    s_cmp_eq_u32 s29, 7340032
    s_cselect_b32 s29, 0, s29
    s_add_u32 m0, s35, 77824
    s_nop 0
    buffer_load_dwordx4 v8, s[12:15], s29 offen offset:0 lds
    buffer_load_dwordx4 v9, s[12:15], s29 offen offset:1024 lds
    buffer_load_dwordx4 v10, s[12:15], s29 offen offset:2048 lds
    buffer_load_dwordx4 v11, s[12:15], s29 offen offset:3072 lds
    s_add_u32 m0, s35, 81920
    s_nop 0
    buffer_load_dwordx4 v12, s[12:15], s29 offen offset:0 lds
    buffer_load_dwordx4 v13, s[12:15], s29 offen offset:1024 lds
    buffer_load_dwordx4 v14, s[12:15], s29 offen offset:2048 lds
    s_add_u32 s29, s29, 458752
    s_cmp_eq_u32 s29, 7340032
    s_cselect_b32 s29, 0, s29
    s_add_u32 m0, s35, 106496
    s_nop 0
    buffer_load_dwordx4 v8, s[12:15], s29 offen offset:0 lds
    buffer_load_dwordx4 v9, s[12:15], s29 offen offset:1024 lds
    buffer_load_dwordx4 v10, s[12:15], s29 offen offset:2048 lds
    buffer_load_dwordx4 v11, s[12:15], s29 offen offset:3072 lds
    s_add_u32 m0, s35, 110592
    s_nop 0
    buffer_load_dwordx4 v12, s[12:15], s29 offen offset:0 lds
    buffer_load_dwordx4 v13, s[12:15], s29 offen offset:1024 lds
    buffer_load_dwordx4 v14, s[12:15], s29 offen offset:2048 lds
    s_add_u32 s29, s29, 458752
    s_cmp_eq_u32 s29, 7340032
    s_cselect_b32 s29, 0, s29
    s_add_u32 s16, s4, 44564480
    s_addc_u32 s17, s5, 0
    s_mov_b32 s18, 524288
    s_mov_b32 s19, 0x20000
    s_lshl_b32 s60, s25, 15
    s_lshl_b32 s31, s38, 9
    s_add_u32 s60, s60, s31
    s_mov_b32 s67, 2048
    v_lshlrev_b32 v24, 3, v1
    s_add_u32 s20, s4, 45088768
    s_addc_u32 s21, s5, 0
    s_mov_b32 s22, 524288
    s_mov_b32 s23, 0x20000
    v_and_b32 v25, 31, v1
    v_lshlrev_b32 v25, 2, v25
    v_lshrrev_b32 v15, 5, v1
    v_lshl_add_u32 v25, v15, 9, v25
    s_lshl_b32 s61, s24, 15
    s_lshl_b32 s31, s38, 7
    s_add_u32 s61, s61, s31
    s_mul_i32 s41, s38, 4096
    s_and_b32 s30, s38, 1
    s_mul_i32 s63, s30, 32768
    s_mul_i32 s64, s30, 57344
    s_and_b32 s30, s25, 4
    s_mul_i32 s66, s30, 57344
    s_and_b32 s42, s25, 3
    s_lshr_b32 s30, s25, 3
    s_lshl_b32 s30, s30, 2
    s_add_u32 s42, s42, s30
    s_mul_i32 s43, s25, 57344
    s_andn2_b32 s30, s25, 4
    s_mul_i32 s30, s30, 128
    s_sub_u32 s31, 7340032, s30
    s_add_u32 s52, s90, s30
    s_addc_u32 s53, s91, 0
    s_mov_b32 s54, s31
    s_mov_b32 s55, 0x20000
    v_lshrrev_b32 v2, 3, v1
    v_mul_u32_u24 v2, 2048, v2
    v_bfe_u32 v3, v1, 4, 2
    v_lshlrev_b32 v3, 1, v3
    v_and_b32 v15, 7, v1
    v_xor_b32 v3, v3, v15
    v_lshl_add_u32 v2, v3, 4, v2
    s_mul_i32 s36, s38, 4
    s_add_u32 s30, s36, 0
    s_and_b32 s31, s30, 3
    s_mul_i32 s31, s31, 16384
    s_lshr_b32 s30, s30, 3
    s_bfe_u32 s39, s25, 0x10002
    s_xor_b32 s30, s30, s39
    s_mul_i32 s30, s30, 512
    s_add_u32 s31, s31, s30
    v_add_u32 v16, s31, v2
    s_add_u32 s30, s36, 1
    s_and_b32 s31, s30, 3
    s_mul_i32 s31, s31, 16384
    s_lshr_b32 s30, s30, 3
    s_bfe_u32 s39, s25, 0x10002
    s_xor_b32 s30, s30, s39
    s_mul_i32 s30, s30, 512
    s_add_u32 s31, s31, s30
    s_sub_u32 s31, s31, 1024
    v_add_u32 v17, s31, v2
    s_add_u32 s30, s36, 2
    s_and_b32 s31, s30, 3
    s_mul_i32 s31, s31, 16384
    s_lshr_b32 s30, s30, 3
    s_bfe_u32 s39, s25, 0x10002
    s_xor_b32 s30, s30, s39
    s_mul_i32 s30, s30, 512
    s_add_u32 s31, s31, s30
    s_sub_u32 s31, s31, 2048
    v_add_u32 v18, s31, v2
    s_add_u32 s30, s36, 3
    s_and_b32 s31, s30, 3
    s_mul_i32 s31, s31, 16384
    s_lshr_b32 s30, s30, 3
    s_bfe_u32 s39, s25, 0x10002
    s_xor_b32 s30, s30, s39
    s_mul_i32 s30, s30, 512
    s_add_u32 s31, s31, s30
    s_sub_u32 s31, s31, 3072
    v_add_u32 v19, s31, v2
    s_lshl_b32 s30, s65, 2
    v_add_u32 v26, s30, v1
    v_and_b32 v26, 63, v26
    v_lshlrev_b32 v26, 3, v26
    s_lshl_b32 s33, s24, 10
    s_add_u32 s33, s33, 32768
    s_mov_b64 s[56:57], 0
    s_mov_b32 s39, 0x200000
    s_lshl_b32 s30, s2, 2
    s_add_u32 s30, s30, s38
    s_mul_i32 s30, s30, 7168
    s_add_u32 s68, s90, s30
    s_addc_u32 s69, s91, 0
    s_add_u32 s28, s28, 16384
    s_and_b32 s28, s28, 262143
    s_waitcnt vmcnt(14)
    s_barrier
gate_71:
    s_bfe_u32 s30, s56, 0x40004
    s_cmp_eq_u32 s30, 15
    s_cbranch_scc1 skip_gate_72
    buffer_load_dwordx2 v[28:29], v26, s[76:79], s33 offen sc0 sc1
    s_waitcnt vmcnt(0)
    v_cmp_eq_u64 s[56:57], s[72:73], v[28:29]
    s_nop 3
    s_sub_u32 s39, s39, 1
    s_cselect_b64 s[58:59], -1, 0
    s_cselect_b32 s39, 0, s39
    s_or_b64 s[56:57], s[56:57], s[58:59]
    s_branch gate_71
skip_gate_72:
    s_add_u32 m0, s34, 16384
    s_nop 0
    buffer_load_dwordx4 v4, s[8:11], s28 offen offset:0 sc1 lds
    buffer_load_dwordx4 v4, s[8:11], s28 offen offset:1024 sc1 lds
    buffer_load_dwordx4 v4, s[8:11], s28 offen offset:2048 sc1 lds
    buffer_load_dwordx4 v4, s[8:11], s28 offen offset:3072 sc1 lds
    s_add_u32 s28, s28, 16384
    s_and_b32 s28, s28, 262143
    s_add_u32 s30, s65, 0
    s_and_b32 s30, s30, 15
    s_lshl_b32 s30, s30, 11
    s_add_u32 s30, s30, s61
    buffer_load_dword v64, v25, s[20:23], s30 offen offset:0 sc0 sc1
    buffer_load_dword v65, v25, s[20:23], s30 offen offset:1024 sc0 sc1
    s_add_u32 s30, s65, 1
    s_and_b32 s30, s30, 15
    s_lshl_b32 s30, s30, 11
    s_add_u32 s30, s30, s61
    buffer_load_dword v66, v25, s[20:23], s30 offen offset:0 sc0 sc1
    buffer_load_dword v67, v25, s[20:23], s30 offen offset:1024 sc0 sc1
gate_73:
    s_bfe_u32 s30, s56, 0x40008
    s_cmp_eq_u32 s30, 15
    s_cbranch_scc1 skip_gate_74
    buffer_load_dwordx2 v[28:29], v26, s[76:79], s33 offen sc0 sc1
    s_waitcnt vmcnt(0)
    v_cmp_eq_u64 s[56:57], s[72:73], v[28:29]
    s_nop 3
    s_sub_u32 s39, s39, 1
    s_cselect_b64 s[58:59], -1, 0
    s_cselect_b32 s39, 0, s39
    s_or_b64 s[56:57], s[56:57], s[58:59]
    s_branch gate_73
skip_gate_74:
    s_add_u32 m0, s34, 32768
    s_nop 0
    buffer_load_dwordx4 v4, s[8:11], s28 offen offset:0 sc1 lds
    buffer_load_dwordx4 v4, s[8:11], s28 offen offset:1024 sc1 lds
    buffer_load_dwordx4 v4, s[8:11], s28 offen offset:2048 sc1 lds
    buffer_load_dwordx4 v4, s[8:11], s28 offen offset:3072 sc1 lds
    s_add_u32 s28, s28, 16384
    s_and_b32 s28, s28, 262143
    s_add_u32 s30, s65, 2
    s_and_b32 s30, s30, 15
    s_lshl_b32 s30, s30, 11
    s_add_u32 s30, s30, s61
    buffer_load_dword v68, v25, s[20:23], s30 offen offset:0 sc0 sc1
    buffer_load_dword v69, v25, s[20:23], s30 offen offset:1024 sc0 sc1
    s_load_dword s100, s[68:69], 3072
    s_load_dword s101, s[68:69], 3136
    s_load_dword s100, s[68:69], 3200
    s_load_dword s101, s[68:69], 3264
    s_load_dword s100, s[68:69], 3328
    s_waitcnt vmcnt(6)
    s_barrier
gate_75:
    s_bfe_u32 s30, s56, 0x4000c
    s_cmp_eq_u32 s30, 15
    s_cbranch_scc1 skip_gate_76
    buffer_load_dwordx2 v[28:29], v26, s[76:79], s33 offen sc0 sc1
    s_waitcnt vmcnt(0)
    v_cmp_eq_u64 s[56:57], s[72:73], v[28:29]
    s_nop 3
    s_sub_u32 s39, s39, 1
    s_cselect_b64 s[58:59], -1, 0
    s_cselect_b32 s39, 0, s39
    s_or_b64 s[56:57], s[56:57], s[58:59]
    s_branch gate_75
skip_gate_76:
    s_add_u32 m0, s34, 0
    s_nop 0
    buffer_load_dwordx4 v4, s[8:11], s28 offen offset:0 sc1 lds
    buffer_load_dwordx4 v4, s[8:11], s28 offen offset:1024 sc1 lds
    buffer_load_dwordx4 v4, s[8:11], s28 offen offset:2048 sc1 lds
    buffer_load_dwordx4 v4, s[8:11], s28 offen offset:3072 sc1 lds
    s_add_u32 s28, s28, 16384
    s_and_b32 s28, s28, 262143
    s_add_u32 m0, s35, 49152
    s_nop 0
    buffer_load_dwordx4 v8, s[12:15], s29 offen offset:0 lds
    buffer_load_dwordx4 v9, s[12:15], s29 offen offset:1024 lds
    buffer_load_dwordx4 v10, s[12:15], s29 offen offset:2048 lds
    buffer_load_dwordx4 v11, s[12:15], s29 offen offset:3072 lds
    s_add_u32 m0, s35, 53248
    s_nop 0
    buffer_load_dwordx4 v12, s[12:15], s29 offen offset:0 lds
    buffer_load_dwordx4 v13, s[12:15], s29 offen offset:1024 lds
    buffer_load_dwordx4 v14, s[12:15], s29 offen offset:2048 lds
    s_add_u32 s29, s29, 458752
    s_cmp_eq_u32 s29, 7340032
    s_cselect_b32 s29, 0, s29
    s_add_u32 s30, s65, 3
    s_and_b32 s30, s30, 15
    s_lshl_b32 s30, s30, 11
    s_add_u32 s30, s30, s61
    buffer_load_dword v70, v25, s[20:23], s30 offen offset:0 sc0 sc1
    buffer_load_dword v71, v25, s[20:23], s30 offen offset:1024 sc0 sc1
    s_load_dword s101, s[68:69], 3392
    s_load_dword s100, s[68:69], 3456
    s_load_dword s101, s[68:69], 3520
    s_load_dword s100, s[68:69], 3584
    s_load_dword s101, s[68:69], 3648
    s_waitcnt vmcnt(13)
    s_barrier
gate_77:
    s_bfe_u32 s30, s56, 0x40010
    s_cmp_eq_u32 s30, 15
    s_cbranch_scc1 skip_gate_78
    buffer_load_dwordx2 v[28:29], v26, s[76:79], s33 offen sc0 sc1
    s_waitcnt vmcnt(0)
    v_cmp_eq_u64 s[56:57], s[72:73], v[28:29]
    s_nop 3
    s_sub_u32 s39, s39, 1
    s_cselect_b64 s[58:59], -1, 0
    s_cselect_b32 s39, 0, s39
    s_or_b64 s[56:57], s[56:57], s[58:59]
    s_branch gate_77
skip_gate_78:
    s_add_u32 m0, s34, 16384
    s_nop 0
    buffer_load_dwordx4 v4, s[8:11], s28 offen offset:0 sc1 lds
    buffer_load_dwordx4 v4, s[8:11], s28 offen offset:1024 sc1 lds
    buffer_load_dwordx4 v4, s[8:11], s28 offen offset:2048 sc1 lds
    buffer_load_dwordx4 v4, s[8:11], s28 offen offset:3072 sc1 lds
    s_add_u32 s28, s28, 16384
    s_and_b32 s28, s28, 262143
    s_add_u32 m0, s35, 77824
    s_nop 0
    buffer_load_dwordx4 v8, s[12:15], s29 offen offset:0 lds
    buffer_load_dwordx4 v9, s[12:15], s29 offen offset:1024 lds
    buffer_load_dwordx4 v10, s[12:15], s29 offen offset:2048 lds
    buffer_load_dwordx4 v11, s[12:15], s29 offen offset:3072 lds
    s_add_u32 m0, s35, 81920
    s_nop 0
    buffer_load_dwordx4 v12, s[12:15], s29 offen offset:0 lds
    buffer_load_dwordx4 v13, s[12:15], s29 offen offset:1024 lds
    buffer_load_dwordx4 v14, s[12:15], s29 offen offset:2048 lds
    s_add_u32 s29, s29, 458752
    s_cmp_eq_u32 s29, 7340032
    s_cselect_b32 s29, 0, s29
    s_add_u32 s30, s65, 4
    s_and_b32 s30, s30, 15
    s_lshl_b32 s30, s30, 11
    s_add_u32 s30, s30, s61
    buffer_load_dword v72, v25, s[20:23], s30 offen offset:0 sc0 sc1
    buffer_load_dword v73, v25, s[20:23], s30 offen offset:1024 sc0 sc1
    s_load_dword s100, s[68:69], 3712
    s_load_dword s101, s[68:69], 3776
    s_load_dword s100, s[68:69], 3840
    s_load_dword s101, s[68:69], 3904
    s_load_dword s100, s[68:69], 3968
    s_setprio 3
    s_add_u32 s16, s4, 44564480
    s_addc_u32 s17, s5, 0
    s_mov_b32 s18, 524288
    s_mov_b32 s19, 0x20000
    s_lshl_b32 s60, s2, 2
    s_add_u32 s60, s60, s38
    v_lshrrev_b32 v24, 2, v1
    v_lshlrev_b32 v24, 11, v24
    v_and_b32 v27, 3, v1
    v_lshl_add_u32 v24, v27, 3, v24
    s_lshr_b32 s67, s60, 6
    s_lshl_b32 s67, s67, 15
    s_and_b32 s31, s60, 63
    s_lshl_b32 s31, s31, 5
    s_add_u32 s67, s67, s31
    buffer_load_dwordx2 v[32:33], v24, s[16:19], s67 offen sc0 sc1
    s_setprio 0
    s_waitcnt vmcnt(14)
    s_barrier
gate_79:
    s_bfe_u32 s30, s56, 0x40014
    s_cmp_eq_u32 s30, 15
    s_cbranch_scc1 skip_gate_80
    buffer_load_dwordx2 v[28:29], v26, s[76:79], s33 offen sc0 sc1
    s_waitcnt vmcnt(0)
    v_cmp_eq_u64 s[56:57], s[72:73], v[28:29]
    s_nop 3
    s_sub_u32 s39, s39, 1
    s_cselect_b64 s[58:59], -1, 0
    s_cselect_b32 s39, 0, s39
    s_or_b64 s[56:57], s[56:57], s[58:59]
    s_branch gate_79
skip_gate_80:
    s_add_u32 m0, s34, 32768
    s_nop 0
    buffer_load_dwordx4 v4, s[8:11], s28 offen offset:0 sc1 lds
    buffer_load_dwordx4 v4, s[8:11], s28 offen offset:1024 sc1 lds
    buffer_load_dwordx4 v4, s[8:11], s28 offen offset:2048 sc1 lds
    buffer_load_dwordx4 v4, s[8:11], s28 offen offset:3072 sc1 lds
    s_add_u32 s28, s28, 16384
    s_and_b32 s28, s28, 262143
    s_add_u32 m0, s35, 106496
    s_nop 0
    buffer_load_dwordx4 v8, s[12:15], s29 offen offset:0 lds
    buffer_load_dwordx4 v9, s[12:15], s29 offen offset:1024 lds
    buffer_load_dwordx4 v10, s[12:15], s29 offen offset:2048 lds
    buffer_load_dwordx4 v11, s[12:15], s29 offen offset:3072 lds
    s_add_u32 m0, s35, 110592
    s_nop 0
    buffer_load_dwordx4 v12, s[12:15], s29 offen offset:0 lds
    buffer_load_dwordx4 v13, s[12:15], s29 offen offset:1024 lds
    buffer_load_dwordx4 v14, s[12:15], s29 offen offset:2048 lds
    s_add_u32 s29, s29, 458752
    s_cmp_eq_u32 s29, 7340032
    s_cselect_b32 s29, 0, s29
    s_add_u32 s30, s65, 5
    s_and_b32 s30, s30, 15
    s_lshl_b32 s30, s30, 11
    s_add_u32 s30, s30, s61
    buffer_load_dword v74, v25, s[20:23], s30 offen offset:0 sc0 sc1
    buffer_load_dword v75, v25, s[20:23], s30 offen offset:1024 sc0 sc1
    s_load_dword s101, s[68:69], 4032
    s_load_dword s100, s[68:69], 4096
    s_load_dword s101, s[68:69], 4160
    s_load_dword s100, s[68:69], 4224
    s_load_dword s101, s[68:69], 4288
    s_waitcnt vmcnt(13)
    s_barrier
gate_81:
    s_bfe_u32 s30, s56, 0x40018
    s_cmp_eq_u32 s30, 15
    s_cbranch_scc1 skip_gate_82
    buffer_load_dwordx2 v[28:29], v26, s[76:79], s33 offen sc0 sc1
    s_waitcnt vmcnt(0)
    v_cmp_eq_u64 s[56:57], s[72:73], v[28:29]
    s_nop 3
    s_sub_u32 s39, s39, 1
    s_cselect_b64 s[58:59], -1, 0
    s_cselect_b32 s39, 0, s39
    s_or_b64 s[56:57], s[56:57], s[58:59]
    s_branch gate_81
skip_gate_82:
    s_add_u32 m0, s34, 0
    s_nop 0
    buffer_load_dwordx4 v4, s[8:11], s28 offen offset:0 sc1 lds
    buffer_load_dwordx4 v4, s[8:11], s28 offen offset:1024 sc1 lds
    buffer_load_dwordx4 v4, s[8:11], s28 offen offset:2048 sc1 lds
    buffer_load_dwordx4 v4, s[8:11], s28 offen offset:3072 sc1 lds
    s_add_u32 s28, s28, 16384
    s_and_b32 s28, s28, 262143
    s_add_u32 m0, s35, 49152
    s_nop 0
    buffer_load_dwordx4 v8, s[12:15], s29 offen offset:0 lds
    buffer_load_dwordx4 v9, s[12:15], s29 offen offset:1024 lds
    buffer_load_dwordx4 v10, s[12:15], s29 offen offset:2048 lds
    buffer_load_dwordx4 v11, s[12:15], s29 offen offset:3072 lds
    s_add_u32 m0, s35, 53248
    s_nop 0
    buffer_load_dwordx4 v12, s[12:15], s29 offen offset:0 lds
    buffer_load_dwordx4 v13, s[12:15], s29 offen offset:1024 lds
    buffer_load_dwordx4 v14, s[12:15], s29 offen offset:2048 lds
    s_add_u32 s29, s29, 458752
    s_cmp_eq_u32 s29, 7340032
    s_cselect_b32 s29, 0, s29
    s_add_u32 s30, s65, 6
    s_and_b32 s30, s30, 15
    s_lshl_b32 s30, s30, 11
    s_add_u32 s30, s30, s61
    buffer_load_dword v76, v25, s[20:23], s30 offen offset:0 sc0 sc1
    buffer_load_dword v77, v25, s[20:23], s30 offen offset:1024 sc0 sc1
    s_load_dword s100, s[68:69], 4352
    s_load_dword s101, s[68:69], 4416
    s_load_dword s100, s[68:69], 4480
    s_load_dword s101, s[68:69], 4544
    s_load_dword s100, s[68:69], 4608
    s_setprio 3
    s_mov_b32 s62, 0x80000
gchk_83:
    v_xor_b32 v15, s72, v33
    v_cmp_ne_u32 vcc, 0, v15
    s_nop 3
    s_cmp_eq_u64 vcc, 0
    s_cbranch_scc1 skip_gok_84
    s_sub_u32 s62, s62, 1
    s_cbranch_scc1 skip_gok_84
    buffer_load_dwordx2 v[32:33], v24, s[16:19], s67 offen sc0 sc1
    s_waitcnt vmcnt(0)
    s_branch gchk_83
skip_gok_84:
    s_add_u32 s16, s4, 43548672
    s_addc_u32 s17, s5, 0
    s_mov_b32 s18, 32768
    s_mov_b32 s19, 0x20000
    v_add_f32_dpp v32, v32, v32 row_ror:4 row_mask:0xf bank_mask:0xf
    s_nop 1
    v_add_f32_dpp v32, v32, v32 row_ror:8 row_mask:0xf bank_mask:0xf
    v_mov_b32 v34, v32
    s_nop 1
    v_permlane16_swap_b32 v32, v34
    v_add_f32 v32, v32, v34
    v_mov_b32 v34, v32
    s_nop 1
    v_permlane32_swap_b32 v32, v34
    v_add_f32 v32, v32, v34
    v_lshlrev_b32 v24, 3, v1
    s_lshl_b32 s60, s60, 5
    s_mov_b64 exec, 15
    buffer_store_dwordx2 v[32:33], v24, s[16:19], s60 offen sc0 sc1
    s_mov_b64 exec, -1
    s_setprio 0
    s_waitcnt vmcnt(14)
    s_barrier
gate_85:
    s_bfe_u32 s30, s56, 0x4001c
    s_cmp_eq_u32 s30, 15
    s_cbranch_scc1 skip_gate_86
    buffer_load_dwordx2 v[28:29], v26, s[76:79], s33 offen sc0 sc1
    s_waitcnt vmcnt(0)
    v_cmp_eq_u64 s[56:57], s[72:73], v[28:29]
    s_nop 3
    s_sub_u32 s39, s39, 1
    s_cselect_b64 s[58:59], -1, 0
    s_cselect_b32 s39, 0, s39
    s_or_b64 s[56:57], s[56:57], s[58:59]
    s_branch gate_85
skip_gate_86:
    s_add_u32 m0, s34, 16384
    s_nop 0
    buffer_load_dwordx4 v4, s[8:11], s28 offen offset:0 sc1 lds
    buffer_load_dwordx4 v4, s[8:11], s28 offen offset:1024 sc1 lds
    buffer_load_dwordx4 v4, s[8:11], s28 offen offset:2048 sc1 lds
    buffer_load_dwordx4 v4, s[8:11], s28 offen offset:3072 sc1 lds
    s_add_u32 s28, s28, 16384
    s_and_b32 s28, s28, 262143
    s_add_u32 m0, s35, 77824
    s_nop 0
    buffer_load_dwordx4 v8, s[12:15], s29 offen offset:0 lds
    buffer_load_dwordx4 v9, s[12:15], s29 offen offset:1024 lds
    buffer_load_dwordx4 v10, s[12:15], s29 offen offset:2048 lds
    buffer_load_dwordx4 v11, s[12:15], s29 offen offset:3072 lds
    s_add_u32 m0, s35, 81920
    s_nop 0
    buffer_load_dwordx4 v12, s[12:15], s29 offen offset:0 lds
    buffer_load_dwordx4 v13, s[12:15], s29 offen offset:1024 lds
    buffer_load_dwordx4 v14, s[12:15], s29 offen offset:2048 lds
    s_add_u32 s29, s29, 458752
    s_cmp_eq_u32 s29, 7340032
    s_cselect_b32 s29, 0, s29
    s_add_u32 s30, s65, 7
    s_and_b32 s30, s30, 15
    s_lshl_b32 s30, s30, 11
    s_add_u32 s30, s30, s61
    buffer_load_dword v78, v25, s[20:23], s30 offen offset:0 sc0 sc1
    buffer_load_dword v79, v25, s[20:23], s30 offen offset:1024 sc0 sc1
    s_load_dword s101, s[68:69], 4672
    s_load_dword s100, s[68:69], 4736
    s_load_dword s101, s[68:69], 4800
    s_load_dword s100, s[68:69], 4864
    s_load_dword s101, s[68:69], 4928
    s_waitcnt vmcnt(13)
    s_barrier
gate_87:
    s_bfe_u32 s30, s57, 0x40000
    s_cmp_eq_u32 s30, 15
    s_cbranch_scc1 skip_gate_88
    buffer_load_dwordx2 v[28:29], v26, s[76:79], s33 offen sc0 sc1
    s_waitcnt vmcnt(0)
    v_cmp_eq_u64 s[56:57], s[72:73], v[28:29]
    s_nop 3
    s_sub_u32 s39, s39, 1
    s_cselect_b64 s[58:59], -1, 0
    s_cselect_b32 s39, 0, s39
    s_or_b64 s[56:57], s[56:57], s[58:59]
    s_branch gate_87
skip_gate_88:
    s_add_u32 m0, s34, 32768
    s_nop 0
    buffer_load_dwordx4 v4, s[8:11], s28 offen offset:0 sc1 lds
    buffer_load_dwordx4 v4, s[8:11], s28 offen offset:1024 sc1 lds
    buffer_load_dwordx4 v4, s[8:11], s28 offen offset:2048 sc1 lds
    buffer_load_dwordx4 v4, s[8:11], s28 offen offset:3072 sc1 lds
    s_add_u32 s28, s28, 16384
    s_and_b32 s28, s28, 262143
    s_add_u32 m0, s35, 106496
    s_nop 0
    buffer_load_dwordx4 v8, s[12:15], s29 offen offset:0 lds
    buffer_load_dwordx4 v9, s[12:15], s29 offen offset:1024 lds
    buffer_load_dwordx4 v10, s[12:15], s29 offen offset:2048 lds
    buffer_load_dwordx4 v11, s[12:15], s29 offen offset:3072 lds
    s_add_u32 m0, s35, 110592
    s_nop 0
    buffer_load_dwordx4 v12, s[12:15], s29 offen offset:0 lds
    buffer_load_dwordx4 v13, s[12:15], s29 offen offset:1024 lds
    buffer_load_dwordx4 v14, s[12:15], s29 offen offset:2048 lds
    s_add_u32 s29, s29, 458752
    s_cmp_eq_u32 s29, 7340032
    s_cselect_b32 s29, 0, s29
    s_add_u32 s30, s65, 8
    s_and_b32 s30, s30, 15
    s_lshl_b32 s30, s30, 11
    s_add_u32 s30, s30, s61
    buffer_load_dword v80, v25, s[20:23], s30 offen offset:0 sc0 sc1
    buffer_load_dword v81, v25, s[20:23], s30 offen offset:1024 sc0 sc1
    s_load_dword s100, s[68:69], 4992
    s_load_dword s101, s[68:69], 5056
    s_load_dword s100, s[68:69], 5120
    s_load_dword s101, s[68:69], 5184
    s_load_dword s100, s[68:69], 5248
    s_waitcnt vmcnt(13)
    s_barrier
gate_89:
    s_bfe_u32 s30, s57, 0x40004
    s_cmp_eq_u32 s30, 15
    s_cbranch_scc1 skip_gate_90
    buffer_load_dwordx2 v[28:29], v26, s[76:79], s33 offen sc0 sc1
    s_waitcnt vmcnt(0)
    v_cmp_eq_u64 s[56:57], s[72:73], v[28:29]
    s_nop 3
    s_sub_u32 s39, s39, 1
    s_cselect_b64 s[58:59], -1, 0
    s_cselect_b32 s39, 0, s39
    s_or_b64 s[56:57], s[56:57], s[58:59]
    s_branch gate_89
skip_gate_90:
    s_add_u32 m0, s34, 0
    s_nop 0
    buffer_load_dwordx4 v4, s[8:11], s28 offen offset:0 sc1 lds
    buffer_load_dwordx4 v4, s[8:11], s28 offen offset:1024 sc1 lds
    buffer_load_dwordx4 v4, s[8:11], s28 offen offset:2048 sc1 lds
    buffer_load_dwordx4 v4, s[8:11], s28 offen offset:3072 sc1 lds
    s_add_u32 s28, s28, 16384
    s_and_b32 s28, s28, 262143
    s_add_u32 m0, s35, 49152
    s_nop 0
    buffer_load_dwordx4 v8, s[12:15], s29 offen offset:0 lds
    buffer_load_dwordx4 v9, s[12:15], s29 offen offset:1024 lds
    buffer_load_dwordx4 v10, s[12:15], s29 offen offset:2048 lds
    buffer_load_dwordx4 v11, s[12:15], s29 offen offset:3072 lds
    s_add_u32 m0, s35, 53248
    s_nop 0
    buffer_load_dwordx4 v12, s[12:15], s29 offen offset:0 lds
    buffer_load_dwordx4 v13, s[12:15], s29 offen offset:1024 lds
    buffer_load_dwordx4 v14, s[12:15], s29 offen offset:2048 lds
    s_add_u32 s29, s29, 458752
    s_cmp_eq_u32 s29, 7340032
    s_cselect_b32 s29, 0, s29
    s_add_u32 s30, s65, 9
    s_and_b32 s30, s30, 15
    s_lshl_b32 s30, s30, 11
    s_add_u32 s30, s30, s61
    buffer_load_dword v82, v25, s[20:23], s30 offen offset:0 sc0 sc1
    buffer_load_dword v83, v25, s[20:23], s30 offen offset:1024 sc0 sc1
    s_load_dword s101, s[68:69], 5312
    s_load_dword s100, s[68:69], 5376
    s_load_dword s101, s[68:69], 5440
    s_load_dword s100, s[68:69], 5504
    s_load_dword s101, s[68:69], 5568
    s_waitcnt vmcnt(13)
    s_barrier
gate_91:
    s_bfe_u32 s30, s57, 0x40008
    s_cmp_eq_u32 s30, 15
    s_cbranch_scc1 skip_gate_92
    buffer_load_dwordx2 v[28:29], v26, s[76:79], s33 offen sc0 sc1
    s_waitcnt vmcnt(0)
    v_cmp_eq_u64 s[56:57], s[72:73], v[28:29]
    s_nop 3
    s_sub_u32 s39, s39, 1
    s_cselect_b64 s[58:59], -1, 0
    s_cselect_b32 s39, 0, s39
    s_or_b64 s[56:57], s[56:57], s[58:59]
    s_branch gate_91
skip_gate_92:
    s_add_u32 m0, s34, 16384
    s_nop 0
    buffer_load_dwordx4 v4, s[8:11], s28 offen offset:0 sc1 lds
    buffer_load_dwordx4 v4, s[8:11], s28 offen offset:1024 sc1 lds
    buffer_load_dwordx4 v4, s[8:11], s28 offen offset:2048 sc1 lds
    buffer_load_dwordx4 v4, s[8:11], s28 offen offset:3072 sc1 lds
    s_add_u32 s28, s28, 16384
    s_and_b32 s28, s28, 262143
    s_add_u32 m0, s35, 77824
    s_nop 0
    buffer_load_dwordx4 v8, s[12:15], s29 offen offset:0 lds
    buffer_load_dwordx4 v9, s[12:15], s29 offen offset:1024 lds
    buffer_load_dwordx4 v10, s[12:15], s29 offen offset:2048 lds
    buffer_load_dwordx4 v11, s[12:15], s29 offen offset:3072 lds
    s_add_u32 m0, s35, 81920
    s_nop 0
    buffer_load_dwordx4 v12, s[12:15], s29 offen offset:0 lds
    buffer_load_dwordx4 v13, s[12:15], s29 offen offset:1024 lds
    buffer_load_dwordx4 v14, s[12:15], s29 offen offset:2048 lds
    s_add_u32 s29, s29, 458752
    s_cmp_eq_u32 s29, 7340032
    s_cselect_b32 s29, 0, s29
    s_add_u32 s30, s65, 10
    s_and_b32 s30, s30, 15
    s_lshl_b32 s30, s30, 11
    s_add_u32 s30, s30, s61
    buffer_load_dword v84, v25, s[20:23], s30 offen offset:0 sc0 sc1
    buffer_load_dword v85, v25, s[20:23], s30 offen offset:1024 sc0 sc1
    s_load_dword s100, s[68:69], 5632
    s_load_dword s101, s[68:69], 5696
    s_load_dword s100, s[68:69], 5760
    s_load_dword s101, s[68:69], 5824
    s_load_dword s100, s[68:69], 5888
    s_setprio 3
    v_add_f32 v64, v64, v65
    v_add_f32 v64, v64, v66
    v_add_f32 v64, v64, v67
    v_add_f32 v64, v64, v68
    v_add_f32 v64, v64, v69
    v_add_f32 v64, v64, v70
    v_add_f32 v64, v64, v71
    v_add_f32 v64, v64, v72
    v_add_f32 v64, v64, v73
    v_add_f32 v64, v64, v74
    v_add_f32 v64, v64, v75
    v_add_f32 v64, v64, v76
    v_add_f32 v64, v64, v77
    v_add_f32 v64, v64, v78
    v_add_f32 v64, v64, v79
    s_setprio 0
    s_waitcnt vmcnt(13)
    s_barrier
gate_93:
    s_bfe_u32 s30, s57, 0x4000c
    s_cmp_eq_u32 s30, 15
    s_cbranch_scc1 skip_gate_94
    buffer_load_dwordx2 v[28:29], v26, s[76:79], s33 offen sc0 sc1
    s_waitcnt vmcnt(0)
    v_cmp_eq_u64 s[56:57], s[72:73], v[28:29]
    s_nop 3
    s_sub_u32 s39, s39, 1
    s_cselect_b64 s[58:59], -1, 0
    s_cselect_b32 s39, 0, s39
    s_or_b64 s[56:57], s[56:57], s[58:59]
    s_branch gate_93
skip_gate_94:
    s_add_u32 m0, s34, 32768
    s_nop 0
    buffer_load_dwordx4 v4, s[8:11], s28 offen offset:0 sc1 lds
    buffer_load_dwordx4 v4, s[8:11], s28 offen offset:1024 sc1 lds
    buffer_load_dwordx4 v4, s[8:11], s28 offen offset:2048 sc1 lds
    buffer_load_dwordx4 v4, s[8:11], s28 offen offset:3072 sc1 lds
    s_add_u32 s28, s28, 16384
    s_and_b32 s28, s28, 262143
    s_add_u32 m0, s35, 106496
    s_nop 0
    buffer_load_dwordx4 v8, s[12:15], s29 offen offset:0 lds
    buffer_load_dwordx4 v9, s[12:15], s29 offen offset:1024 lds
    buffer_load_dwordx4 v10, s[12:15], s29 offen offset:2048 lds
    buffer_load_dwordx4 v11, s[12:15], s29 offen offset:3072 lds
    s_add_u32 m0, s35, 110592
    s_nop 0
    buffer_load_dwordx4 v12, s[12:15], s29 offen offset:0 lds
    buffer_load_dwordx4 v13, s[12:15], s29 offen offset:1024 lds
    buffer_load_dwordx4 v14, s[12:15], s29 offen offset:2048 lds
    s_add_u32 s29, s29, 458752
    s_cmp_eq_u32 s29, 7340032
    s_cselect_b32 s29, 0, s29
    s_add_u32 s30, s65, 11
    s_and_b32 s30, s30, 15
    s_lshl_b32 s30, s30, 11
    s_add_u32 s30, s30, s61
    buffer_load_dword v86, v25, s[20:23], s30 offen offset:0 sc0 sc1
    buffer_load_dword v87, v25, s[20:23], s30 offen offset:1024 sc0 sc1
    s_load_dword s101, s[68:69], 5952
    s_load_dword s100, s[68:69], 6016
    s_load_dword s101, s[68:69], 6080
    s_load_dword s100, s[68:69], 6144
    s_load_dword s101, s[68:69], 6208
    s_waitcnt vmcnt(13)
    s_barrier
gate_95:
    s_bfe_u32 s30, s57, 0x40010
    s_cmp_eq_u32 s30, 15
    s_cbranch_scc1 skip_gate_96
    buffer_load_dwordx2 v[28:29], v26, s[76:79], s33 offen sc0 sc1
    s_waitcnt vmcnt(0)
    v_cmp_eq_u64 s[56:57], s[72:73], v[28:29]
    s_nop 3
    s_sub_u32 s39, s39, 1
    s_cselect_b64 s[58:59], -1, 0
    s_cselect_b32 s39, 0, s39
    s_or_b64 s[56:57], s[56:57], s[58:59]
    s_branch gate_95
skip_gate_96:
    s_add_u32 m0, s34, 0
    s_nop 0
    buffer_load_dwordx4 v4, s[8:11], s28 offen offset:0 sc1 lds
    buffer_load_dwordx4 v4, s[8:11], s28 offen offset:1024 sc1 lds
    buffer_load_dwordx4 v4, s[8:11], s28 offen offset:2048 sc1 lds
    buffer_load_dwordx4 v4, s[8:11], s28 offen offset:3072 sc1 lds
    s_add_u32 s28, s28, 16384
    s_and_b32 s28, s28, 262143
    s_add_u32 m0, s35, 49152
    s_nop 0
    buffer_load_dwordx4 v8, s[12:15], s29 offen offset:0 lds
    buffer_load_dwordx4 v9, s[12:15], s29 offen offset:1024 lds
    buffer_load_dwordx4 v10, s[12:15], s29 offen offset:2048 lds
    buffer_load_dwordx4 v11, s[12:15], s29 offen offset:3072 lds
    s_add_u32 m0, s35, 53248
    s_nop 0
    buffer_load_dwordx4 v12, s[12:15], s29 offen offset:0 lds
    buffer_load_dwordx4 v13, s[12:15], s29 offen offset:1024 lds
    buffer_load_dwordx4 v14, s[12:15], s29 offen offset:2048 lds
    s_add_u32 s29, s29, 458752
    s_cmp_eq_u32 s29, 7340032
    s_cselect_b32 s29, 0, s29
    s_add_u32 s30, s65, 12
    s_and_b32 s30, s30, 15
    s_lshl_b32 s30, s30, 11
    s_add_u32 s30, s30, s61
    buffer_load_dword v88, v25, s[20:23], s30 offen offset:0 sc0 sc1
    buffer_load_dword v89, v25, s[20:23], s30 offen offset:1024 sc0 sc1
    s_load_dword s100, s[68:69], 6272
    s_load_dword s101, s[68:69], 6336
    s_load_dword s100, s[68:69], 6400
    s_load_dword s101, s[68:69], 6464
    s_load_dword s100, s[68:69], 6528
    s_waitcnt vmcnt(13)
    s_barrier
gate_97:
    s_bfe_u32 s30, s57, 0x40014
    s_cmp_eq_u32 s30, 15
    s_cbranch_scc1 skip_gate_98
    buffer_load_dwordx2 v[28:29], v26, s[76:79], s33 offen sc0 sc1
    s_waitcnt vmcnt(0)
    v_cmp_eq_u64 s[56:57], s[72:73], v[28:29]
    s_nop 3
    s_sub_u32 s39, s39, 1
    s_cselect_b64 s[58:59], -1, 0
    s_cselect_b32 s39, 0, s39
    s_or_b64 s[56:57], s[56:57], s[58:59]
    s_branch gate_97
skip_gate_98:
    s_add_u32 m0, s34, 16384
    s_nop 0
    buffer_load_dwordx4 v4, s[8:11], s28 offen offset:0 sc1 lds
    buffer_load_dwordx4 v4, s[8:11], s28 offen offset:1024 sc1 lds
    buffer_load_dwordx4 v4, s[8:11], s28 offen offset:2048 sc1 lds
    buffer_load_dwordx4 v4, s[8:11], s28 offen offset:3072 sc1 lds
    s_add_u32 s28, s28, 16384
    s_and_b32 s28, s28, 262143
    s_add_u32 m0, s35, 77824
    s_nop 0
    buffer_load_dwordx4 v8, s[12:15], s29 offen offset:0 lds
    buffer_load_dwordx4 v9, s[12:15], s29 offen offset:1024 lds
    buffer_load_dwordx4 v10, s[12:15], s29 offen offset:2048 lds
    buffer_load_dwordx4 v11, s[12:15], s29 offen offset:3072 lds
    s_add_u32 m0, s35, 81920
    s_nop 0
    buffer_load_dwordx4 v12, s[12:15], s29 offen offset:0 lds
    buffer_load_dwordx4 v13, s[12:15], s29 offen offset:1024 lds
    buffer_load_dwordx4 v14, s[12:15], s29 offen offset:2048 lds
    s_add_u32 s29, s29, 458752
    s_cmp_eq_u32 s29, 7340032
    s_cselect_b32 s29, 0, s29
    s_add_u32 s30, s65, 13
    s_and_b32 s30, s30, 15
    s_lshl_b32 s30, s30, 11
    s_add_u32 s30, s30, s61
    buffer_load_dword v90, v25, s[20:23], s30 offen offset:0 sc0 sc1
    buffer_load_dword v91, v25, s[20:23], s30 offen offset:1024 sc0 sc1
    s_load_dword s101, s[68:69], 6592
    s_load_dword s100, s[68:69], 6656
    s_load_dword s101, s[68:69], 6720
    s_load_dword s100, s[68:69], 6784
    s_load_dword s101, s[68:69], 6848
    s_waitcnt vmcnt(13)
    s_barrier
gate_99:
    s_bfe_u32 s30, s57, 0x40018
    s_cmp_eq_u32 s30, 15
    s_cbranch_scc1 skip_gate_100
    buffer_load_dwordx2 v[28:29], v26, s[76:79], s33 offen sc0 sc1
    s_waitcnt vmcnt(0)
    v_cmp_eq_u64 s[56:57], s[72:73], v[28:29]
    s_nop 3
    s_sub_u32 s39, s39, 1
    s_cselect_b64 s[58:59], -1, 0
    s_cselect_b32 s39, 0, s39
    s_or_b64 s[56:57], s[56:57], s[58:59]
    s_branch gate_99
skip_gate_100:
    s_add_u32 m0, s34, 32768
    s_nop 0
    buffer_load_dwordx4 v4, s[8:11], s28 offen offset:0 sc1 lds
    buffer_load_dwordx4 v4, s[8:11], s28 offen offset:1024 sc1 lds
    buffer_load_dwordx4 v4, s[8:11], s28 offen offset:2048 sc1 lds
    buffer_load_dwordx4 v4, s[8:11], s28 offen offset:3072 sc1 lds
    s_add_u32 s28, s28, 16384
    s_and_b32 s28, s28, 262143
    s_add_u32 m0, s35, 106496
    s_nop 0
    buffer_load_dwordx4 v8, s[12:15], s29 offen offset:0 lds
    buffer_load_dwordx4 v9, s[12:15], s29 offen offset:1024 lds
    buffer_load_dwordx4 v10, s[12:15], s29 offen offset:2048 lds
    buffer_load_dwordx4 v11, s[12:15], s29 offen offset:3072 lds
    s_add_u32 m0, s35, 110592
    s_nop 0
    buffer_load_dwordx4 v12, s[12:15], s29 offen offset:0 lds
    buffer_load_dwordx4 v13, s[12:15], s29 offen offset:1024 lds
    buffer_load_dwordx4 v14, s[12:15], s29 offen offset:2048 lds
    s_add_u32 s29, s29, 458752
    s_cmp_eq_u32 s29, 7340032
    s_cselect_b32 s29, 0, s29
    s_add_u32 s30, s65, 14
    s_and_b32 s30, s30, 15
    s_lshl_b32 s30, s30, 11
    s_add_u32 s30, s30, s61
    buffer_load_dword v92, v25, s[20:23], s30 offen offset:0 sc0 sc1
    buffer_load_dword v93, v25, s[20:23], s30 offen offset:1024 sc0 sc1
    s_load_dword s100, s[68:69], 6912
    s_load_dword s101, s[68:69], 6976
    s_load_dword s100, s[68:69], 7040
    s_load_dword s101, s[68:69], 7104
    s_waitcnt vmcnt(13)
    s_barrier
gate_101:
    s_bfe_u32 s30, s57, 0x4001c
    s_cmp_eq_u32 s30, 15
    s_cbranch_scc1 skip_gate_102
    buffer_load_dwordx2 v[28:29], v26, s[76:79], s33 offen sc0 sc1
    s_waitcnt vmcnt(0)
    v_cmp_eq_u64 s[56:57], s[72:73], v[28:29]
    s_nop 3
    s_sub_u32 s39, s39, 1
    s_cselect_b64 s[58:59], -1, 0
    s_cselect_b32 s39, 0, s39
    s_or_b64 s[56:57], s[56:57], s[58:59]
    s_branch gate_101
skip_gate_102:
    s_add_u32 m0, s34, 0
    s_nop 0
    buffer_load_dwordx4 v4, s[8:11], s28 offen offset:0 sc1 lds
    buffer_load_dwordx4 v4, s[8:11], s28 offen offset:1024 sc1 lds
    buffer_load_dwordx4 v4, s[8:11], s28 offen offset:2048 sc1 lds
    buffer_load_dwordx4 v4, s[8:11], s28 offen offset:3072 sc1 lds
    s_add_u32 s28, s28, 16384
    s_and_b32 s28, s28, 262143
    s_add_u32 m0, s35, 49152
    s_nop 0
    buffer_load_dwordx4 v8, s[12:15], s29 offen offset:0 lds
    buffer_load_dwordx4 v9, s[12:15], s29 offen offset:1024 lds
    buffer_load_dwordx4 v10, s[12:15], s29 offen offset:2048 lds
    buffer_load_dwordx4 v11, s[12:15], s29 offen offset:3072 lds
    s_add_u32 m0, s35, 53248
    s_nop 0
    buffer_load_dwordx4 v12, s[12:15], s29 offen offset:0 lds
    buffer_load_dwordx4 v13, s[12:15], s29 offen offset:1024 lds
    buffer_load_dwordx4 v14, s[12:15], s29 offen offset:2048 lds
    s_add_u32 s29, s29, 458752
    s_cmp_eq_u32 s29, 7340032
    s_cselect_b32 s29, 0, s29
    s_add_u32 s30, s65, 15
    s_and_b32 s30, s30, 15
    s_lshl_b32 s30, s30, 11
    s_add_u32 s30, s30, s61
    buffer_load_dword v94, v25, s[20:23], s30 offen offset:0 sc0 sc1
    buffer_load_dword v95, v25, s[20:23], s30 offen offset:1024 sc0 sc1
    s_setprio 3
    v_add_f32 v64, v64, v80
    v_add_f32 v64, v64, v81
    v_add_f32 v64, v64, v82
    v_add_f32 v64, v64, v83
    v_add_f32 v64, v64, v84
    v_add_f32 v64, v64, v85
    v_add_f32 v64, v64, v86
    v_add_f32 v64, v64, v87
    v_add_f32 v64, v64, v88
    v_add_f32 v64, v64, v89
    s_setprio 0
    s_waitcnt vmcnt(13)
    s_barrier
    s_lshl_b32 s60, s25, 11
    s_lshl_b32 s31, s38, 9
    s_add_u32 s60, s60, s31
    buffer_load_dwordx2 v[32:33], v24, s[16:19], s60 offen sc0 sc1
    s_add_u32 s30, s43, s63
    s_add_u32 s29, s30, 0
    s_lshl_b32 s29, s29, 3
    s_add_u32 m0, s41, 77824
    s_nop 0
    buffer_load_dwordx4 v16, s[52:55], s29 offen offset:0 lds
    buffer_load_dwordx4 v17, s[52:55], s29 offen offset:1024 lds
    buffer_load_dwordx4 v18, s[52:55], s29 offen offset:2048 lds
    buffer_load_dwordx4 v19, s[52:55], s29 offen offset:3072 lds
    s_waitcnt vmcnt(5)
    s_barrier
    s_add_u32 s30, s43, s63
    s_add_u32 s29, s30, 8192
    s_lshl_b32 s29, s29, 3
    s_add_u32 m0, s41, 94208
    s_nop 0
    buffer_load_dwordx4 v16, s[52:55], s29 offen offset:0 lds
    buffer_load_dwordx4 v17, s[52:55], s29 offen offset:1024 lds
    buffer_load_dwordx4 v18, s[52:55], s29 offen offset:2048 lds
    buffer_load_dwordx4 v19, s[52:55], s29 offen offset:3072 lds
    s_add_u32 s30, s43, s63
    s_add_u32 s29, s30, 16384
    s_lshl_b32 s29, s29, 3
    s_add_u32 m0, s41, 110592
    s_nop 0
    buffer_load_dwordx4 v16, s[52:55], s29 offen offset:0 lds
    buffer_load_dwordx4 v17, s[52:55], s29 offen offset:1024 lds
    buffer_load_dwordx4 v18, s[52:55], s29 offen offset:2048 lds
    buffer_load_dwordx4 v19, s[52:55], s29 offen offset:3072 lds
    s_add_u32 s30, s42, 1
    s_and_b32 s30, s30, 7
    s_and_b32 s31, s30, 4
    s_add_u32 s30, s30, s31
    s_mul_i32 s30, s30, 57344
    s_add_u32 s30, s30, s66
    s_add_u32 s30, s30, s63
    s_add_u32 s29, s30, 0
    s_lshl_b32 s29, s29, 3
    s_add_u32 m0, s41, 126976
    s_nop 0
    buffer_load_dwordx4 v16, s[52:55], s29 offen offset:0 lds
    buffer_load_dwordx4 v17, s[52:55], s29 offen offset:1024 lds
    buffer_load_dwordx4 v18, s[52:55], s29 offen offset:2048 lds
    buffer_load_dwordx4 v19, s[52:55], s29 offen offset:3072 lds
    s_setprio 3
    v_add_f32 v64, v64, v90
    v_add_f32 v64, v64, v91
    v_add_f32 v64, v64, v92
    v_add_f32 v64, v64, v93
    v_add_f32 v64, v64, v94
    v_add_f32 v64, v64, v95
    s_setprio 0
    s_waitcnt vmcnt(16)
    s_setprio 3
    s_mov_b32 s62, 0x80000
gchk_103:
    v_xor_b32 v15, s72, v33
    v_cmp_ne_u32 vcc, 0, v15
    s_nop 3
    s_cmp_eq_u64 vcc, 0
    s_cbranch_scc1 skip_gok_104
    s_sub_u32 s62, s62, 1
    s_cbranch_scc1 skip_gok_104
    buffer_load_dwordx2 v[32:33], v24, s[16:19], s60 offen sc0 sc1
    s_waitcnt vmcnt(0)
    s_branch gchk_103
skip_gok_104:
    v_lshlrev_b32 v2, 2, v1
    s_lshl_b32 s30, s38, 8
    s_add_u32 s30, s30, 158720
    v_add_u32 v2, s30, v2
    ds_write_b32 v2, v32
    s_setprio 0
    s_setprio 3
    v_and_b32 v3, 31, v1
    s_lshl_b32 s30, s38, 5
    v_add_u32 v3, s30, v3
    v_lshlrev_b32 v2, 4, v3
    v_add_u32 v2, 155648, v2
    v_mov_b32 v65, v64
    s_nop 1
    v_permlane32_swap_b32 v64, v65
    v_mul_f32 v64, 0x3a800000, v64
    v_mul_f32 v65, 0x3a800000, v65
    v_fma_f32 v65, -v64, v64, v65
    v_max_f32 v65, 0, v65
    v_add_f32 v68, 0x3727c5ac, v65
    v_rsq_f32 v65, v68
    v_sqrt_f32 v67, v68
    v_sqrt_f32 v66, v68
    v_mul_f32 v65, 0xbfb8aa3b, v65
    ds_write_b128 v2, v[64:67]
    s_waitcnt lgkmcnt(0)
    s_setprio 0
    s_barrier
    s_and_b32 s30, s2, 7
    s_lshr_b32 s31, s2, 3
    s_lshr_b32 s24, s30, 2
    s_lshl_b32 s24, s24, 3
    s_and_b32 s25, s30, 3
    s_lshl_b32 s25, s25, 2
    s_lshr_b32 s30, s31, 2
    s_add_u32 s24, s24, s30
    s_and_b32 s30, s31, 3
    s_add_u32 s25, s25, s30
    s_mul_i32 s30, s24, 917504
    s_add_u32 s30, s30, 25165824
    s_add_u32 s8, s4, s30
    s_addc_u32 s9, s5, 0
    s_mov_b32 s10, 917504
    s_mov_b32 s11, 0x20000
    s_lshr_b32 s30, s38, 1
    s_lshl_b32 s30, s30, 12
    v_lshlrev_b32 v4, 4, v1
    v_add_u32 v4, s30, v4
    s_and_b32 s30, s38, 1
    s_mul_i32 s63, s30, 32768
    s_mul_i32 s64, s30, 57344
    s_and_b32 s65, s25, 3
    s_mul_i32 s65, s65, 0
    s_and_b32 s65, s25, 4
    s_lshl_b32 s65, s65, 1
    s_lshl_b32 s34, s38, 12
    s_mul_i32 s35, s38, 4096
    s_and_b32 s34, s38, 1
    s_lshl_b32 s34, s34, 13
    s_lshr_b32 s30, s38, 1
    s_lshl_b32 s30, s30, 12
    s_add_u32 s34, s34, s30
    s_mov_b32 s27, 0
    s_mov_b32 s32, 77824
    s_mul_i32 s28, s65, 16384
    s_mul_i32 s29, s65, 131072
    s_barrier
    s_barrier
    v_lshrrev_b32 v2, 2, v1
    s_add_u32 s30, s42, 1
    v_add_u32 v2, s30, v2
    v_and_b32 v2, 7, v2
    v_and_b32 v3, 4, v2
    v_add_u32 v2, v2, v3
    s_and_b32 s30, s25, 4
    v_add_u32 v2, s30, v2
    v_and_b32 v3, 3, v1
    v_lshl_add_u32 v2, v2, 2, v3
    v_lshlrev_b32 v26, 3, v2
    s_lshl_b32 s33, s24, 10
    s_add_u32 s33, s33, 0
    s_mov_b64 s[56:57], 0
    s_mov_b32 s39, 0x200000
    s_waitcnt vmcnt(0)
    s_barrier
    s_barrier
    buffer_load_dwordx2 v[28:29], v26, s[76:79], s33 offen sc0 sc1
    s_add_u32 s30, s42, 2
    s_and_b32 s30, s30, 7
    s_and_b32 s31, s30, 4
    s_add_u32 s30, s30, s31
    s_mul_i32 s30, s30, 57344
    s_add_u32 s30, s30, s66
    s_add_u32 s30, s30, s63
    s_add_u32 s29, s30, 0
    s_lshl_b32 s29, s29, 3
    s_add_u32 m0, s41, 77824
    s_nop 0
    buffer_load_dwordx4 v16, s[52:55], s29 offen offset:0 lds
    buffer_load_dwordx4 v17, s[52:55], s29 offen offset:1024 lds
    buffer_load_dwordx4 v18, s[52:55], s29 offen offset:2048 lds
    buffer_load_dwordx4 v19, s[52:55], s29 offen offset:3072 lds
    s_barrier
    s_waitcnt vmcnt(4)
    v_cmp_eq_u64 s[56:57], s[72:73], v[28:29]
    s_nop 3
gate_105:
    s_bfe_u32 s30, s56, 0x40000
    s_cmp_eq_u32 s30, 15
    s_cbranch_scc1 skip_gate_106
    buffer_load_dwordx2 v[28:29], v26, s[76:79], s33 offen sc0 sc1
    s_waitcnt vmcnt(0)
    v_cmp_eq_u64 s[56:57], s[72:73], v[28:29]
    s_nop 3
    s_sub_u32 s39, s39, 1
    s_cselect_b64 s[58:59], -1, 0
    s_cselect_b32 s39, 0, s39
    s_or_b64 s[56:57], s[56:57], s[58:59]
    s_branch gate_105
skip_gate_106:
    s_add_u32 s30, s42, 1
    s_and_b32 s30, s30, 7
    s_and_b32 s31, s30, 4
    s_add_u32 s30, s30, s31
    s_mul_i32 s30, s30, 57344
    s_add_u32 s30, s30, s66
    s_add_u32 s30, s30, s63
    s_add_u32 s28, s30, 0
    s_add_u32 m0, s34, 49152
    s_nop 0
    buffer_load_dwordx4 v4, s[8:11], s28 offen offset:0 sc1 lds
    buffer_load_dwordx4 v4, s[8:11], s28 offen offset:1024 sc1 lds
    buffer_load_dwordx4 v4, s[8:11], s28 offen offset:2048 sc1 lds
    buffer_load_dwordx4 v4, s[8:11], s28 offen offset:3072 sc1 lds
    s_add_u32 s30, s42, 3
    s_and_b32 s30, s30, 7
    s_and_b32 s31, s30, 4
    s_add_u32 s30, s30, s31
    s_mul_i32 s30, s30, 57344
    s_add_u32 s30, s30, s66
    s_add_u32 s30, s30, s63
    s_add_u32 s29, s30, 0
    s_lshl_b32 s29, s29, 3
    s_add_u32 m0, s41, 94208
    s_nop 0
    buffer_load_dwordx4 v16, s[52:55], s29 offen offset:0 lds
    buffer_load_dwordx4 v17, s[52:55], s29 offen offset:1024 lds
    buffer_load_dwordx4 v18, s[52:55], s29 offen offset:2048 lds
    buffer_load_dwordx4 v19, s[52:55], s29 offen offset:3072 lds
gate_107:
    s_bfe_u32 s30, s56, 0x40004
    s_cmp_eq_u32 s30, 15
    s_cbranch_scc1 skip_gate_108
    buffer_load_dwordx2 v[28:29], v26, s[76:79], s33 offen sc0 sc1
    s_waitcnt vmcnt(0)
    v_cmp_eq_u64 s[56:57], s[72:73], v[28:29]
    s_nop 3
    s_sub_u32 s39, s39, 1
    s_cselect_b64 s[58:59], -1, 0
    s_cselect_b32 s39, 0, s39
    s_or_b64 s[56:57], s[56:57], s[58:59]
    s_branch gate_107
skip_gate_108:
    s_add_u32 s30, s42, 2
    s_and_b32 s30, s30, 7
    s_and_b32 s31, s30, 4
    s_add_u32 s30, s30, s31
    s_mul_i32 s30, s30, 57344
    s_add_u32 s30, s30, s66
    s_add_u32 s30, s30, s63
    s_add_u32 s28, s30, 0
    s_add_u32 m0, s34, 0
    s_nop 0
    buffer_load_dwordx4 v4, s[8:11], s28 offen offset:0 sc1 lds
    buffer_load_dwordx4 v4, s[8:11], s28 offen offset:1024 sc1 lds
    buffer_load_dwordx4 v4, s[8:11], s28 offen offset:2048 sc1 lds
    buffer_load_dwordx4 v4, s[8:11], s28 offen offset:3072 sc1 lds
gate_109:
    s_bfe_u32 s30, s56, 0x40008
    s_cmp_eq_u32 s30, 15
    s_cbranch_scc1 skip_gate_110
    buffer_load_dwordx2 v[28:29], v26, s[76:79], s33 offen sc0 sc1
    s_waitcnt vmcnt(0)
    v_cmp_eq_u64 s[56:57], s[72:73], v[28:29]
    s_nop 3
    s_sub_u32 s39, s39, 1
    s_cselect_b64 s[58:59], -1, 0
    s_cselect_b32 s39, 0, s39
    s_or_b64 s[56:57], s[56:57], s[58:59]
    s_branch gate_109
skip_gate_110:
    s_add_u32 s30, s42, 3
    s_and_b32 s30, s30, 7
    s_and_b32 s31, s30, 4
    s_add_u32 s30, s30, s31
    s_mul_i32 s30, s30, 57344
    s_add_u32 s30, s30, s66
    s_add_u32 s30, s30, s63
    s_add_u32 s28, s30, 0
    s_add_u32 m0, s34, 16384
    s_nop 0
    buffer_load_dwordx4 v4, s[8:11], s28 offen offset:0 sc1 lds
    buffer_load_dwordx4 v4, s[8:11], s28 offen offset:1024 sc1 lds
    buffer_load_dwordx4 v4, s[8:11], s28 offen offset:2048 sc1 lds
    buffer_load_dwordx4 v4, s[8:11], s28 offen offset:3072 sc1 lds
    s_waitcnt vmcnt(12)
    s_barrier
gate_111:
    s_bfe_u32 s30, s56, 0x4000c
    s_cmp_eq_u32 s30, 15
    s_cbranch_scc1 skip_gate_112
    buffer_load_dwordx2 v[28:29], v26, s[76:79], s33 offen sc0 sc1
    s_waitcnt vmcnt(0)
    v_cmp_eq_u64 s[56:57], s[72:73], v[28:29]
    s_nop 3
    s_sub_u32 s39, s39, 1
    s_cselect_b64 s[58:59], -1, 0
    s_cselect_b32 s39, 0, s39
    s_or_b64 s[56:57], s[56:57], s[58:59]
    s_branch gate_111
skip_gate_112:
    s_add_u32 s30, s42, 4
    s_and_b32 s30, s30, 7
    s_and_b32 s31, s30, 4
    s_add_u32 s30, s30, s31
    s_mul_i32 s30, s30, 57344
    s_add_u32 s30, s30, s66
    s_add_u32 s30, s30, s63
    s_add_u32 s28, s30, 0
    s_add_u32 m0, s34, 32768
    s_nop 0
    buffer_load_dwordx4 v4, s[8:11], s28 offen offset:0 sc1 lds
    buffer_load_dwordx4 v4, s[8:11], s28 offen offset:1024 sc1 lds
    buffer_load_dwordx4 v4, s[8:11], s28 offen offset:2048 sc1 lds
    buffer_load_dwordx4 v4, s[8:11], s28 offen offset:3072 sc1 lds
    s_lshl_b32 s29, s28, 3
    s_add_u32 m0, s41, 110592
    s_nop 0
    buffer_load_dwordx4 v16, s[52:55], s29 offen offset:0 lds
    buffer_load_dwordx4 v17, s[52:55], s29 offen offset:1024 lds
    buffer_load_dwordx4 v18, s[52:55], s29 offen offset:2048 lds
    buffer_load_dwordx4 v19, s[52:55], s29 offen offset:3072 lds
    s_waitcnt vmcnt(12)
    s_barrier
gate_113:
    s_bfe_u32 s30, s56, 0x40010
    s_cmp_eq_u32 s30, 15
    s_cbranch_scc1 skip_gate_114
    buffer_load_dwordx2 v[28:29], v26, s[76:79], s33 offen sc0 sc1
    s_waitcnt vmcnt(0)
    v_cmp_eq_u64 s[56:57], s[72:73], v[28:29]
    s_nop 3
    s_sub_u32 s39, s39, 1
    s_cselect_b64 s[58:59], -1, 0
    s_cselect_b32 s39, 0, s39
    s_or_b64 s[56:57], s[56:57], s[58:59]
    s_branch gate_113
skip_gate_114:
    s_add_u32 s30, s42, 5
    s_and_b32 s30, s30, 7
    s_and_b32 s31, s30, 4
    s_add_u32 s30, s30, s31
    s_mul_i32 s30, s30, 57344
    s_add_u32 s30, s30, s66
    s_add_u32 s30, s30, s63
    s_add_u32 s28, s30, 0
    s_add_u32 m0, s34, 49152
    s_nop 0
    buffer_load_dwordx4 v4, s[8:11], s28 offen offset:0 sc1 lds
    buffer_load_dwordx4 v4, s[8:11], s28 offen offset:1024 sc1 lds
    buffer_load_dwordx4 v4, s[8:11], s28 offen offset:2048 sc1 lds
    buffer_load_dwordx4 v4, s[8:11], s28 offen offset:3072 sc1 lds
    s_lshl_b32 s29, s28, 3
    s_add_u32 m0, s41, 126976
    s_nop 0
    buffer_load_dwordx4 v16, s[52:55], s29 offen offset:0 lds
    buffer_load_dwordx4 v17, s[52:55], s29 offen offset:1024 lds
    buffer_load_dwordx4 v18, s[52:55], s29 offen offset:2048 lds
    buffer_load_dwordx4 v19, s[52:55], s29 offen offset:3072 lds
    s_waitcnt vmcnt(16)
    s_barrier
gate_115:
    s_bfe_u32 s30, s56, 0x40014
    s_cmp_eq_u32 s30, 15
    s_cbranch_scc1 skip_gate_116
    buffer_load_dwordx2 v[28:29], v26, s[76:79], s33 offen sc0 sc1
    s_waitcnt vmcnt(0)
    v_cmp_eq_u64 s[56:57], s[72:73], v[28:29]
    s_nop 3
    s_sub_u32 s39, s39, 1
    s_cselect_b64 s[58:59], -1, 0
    s_cselect_b32 s39, 0, s39
    s_or_b64 s[56:57], s[56:57], s[58:59]
    s_branch gate_115
skip_gate_116:
    s_add_u32 s30, s42, 6
    s_and_b32 s30, s30, 7
    s_and_b32 s31, s30, 4
    s_add_u32 s30, s30, s31
    s_mul_i32 s30, s30, 57344
    s_add_u32 s30, s30, s66
    s_add_u32 s30, s30, s63
    s_add_u32 s28, s30, 0
    s_add_u32 m0, s34, 0
    s_nop 0
    buffer_load_dwordx4 v4, s[8:11], s28 offen offset:0 sc1 lds
    buffer_load_dwordx4 v4, s[8:11], s28 offen offset:1024 sc1 lds
    buffer_load_dwordx4 v4, s[8:11], s28 offen offset:2048 sc1 lds
    buffer_load_dwordx4 v4, s[8:11], s28 offen offset:3072 sc1 lds
    s_lshl_b32 s29, s28, 3
    s_add_u32 m0, s41, 77824
    s_nop 0
    buffer_load_dwordx4 v16, s[52:55], s29 offen offset:0 lds
    buffer_load_dwordx4 v17, s[52:55], s29 offen offset:1024 lds
    buffer_load_dwordx4 v18, s[52:55], s29 offen offset:2048 lds
    buffer_load_dwordx4 v19, s[52:55], s29 offen offset:3072 lds
    s_waitcnt vmcnt(16)
    s_barrier
gate_117:
    s_bfe_u32 s30, s56, 0x40018
    s_cmp_eq_u32 s30, 15
    s_cbranch_scc1 skip_gate_118
    buffer_load_dwordx2 v[28:29], v26, s[76:79], s33 offen sc0 sc1
    s_waitcnt vmcnt(0)
    v_cmp_eq_u64 s[56:57], s[72:73], v[28:29]
    s_nop 3
    s_sub_u32 s39, s39, 1
    s_cselect_b64 s[58:59], -1, 0
    s_cselect_b32 s39, 0, s39
    s_or_b64 s[56:57], s[56:57], s[58:59]
    s_branch gate_117
skip_gate_118:
    s_add_u32 s30, s42, 7
    s_and_b32 s30, s30, 7
    s_and_b32 s31, s30, 4
    s_add_u32 s30, s30, s31
    s_mul_i32 s30, s30, 57344
    s_add_u32 s30, s30, s66
    s_add_u32 s30, s30, s63
    s_add_u32 s28, s30, 0
    s_add_u32 m0, s34, 16384
    s_nop 0
    buffer_load_dwordx4 v4, s[8:11], s28 offen offset:0 sc1 lds
    buffer_load_dwordx4 v4, s[8:11], s28 offen offset:1024 sc1 lds
    buffer_load_dwordx4 v4, s[8:11], s28 offen offset:2048 sc1 lds
    buffer_load_dwordx4 v4, s[8:11], s28 offen offset:3072 sc1 lds
    s_lshl_b32 s29, s28, 3
    s_add_u32 m0, s41, 94208
    s_nop 0
    buffer_load_dwordx4 v16, s[52:55], s29 offen offset:0 lds
    buffer_load_dwordx4 v17, s[52:55], s29 offen offset:1024 lds
    buffer_load_dwordx4 v18, s[52:55], s29 offen offset:2048 lds
    buffer_load_dwordx4 v19, s[52:55], s29 offen offset:3072 lds
    s_waitcnt vmcnt(16)
    s_barrier
    s_add_u32 s30, s66, s64
    s_add_u32 s28, s30, 24576
    s_add_u32 m0, s34, 32768
    s_nop 0
    buffer_load_dwordx4 v4, s[8:11], s28 offen offset:0 sc1 lds
    buffer_load_dwordx4 v4, s[8:11], s28 offen offset:1024 sc1 lds
    buffer_load_dwordx4 v4, s[8:11], s28 offen offset:2048 sc1 lds
    buffer_load_dwordx4 v4, s[8:11], s28 offen offset:3072 sc1 lds
    s_lshl_b32 s29, s28, 3
    s_add_u32 m0, s41, 110592
    s_nop 0
    buffer_load_dwordx4 v16, s[52:55], s29 offen offset:0 lds
    buffer_load_dwordx4 v17, s[52:55], s29 offen offset:1024 lds
    buffer_load_dwordx4 v18, s[52:55], s29 offen offset:2048 lds
    buffer_load_dwordx4 v19, s[52:55], s29 offen offset:3072 lds
    s_waitcnt vmcnt(16)
    s_barrier
    s_add_u32 s30, s66, s64
    s_add_u32 s28, s30, 139264
    s_add_u32 m0, s34, 49152
    s_nop 0
    buffer_load_dwordx4 v4, s[8:11], s28 offen offset:0 sc1 lds
    buffer_load_dwordx4 v4, s[8:11], s28 offen offset:1024 sc1 lds
    buffer_load_dwordx4 v4, s[8:11], s28 offen offset:2048 sc1 lds
    buffer_load_dwordx4 v4, s[8:11], s28 offen offset:3072 sc1 lds
    s_lshl_b32 s29, s28, 3
    s_add_u32 m0, s41, 126976
    s_nop 0
    buffer_load_dwordx4 v16, s[52:55], s29 offen offset:0 lds
    buffer_load_dwordx4 v17, s[52:55], s29 offen offset:1024 lds
    buffer_load_dwordx4 v18, s[52:55], s29 offen offset:2048 lds
    buffer_load_dwordx4 v19, s[52:55], s29 offen offset:3072 lds
    s_waitcnt vmcnt(16)
    s_barrier
    s_add_u32 s37, s33, 49152
    buffer_load_dwordx2 v[30:31], v26, s[76:79], s37 offen sc0 sc1
    s_add_u32 s30, s66, s64
    s_add_u32 s28, s30, 483328
    s_add_u32 m0, s34, 0
    s_nop 0
    buffer_load_dwordx4 v4, s[8:11], s28 offen offset:0 sc1 lds
    buffer_load_dwordx4 v4, s[8:11], s28 offen offset:1024 sc1 lds
    buffer_load_dwordx4 v4, s[8:11], s28 offen offset:2048 sc1 lds
    buffer_load_dwordx4 v4, s[8:11], s28 offen offset:3072 sc1 lds
    s_lshl_b32 s29, s28, 3
    s_add_u32 m0, s41, 77824
    s_nop 0
    buffer_load_dwordx4 v16, s[52:55], s29 offen offset:0 lds
    buffer_load_dwordx4 v17, s[52:55], s29 offen offset:1024 lds
    buffer_load_dwordx4 v18, s[52:55], s29 offen offset:2048 lds
    buffer_load_dwordx4 v19, s[52:55], s29 offen offset:3072 lds
    s_waitcnt vmcnt(17)
    s_barrier
    s_add_u32 s30, s66, s64
    s_add_u32 s28, s30, 598016
    s_add_u32 m0, s34, 16384
    s_nop 0
    buffer_load_dwordx4 v4, s[8:11], s28 offen offset:0 sc1 lds
    buffer_load_dwordx4 v4, s[8:11], s28 offen offset:1024 sc1 lds
    buffer_load_dwordx4 v4, s[8:11], s28 offen offset:2048 sc1 lds
    buffer_load_dwordx4 v4, s[8:11], s28 offen offset:3072 sc1 lds
    s_lshl_b32 s29, s28, 3
    s_add_u32 m0, s41, 94208
    s_nop 0
    buffer_load_dwordx4 v16, s[52:55], s29 offen offset:0 lds
    buffer_load_dwordx4 v17, s[52:55], s29 offen offset:1024 lds
    buffer_load_dwordx4 v18, s[52:55], s29 offen offset:2048 lds
    buffer_load_dwordx4 v19, s[52:55], s29 offen offset:3072 lds
    s_waitcnt vmcnt(17)
    s_barrier
    s_waitcnt vmcnt(16)
    v_cmp_eq_u64 s[56:57], s[72:73], v[30:31]
    s_mov_b32 s33, s37
    s_nop 3
gate_119:
    s_cmp_eq_u32 s56, -1
    s_cbranch_scc1 skip_gate_120
    buffer_load_dwordx2 v[28:29], v26, s[76:79], s33 offen sc0 sc1
    s_waitcnt vmcnt(0)
    v_cmp_eq_u64 s[56:57], s[72:73], v[28:29]
    s_nop 3
    s_sub_u32 s39, s39, 1
    s_cselect_b64 s[58:59], -1, 0
    s_cselect_b32 s39, 0, s39
    s_or_b64 s[56:57], s[56:57], s[58:59]
    s_branch gate_119
skip_gate_120:
    s_add_u32 s30, s42, 1
    s_and_b32 s30, s30, 7
    s_and_b32 s31, s30, 4
    s_add_u32 s30, s30, s31
    s_mul_i32 s30, s30, 57344
    s_add_u32 s30, s30, s66
    s_add_u32 s30, s30, s63
    s_add_u32 s28, s30, 8192
    s_add_u32 m0, s34, 32768
    s_nop 0
    buffer_load_dwordx4 v4, s[8:11], s28 offen offset:0 sc1 lds
    buffer_load_dwordx4 v4, s[8:11], s28 offen offset:1024 sc1 lds
    buffer_load_dwordx4 v4, s[8:11], s28 offen offset:2048 sc1 lds
    buffer_load_dwordx4 v4, s[8:11], s28 offen offset:3072 sc1 lds
    s_lshl_b32 s29, s28, 3
    s_add_u32 m0, s41, 110592
    s_nop 0
    buffer_load_dwordx4 v16, s[52:55], s29 offen offset:0 lds
    buffer_load_dwordx4 v17, s[52:55], s29 offen offset:1024 lds
    buffer_load_dwordx4 v18, s[52:55], s29 offen offset:2048 lds
    buffer_load_dwordx4 v19, s[52:55], s29 offen offset:3072 lds
    s_waitcnt vmcnt(16)
    s_barrier
    s_add_u32 s30, s42, 2
    s_and_b32 s30, s30, 7
    s_and_b32 s31, s30, 4
    s_add_u32 s30, s30, s31
    s_mul_i32 s30, s30, 57344
    s_add_u32 s30, s30, s66
    s_add_u32 s30, s30, s63
    s_add_u32 s28, s30, 8192
    s_add_u32 m0, s34, 49152
    s_nop 0
    buffer_load_dwordx4 v4, s[8:11], s28 offen offset:0 sc1 lds
    buffer_load_dwordx4 v4, s[8:11], s28 offen offset:1024 sc1 lds
    buffer_load_dwordx4 v4, s[8:11], s28 offen offset:2048 sc1 lds
    buffer_load_dwordx4 v4, s[8:11], s28 offen offset:3072 sc1 lds
    s_lshl_b32 s29, s28, 3
    s_add_u32 m0, s41, 126976
    s_nop 0
    buffer_load_dwordx4 v16, s[52:55], s29 offen offset:0 lds
    buffer_load_dwordx4 v17, s[52:55], s29 offen offset:1024 lds
    buffer_load_dwordx4 v18, s[52:55], s29 offen offset:2048 lds
    buffer_load_dwordx4 v19, s[52:55], s29 offen offset:3072 lds
    s_waitcnt vmcnt(16)
    s_barrier
    s_add_u32 s30, s42, 3
    s_and_b32 s30, s30, 7
    s_and_b32 s31, s30, 4
    s_add_u32 s30, s30, s31
    s_mul_i32 s30, s30, 57344
    s_add_u32 s30, s30, s66
    s_add_u32 s30, s30, s63
    s_add_u32 s28, s30, 8192
    s_add_u32 m0, s34, 0
    s_nop 0
    buffer_load_dwordx4 v4, s[8:11], s28 offen offset:0 sc1 lds
    buffer_load_dwordx4 v4, s[8:11], s28 offen offset:1024 sc1 lds
    buffer_load_dwordx4 v4, s[8:11], s28 offen offset:2048 sc1 lds
    buffer_load_dwordx4 v4, s[8:11], s28 offen offset:3072 sc1 lds
    s_lshl_b32 s29, s28, 3
    s_add_u32 m0, s41, 77824
    s_nop 0
    buffer_load_dwordx4 v16, s[52:55], s29 offen offset:0 lds
    buffer_load_dwordx4 v17, s[52:55], s29 offen offset:1024 lds
    buffer_load_dwordx4 v18, s[52:55], s29 offen offset:2048 lds
    buffer_load_dwordx4 v19, s[52:55], s29 offen offset:3072 lds
    s_waitcnt vmcnt(16)
    s_barrier
    s_add_u32 s30, s42, 4
    s_and_b32 s30, s30, 7
    s_and_b32 s31, s30, 4
    s_add_u32 s30, s30, s31
    s_mul_i32 s30, s30, 57344
    s_add_u32 s30, s30, s66
    s_add_u32 s30, s30, s63
    s_add_u32 s28, s30, 8192
    s_add_u32 m0, s34, 16384
    s_nop 0
    buffer_load_dwordx4 v4, s[8:11], s28 offen offset:0 sc1 lds
    buffer_load_dwordx4 v4, s[8:11], s28 offen offset:1024 sc1 lds
    buffer_load_dwordx4 v4, s[8:11], s28 offen offset:2048 sc1 lds
    buffer_load_dwordx4 v4, s[8:11], s28 offen offset:3072 sc1 lds
    s_lshl_b32 s29, s28, 3
    s_add_u32 m0, s41, 94208
    s_nop 0
    buffer_load_dwordx4 v16, s[52:55], s29 offen offset:0 lds
    buffer_load_dwordx4 v17, s[52:55], s29 offen offset:1024 lds
    buffer_load_dwordx4 v18, s[52:55], s29 offen offset:2048 lds
    buffer_load_dwordx4 v19, s[52:55], s29 offen offset:3072 lds
    s_waitcnt vmcnt(16)
    s_barrier
    s_add_u32 s30, s42, 5
    s_and_b32 s30, s30, 7
    s_and_b32 s31, s30, 4
    s_add_u32 s30, s30, s31
    s_mul_i32 s30, s30, 57344
    s_add_u32 s30, s30, s66
    s_add_u32 s30, s30, s63
    s_add_u32 s28, s30, 8192
    s_add_u32 m0, s34, 32768
    s_nop 0
    buffer_load_dwordx4 v4, s[8:11], s28 offen offset:0 sc1 lds
    buffer_load_dwordx4 v4, s[8:11], s28 offen offset:1024 sc1 lds
    buffer_load_dwordx4 v4, s[8:11], s28 offen offset:2048 sc1 lds
    buffer_load_dwordx4 v4, s[8:11], s28 offen offset:3072 sc1 lds
    s_lshl_b32 s29, s28, 3
    s_add_u32 m0, s41, 110592
    s_nop 0
    buffer_load_dwordx4 v16, s[52:55], s29 offen offset:0 lds
    buffer_load_dwordx4 v17, s[52:55], s29 offen offset:1024 lds
    buffer_load_dwordx4 v18, s[52:55], s29 offen offset:2048 lds
    buffer_load_dwordx4 v19, s[52:55], s29 offen offset:3072 lds
    s_waitcnt vmcnt(16)
    s_barrier
    s_add_u32 s30, s42, 6
    s_and_b32 s30, s30, 7
    s_and_b32 s31, s30, 4
    s_add_u32 s30, s30, s31
    s_mul_i32 s30, s30, 57344
    s_add_u32 s30, s30, s66
    s_add_u32 s30, s30, s63
    s_add_u32 s28, s30, 8192
    s_add_u32 m0, s34, 49152
    s_nop 0
    buffer_load_dwordx4 v4, s[8:11], s28 offen offset:0 sc1 lds
    buffer_load_dwordx4 v4, s[8:11], s28 offen offset:1024 sc1 lds
    buffer_load_dwordx4 v4, s[8:11], s28 offen offset:2048 sc1 lds
    buffer_load_dwordx4 v4, s[8:11], s28 offen offset:3072 sc1 lds
    s_lshl_b32 s29, s28, 3
    s_add_u32 m0, s41, 126976
    s_nop 0
    buffer_load_dwordx4 v16, s[52:55], s29 offen offset:0 lds
    buffer_load_dwordx4 v17, s[52:55], s29 offen offset:1024 lds
    buffer_load_dwordx4 v18, s[52:55], s29 offen offset:2048 lds
    buffer_load_dwordx4 v19, s[52:55], s29 offen offset:3072 lds
    s_waitcnt vmcnt(16)
    s_barrier
    s_add_u32 s30, s42, 7
    s_and_b32 s30, s30, 7
    s_and_b32 s31, s30, 4
    s_add_u32 s30, s30, s31
    s_mul_i32 s30, s30, 57344
    s_add_u32 s30, s30, s66
    s_add_u32 s30, s30, s63
    s_add_u32 s28, s30, 8192
    s_add_u32 m0, s34, 0
    s_nop 0
    buffer_load_dwordx4 v4, s[8:11], s28 offen offset:0 sc1 lds
    buffer_load_dwordx4 v4, s[8:11], s28 offen offset:1024 sc1 lds
    buffer_load_dwordx4 v4, s[8:11], s28 offen offset:2048 sc1 lds
    buffer_load_dwordx4 v4, s[8:11], s28 offen offset:3072 sc1 lds
    s_lshl_b32 s29, s28, 3
    s_add_u32 m0, s41, 77824
    s_nop 0
    buffer_load_dwordx4 v16, s[52:55], s29 offen offset:0 lds
    buffer_load_dwordx4 v17, s[52:55], s29 offen offset:1024 lds
    buffer_load_dwordx4 v18, s[52:55], s29 offen offset:2048 lds
    buffer_load_dwordx4 v19, s[52:55], s29 offen offset:3072 lds
    s_waitcnt vmcnt(16)
    s_barrier
    s_add_u32 s30, s42, 1
    s_and_b32 s30, s30, 7
    s_and_b32 s31, s30, 4
    s_add_u32 s30, s30, s31
    s_mul_i32 s30, s30, 57344
    s_add_u32 s30, s30, s66
    s_add_u32 s30, s30, s63
    s_add_u32 s28, s30, 16384
    s_add_u32 m0, s34, 16384
    s_nop 0
    buffer_load_dwordx4 v4, s[8:11], s28 offen offset:0 sc1 lds
    buffer_load_dwordx4 v4, s[8:11], s28 offen offset:1024 sc1 lds
    buffer_load_dwordx4 v4, s[8:11], s28 offen offset:2048 sc1 lds
    buffer_load_dwordx4 v4, s[8:11], s28 offen offset:3072 sc1 lds
    s_lshl_b32 s29, s28, 3
    s_add_u32 m0, s41, 94208
    s_nop 0
    buffer_load_dwordx4 v16, s[52:55], s29 offen offset:0 lds
    buffer_load_dwordx4 v17, s[52:55], s29 offen offset:1024 lds
    buffer_load_dwordx4 v18, s[52:55], s29 offen offset:2048 lds
    buffer_load_dwordx4 v19, s[52:55], s29 offen offset:3072 lds
    s_waitcnt vmcnt(16)
    s_barrier
    s_add_u32 s30, s42, 2
    s_and_b32 s30, s30, 7
    s_and_b32 s31, s30, 4
    s_add_u32 s30, s30, s31
    s_mul_i32 s30, s30, 57344
    s_add_u32 s30, s30, s66
    s_add_u32 s30, s30, s63
    s_add_u32 s28, s30, 16384
    s_add_u32 m0, s34, 32768
    s_nop 0
    buffer_load_dwordx4 v4, s[8:11], s28 offen offset:0 sc1 lds
    buffer_load_dwordx4 v4, s[8:11], s28 offen offset:1024 sc1 lds
    buffer_load_dwordx4 v4, s[8:11], s28 offen offset:2048 sc1 lds
    buffer_load_dwordx4 v4, s[8:11], s28 offen offset:3072 sc1 lds
    s_lshl_b32 s29, s28, 3
    s_add_u32 m0, s41, 110592
    s_nop 0
    buffer_load_dwordx4 v16, s[52:55], s29 offen offset:0 lds
    buffer_load_dwordx4 v17, s[52:55], s29 offen offset:1024 lds
    buffer_load_dwordx4 v18, s[52:55], s29 offen offset:2048 lds
    buffer_load_dwordx4 v19, s[52:55], s29 offen offset:3072 lds
    s_waitcnt vmcnt(16)
    s_barrier
    s_add_u32 s30, s42, 3
    s_and_b32 s30, s30, 7
    s_and_b32 s31, s30, 4
    s_add_u32 s30, s30, s31
    s_mul_i32 s30, s30, 57344
    s_add_u32 s30, s30, s66
    s_add_u32 s30, s30, s63
    s_add_u32 s28, s30, 16384
    s_add_u32 m0, s34, 49152
    s_nop 0
    buffer_load_dwordx4 v4, s[8:11], s28 offen offset:0 sc1 lds
    buffer_load_dwordx4 v4, s[8:11], s28 offen offset:1024 sc1 lds
    buffer_load_dwordx4 v4, s[8:11], s28 offen offset:2048 sc1 lds
    buffer_load_dwordx4 v4, s[8:11], s28 offen offset:3072 sc1 lds
    s_lshl_b32 s29, s28, 3
    s_add_u32 m0, s41, 126976
    s_nop 0
    buffer_load_dwordx4 v16, s[52:55], s29 offen offset:0 lds
    buffer_load_dwordx4 v17, s[52:55], s29 offen offset:1024 lds
    buffer_load_dwordx4 v18, s[52:55], s29 offen offset:2048 lds
    buffer_load_dwordx4 v19, s[52:55], s29 offen offset:3072 lds
    s_waitcnt vmcnt(16)
    s_barrier
    s_add_u32 s30, s42, 4
    s_and_b32 s30, s30, 7
    s_and_b32 s31, s30, 4
    s_add_u32 s30, s30, s31
    s_mul_i32 s30, s30, 57344
    s_add_u32 s30, s30, s66
    s_add_u32 s30, s30, s63
    s_add_u32 s28, s30, 16384
    s_add_u32 m0, s34, 0
    s_nop 0
    buffer_load_dwordx4 v4, s[8:11], s28 offen offset:0 sc1 lds
    buffer_load_dwordx4 v4, s[8:11], s28 offen offset:1024 sc1 lds
    buffer_load_dwordx4 v4, s[8:11], s28 offen offset:2048 sc1 lds
    buffer_load_dwordx4 v4, s[8:11], s28 offen offset:3072 sc1 lds
    s_lshl_b32 s29, s28, 3
    s_add_u32 m0, s41, 77824
    s_nop 0
    buffer_load_dwordx4 v16, s[52:55], s29 offen offset:0 lds
    buffer_load_dwordx4 v17, s[52:55], s29 offen offset:1024 lds
    buffer_load_dwordx4 v18, s[52:55], s29 offen offset:2048 lds
    buffer_load_dwordx4 v19, s[52:55], s29 offen offset:3072 lds
    s_waitcnt vmcnt(16)
    s_barrier
    s_add_u32 s30, s42, 5
    s_and_b32 s30, s30, 7
    s_and_b32 s31, s30, 4
    s_add_u32 s30, s30, s31
    s_mul_i32 s30, s30, 57344
    s_add_u32 s30, s30, s66
    s_add_u32 s30, s30, s63
    s_add_u32 s28, s30, 16384
    s_add_u32 m0, s34, 16384
    s_nop 0
    buffer_load_dwordx4 v4, s[8:11], s28 offen offset:0 sc1 lds
    buffer_load_dwordx4 v4, s[8:11], s28 offen offset:1024 sc1 lds
    buffer_load_dwordx4 v4, s[8:11], s28 offen offset:2048 sc1 lds
    buffer_load_dwordx4 v4, s[8:11], s28 offen offset:3072 sc1 lds
    s_lshl_b32 s29, s28, 3
    s_add_u32 m0, s41, 94208
    s_nop 0
    buffer_load_dwordx4 v16, s[52:55], s29 offen offset:0 lds
    buffer_load_dwordx4 v17, s[52:55], s29 offen offset:1024 lds
    buffer_load_dwordx4 v18, s[52:55], s29 offen offset:2048 lds
    buffer_load_dwordx4 v19, s[52:55], s29 offen offset:3072 lds
    s_waitcnt vmcnt(16)
    s_barrier
    s_add_u32 s30, s42, 6
    s_and_b32 s30, s30, 7
    s_and_b32 s31, s30, 4
    s_add_u32 s30, s30, s31
    s_mul_i32 s30, s30, 57344
    s_add_u32 s30, s30, s66
    s_add_u32 s30, s30, s63
    s_add_u32 s28, s30, 16384
    s_add_u32 m0, s34, 32768
    s_nop 0
    buffer_load_dwordx4 v4, s[8:11], s28 offen offset:0 sc1 lds
    buffer_load_dwordx4 v4, s[8:11], s28 offen offset:1024 sc1 lds
    buffer_load_dwordx4 v4, s[8:11], s28 offen offset:2048 sc1 lds
    buffer_load_dwordx4 v4, s[8:11], s28 offen offset:3072 sc1 lds
    s_lshl_b32 s29, s28, 3
    s_add_u32 m0, s41, 110592
    s_nop 0
    buffer_load_dwordx4 v16, s[52:55], s29 offen offset:0 lds
    buffer_load_dwordx4 v17, s[52:55], s29 offen offset:1024 lds
    buffer_load_dwordx4 v18, s[52:55], s29 offen offset:2048 lds
    buffer_load_dwordx4 v19, s[52:55], s29 offen offset:3072 lds
    s_waitcnt vmcnt(16)
    s_barrier
    s_add_u32 s30, s42, 7
    s_and_b32 s30, s30, 7
    s_and_b32 s31, s30, 4
    s_add_u32 s30, s30, s31
    s_mul_i32 s30, s30, 57344
    s_add_u32 s30, s30, s66
    s_add_u32 s30, s30, s63
    s_add_u32 s28, s30, 16384
    s_add_u32 m0, s34, 49152
    s_nop 0
    buffer_load_dwordx4 v4, s[8:11], s28 offen offset:0 sc1 lds
    buffer_load_dwordx4 v4, s[8:11], s28 offen offset:1024 sc1 lds
    buffer_load_dwordx4 v4, s[8:11], s28 offen offset:2048 sc1 lds
    buffer_load_dwordx4 v4, s[8:11], s28 offen offset:3072 sc1 lds
    s_lshl_b32 s29, s28, 3
    s_add_u32 m0, s41, 126976
    s_nop 0
    buffer_load_dwordx4 v16, s[52:55], s29 offen offset:0 lds
    buffer_load_dwordx4 v17, s[52:55], s29 offen offset:1024 lds
    buffer_load_dwordx4 v18, s[52:55], s29 offen offset:2048 lds
    buffer_load_dwordx4 v19, s[52:55], s29 offen offset:3072 lds
    s_waitcnt vmcnt(16)
    s_barrier
    s_waitcnt vmcnt(8)
    s_barrier
    s_waitcnt vmcnt(0)
    s_barrier
    s_barrier
L_end:
    s_endpgm
L_code_end:
.section .rodata,"a"
.p2align 6
.amdhsa_kernel sequential_preLN__sliding_block__dense_activation_silu__prompt_kernel
  .amdhsa_next_free_vgpr 256
  .amdhsa_next_free_sgpr 102
  .amdhsa_accum_offset 256
  .amdhsa_group_segment_fixed_size 0
  .amdhsa_kernarg_size 72
  .amdhsa_user_sgpr_count 2
  .amdhsa_user_sgpr_kernarg_segment_ptr 1
  .amdhsa_system_sgpr_workgroup_id_x 1
.end_amdhsa_kernel
.text
```
